```python
import torch

def _softmax(x, axis=-1):
    return torch.softmax(x, dim=axis)
def _gelu(x):
    return torch.nn.functional.gelu(x, approximate="tanh")
def _silu(x):
    return torch.nn.functional.silu(x)
def _sigmoid(x):
    return torch.sigmoid(x)
def _layernorm(x, axis=-1, eps=1e-5):
    m = x.mean(dim=axis, keepdim=True)
    v = x.var(dim=axis, keepdim=True, unbiased=False)
    return (x - m) / torch.sqrt(v + eps)
def _scatter_add(tgt, idx, src, axis=0):
    return tgt.clone().index_add_(axis, idx, src)
def _segment_sum(src, seg, n):
    out = torch.zeros((n,) + src.shape[1:], dtype=src.dtype)
    return out.index_add_(0, seg, src)
def _pad(x, pw):
    flat = tuple(v for pair in reversed(pw) for v in pair)
    return torch.nn.functional.pad(x, flat)

kernel_name = 'recurrent_scan__softmax_full_mha__mixer_channel_mlp__prompt'

def setup_inputs():

    _w = (lambda a: (lambda t: t.to(torch.bfloat16) if t.is_floating_point() else t)(torch.as_tensor(a)))
    def _A_setup():
        B, S, D = 1, 2048, 640
        return {
            "x": _w((lambda *s: torch.randn(*s, dtype=torch.bfloat16) * 0.05)(B, S, D)),
            "wqkv": _w((lambda *s: torch.randn(*s, dtype=torch.bfloat16) * 0.05)(D, 3 * D)),
            "wo": _w((lambda *s: torch.randn(*s, dtype=torch.bfloat16) * 0.05)(D, D)),
        }
    _A_in = _A_setup()

    def _B_setup():
        B, S, D, F = 1, 2048, 640, 1536
        return {
            "x": _w((lambda *s: torch.randn(*s, dtype=torch.bfloat16) * 0.05)(B, S, D)),
            "w1": _w((lambda *s: torch.randn(*s, dtype=torch.bfloat16) * 1.6)(D, F) * (D ** -0.5)),
            "b1": _w((lambda *s: torch.randn(*s, dtype=torch.bfloat16) * 0.8)(F)),
            "w2": _w((lambda *s: torch.randn(*s, dtype=torch.bfloat16) * 0.05)(F, D) * (F ** -0.5)),
            "b2": _w((lambda *s: torch.randn(*s, dtype=torch.bfloat16) * 0.05)(D)),
        }
    _B_in = _B_setup()

    return {
        "A_x": _A_in["x"],
        "A_wqkv": _A_in["wqkv"],
        "A_wo": _A_in["wo"],
        "B_x": _B_in["x"],
        "B_w1": _B_in["w1"],
        "B_b1": _B_in["b1"],
        "B_w2": _B_in["w2"],
        "B_b2": _B_in["b2"],
    }

def reference(A_x, A_wqkv, A_wo, B_x, B_w1, B_b1, B_w2, B_b2):
    def _A_ref(x, wqkv, wo):
        B, S, D = x.shape
        H = 32; Dh = D // H
        qkv = (lambda x, *d: x.permute(*d))((x @ wqkv).reshape(B, S, 3, H, Dh), 2, 0, 3, 1, 4)
        q, k, v = qkv[0], qkv[1], qkv[2]
        scale = Dh ** -0.5
        scores = torch.einsum("bhqd,bhkd->bhqk", q, k) * scale
        p = _softmax(scores, axis=-1)
        o = torch.einsum("bhqk,bhkd->bhqd", p, v)
        return (lambda x, *d: x.permute(*d))(o, 0, 2, 1, 3).reshape(B, S, D) @ wo

    def _B_ref(x, w1, b1, w2, b2):
        y = _layernorm(x, axis=-1)
        h = _gelu(torch.einsum("bsd,df->bsf", y, w1) + b1)
        return torch.einsum("bsf,fd->bsd", h, w2) + b2

    x = A_x
    xn = _layernorm(x, axis=-1)
    s = _A_ref(xn, A_wqkv, A_wo)
    g = _silu(_B_ref(xn, B_w1, B_b1, B_w2, B_b2))
    return x + s * g
```

```asm
; @launch kernel=p1_kernel grid=(256,1,1) block=(512,1,1) lds=163328
; @launch kernel=attn_kernel grid=(256,1,1) block=(768,1,1) lds=158336
.amdgcn_target "amdgcn-amd-amdhsa--gfx950"
.text
.globl p1_kernel
.p2align 8
.type p1_kernel,@function
p1_kernel:
    s_cmp_ge_u32 s2, 256
    s_cbranch_scc1 p1_kernel_end
    s_load_dwordx4 s[36:39], s[0:1], 0
    s_load_dwordx4 s[40:43], s[0:1], 32
    s_load_dwordx4 s[72:75], s[0:1], 72
    s_load_dwordx2 s[80:81], s[0:1], 48
    s_load_dwordx2 s[82:83], s[0:1], 16
    v_lshrrev_b32 v4, 6, v0
    v_and_b32 v1, 63, v0
    s_and_b32 s48, s2, 7
    v_readfirstlane_b32 s20, v4
    s_lshr_b32 s49, s2, 3
    s_and_b32 s50, s48, 1
    s_lshr_b32 s51, s48, 1
    s_and_b32 s52, s49, 3
    s_lshl_b32 s50, s50, 2
    s_add_u32 s21, s50, s52
    s_lshr_b32 s52, s49, 2
    s_lshl_b32 s51, s51, 3
    s_add_u32 s22, s51, s52
    v_and_b32 v2, 31, v1
    v_lshrrev_b32 v3, 5, v1
    s_mov_b32 s44, -1
    s_mov_b32 s45, 0
    s_lshl_b32 s34, s21, 8
    s_lshl_b32 s48, s22, 3
    s_add_u32 s48, s48, s34
    s_add_u32 s48, s48, s20
    s_mul_i32 s53, s48, 1280
    s_lshl_b32 s48, s20, 5
    s_add_u32 s34, s34, s48
    v_lshlrev_b32 v34, 4, v1
    v_lshlrev_b32 v35, 2, v1
    s_waitcnt lgkmcnt(0)
    s_mov_b32 s4, s36
    s_and_b32 s5, s37, 0xffff
    s_mov_b32 s6, 0x280000
    s_mov_b32 s7, 0x00020000
    v_mov_b32 v182, v34
    v_mov_b32 v183, v35
    s_mov_b32 s12, s74
    s_and_b32 s13, s75, 0xffff
    s_mov_b32 s14, 0x10000000
    s_mov_b32 s15, 0x00020000
    s_mov_b32 s16, s42
    s_and_b32 s17, s43, 0xffff
    s_mov_b32 s18, 0xc00
    s_mov_b32 s19, 0x00020000
    s_mov_b32 s76, s72
    s_and_b32 s77, s73, 0xffff
    s_mov_b32 s78, 0x100
    s_mov_b32 s79, 0x00020000
    v_lshrrev_b32 v34, 3, v1
    v_and_b32 v35, 7, v1
    v_add_u32 v36, 0, v34
    v_lshrrev_b32 v37, 1, v36
    v_and_b32 v37, 7, v37
    v_xor_b32 v37, v37, v35
    v_mul_u32_u24 v36, 1280, v36
    v_lshl_add_u32 v4, v37, 4, v36
    v_add_u32 v36, 8, v34
    v_lshrrev_b32 v37, 1, v36
    v_and_b32 v37, 7, v37
    v_xor_b32 v37, v37, v35
    v_mul_u32_u24 v36, 1280, v36
    v_lshl_add_u32 v5, v37, 4, v36
    v_add_u32 v36, 16, v34
    v_lshrrev_b32 v37, 1, v36
    v_and_b32 v37, 7, v37
    v_xor_b32 v37, v37, v35
    v_mul_u32_u24 v36, 1280, v36
    v_lshl_add_u32 v6, v37, 4, v36
    v_add_u32 v36, 24, v34
    v_lshrrev_b32 v37, 1, v36
    v_and_b32 v37, 7, v37
    v_xor_b32 v37, v37, v35
    v_mul_u32_u24 v36, 1280, v36
    v_lshl_add_u32 v7, v37, 4, v36
    s_mul_i32 s24, s34, 1280
    s_lshl_b32 s27, s20, 12
    s_cmp_eq_u32 s22, 31
    s_cbranch_scc1 p1_kernel_S
    s_cmp_ge_u32 s22, 15
    s_cbranch_scc1 p1_kernel_F
    s_mov_b32 s8, s38
    s_and_b32 s9, s39, 0xffff
    s_mov_b32 s10, 0x258000
    s_mov_b32 s11, 0x00020000
    s_cmp_ge_u32 s22, 10
    s_cbranch_scc1 p1_kernel_V
    s_lshl_b32 s33, s22, 7
    s_mov_b32 s29, 0
    s_mov_b32 s30, 1
    s_mov_b32 s31, 2
    s_mov_b32 s32, 3
    v_lshrrev_b32 v34, 4, v1
    v_bfe_u32 v35, v1, 2, 2
    v_xor_b32 v35, v35, v34
    v_and_b32 v36, 3, v1
    v_mul_u32_u24 v34, 3840, v34
    v_lshl_add_u32 v34, v35, 6, v34
    v_lshl_add_u32 v8, v36, 4, v34
    v_add_u32 v9, 15360, v8
    s_lshl_b32 s28, s20, 11
    s_add_u32 s28, s28, 32768
    s_mul_i32 s25, s20, 30720
    s_lshl_b32 s48, s33, 1
    s_add_u32 s25, s25, s48
    s_and_b32 s55, s22, 7
    s_and_b32 s56, s21, 3
    s_mul_i32 s56, s56, 3
    s_add_u32 s55, s55, s56
    s_cmp_ge_u32 s55, 10
    s_cselect_b32 s56, 10, 0
    s_sub_u32 s55, s55, s56
    s_lshl_b32 s56, s55, 7
    s_add_u32 s24, s24, s56
    s_mul_i32 s56, s55, 245760
    s_add_u32 s25, s25, s56
    buffer_load_dwordx4 v[152:155], v182, s[4:7], s53 offen
    buffer_load_dword v156, v183, s[4:7], s53 offen offset:1024
    s_mul_i32 s48, s21, 80
    s_mul_i32 s49, s20, 10
    s_add_u32 s48, s48, s49
    s_mul_i32 s48, s48, 3840
    s_lshl_b32 s49, s33, 1
    s_add_u32 s48, s48, s49
    buffer_load_dword v158, v183, s[8:11], s48 offen
    s_add_u32 s48, s48, 3840
    buffer_load_dword v159, v183, s[8:11], s48 offen
    s_add_u32 s48, s48, 3840
    buffer_load_dword v160, v183, s[8:11], s48 offen
    s_add_u32 s48, s48, 3840
    buffer_load_dword v161, v183, s[8:11], s48 offen
    s_add_u32 s48, s48, 3840
    buffer_load_dword v162, v183, s[8:11], s48 offen
    s_add_u32 s48, s48, 3840
    buffer_load_dword v163, v183, s[8:11], s48 offen
    s_add_u32 s48, s48, 3840
    buffer_load_dword v164, v183, s[8:11], s48 offen
    s_add_u32 s48, s48, 3840
    buffer_load_dword v165, v183, s[8:11], s48 offen
    s_add_u32 s48, s48, 3840
    buffer_load_dword v166, v183, s[8:11], s48 offen
    s_add_u32 s48, s48, 3840
    buffer_load_dword v167, v183, s[8:11], s48 offen
    s_add_u32 s48, s48, 3840
    s_add_u32 m0, s27, 0
    s_nop 0
    buffer_load_dwordx4 v4, s[4:7], s24 offen lds
    s_add_u32 m0, s27, 1024
    s_nop 0
    buffer_load_dwordx4 v5, s[4:7], s24 offen lds
    s_add_u32 m0, s27, 2048
    s_nop 0
    buffer_load_dwordx4 v6, s[4:7], s24 offen lds
    s_add_u32 m0, s27, 3072
    s_nop 0
    buffer_load_dwordx4 v7, s[4:7], s24 offen lds
    s_add_u32 s24, s24, 128
    s_cmp_eq_u32 s55, 9
    s_cselect_b32 s56, 1280, 0
    s_sub_u32 s24, s24, s56
    s_add_u32 m0, s28, 0
    s_nop 0
    buffer_load_dwordx4 v8, s[8:11], s25 offen lds
    s_add_u32 m0, s28, 1024
    s_nop 0
    buffer_load_dwordx4 v9, s[8:11], s25 offen lds
    s_add_u32 s25, s25, 245760
    s_cmp_eq_u32 s55, 9
    s_cselect_b32 s56, 2457600, 0
    s_sub_u32 s25, s25, s56
    s_add_u32 m0, s27, 49152
    s_nop 0
    buffer_load_dwordx4 v4, s[4:7], s24 offen lds
    s_add_u32 m0, s27, 50176
    s_nop 0
    buffer_load_dwordx4 v5, s[4:7], s24 offen lds
    s_add_u32 m0, s27, 51200
    s_nop 0
    buffer_load_dwordx4 v6, s[4:7], s24 offen lds
    s_add_u32 m0, s27, 52224
    s_nop 0
    buffer_load_dwordx4 v7, s[4:7], s24 offen lds
    s_add_u32 s24, s24, 128
    s_cmp_eq_u32 s55, 8
    s_cselect_b32 s56, 1280, 0
    s_sub_u32 s24, s24, s56
    s_add_u32 m0, s28, 49152
    s_nop 0
    buffer_load_dwordx4 v8, s[8:11], s25 offen lds
    s_add_u32 m0, s28, 50176
    s_nop 0
    buffer_load_dwordx4 v9, s[8:11], s25 offen lds
    s_add_u32 s25, s25, 245760
    s_cmp_eq_u32 s55, 8
    s_cselect_b32 s56, 2457600, 0
    s_sub_u32 s25, s25, s56
    v_lshrrev_b32 v34, 1, v2
    v_and_b32 v34, 7, v34
    s_lshl_b32 s48, s20, 12
    v_lshlrev_b32 v35, 7, v2
    v_add_u32 v35, s48, v35
    v_add_u32 v36, 0, v3
    v_xor_b32 v36, v36, v34
    v_lshl_add_u32 v10, v36, 4, v35
    v_add_u32 v14, 49152, v10
    v_add_u32 v18, 98304, v10
    v_add_u32 v36, 2, v3
    v_xor_b32 v36, v36, v34
    v_lshl_add_u32 v11, v36, 4, v35
    v_add_u32 v15, 49152, v11
    v_add_u32 v19, 98304, v11
    v_add_u32 v36, 4, v3
    v_xor_b32 v36, v36, v34
    v_lshl_add_u32 v12, v36, 4, v35
    v_add_u32 v16, 49152, v12
    v_add_u32 v20, 98304, v12
    v_add_u32 v36, 6, v3
    v_xor_b32 v36, v36, v34
    v_lshl_add_u32 v13, v36, 4, v35
    v_add_u32 v17, 49152, v13
    v_add_u32 v21, 98304, v13
    v_bfe_u32 v34, v1, 2, 2
    v_and_b32 v35, 3, v1
    v_bfe_u32 v36, v1, 4, 1
    v_lshl_add_u32 v37, v3, 3, v34
    v_mul_u32_u24 v37, 256, v37
    v_lshl_add_u32 v37, v36, 5, v37
    v_lshl_add_u32 v37, v35, 3, v37
    v_add_u32 v37, 32768, v37
    v_xor_b32 v38, s29, v34
    v_lshl_add_u32 v22, v38, 6, v37
    v_add_u32 v26, 49152, v22
    v_add_u32 v30, 98304, v22
    v_xor_b32 v38, s30, v34
    v_lshl_add_u32 v23, v38, 6, v37
    v_add_u32 v27, 49152, v23
    v_add_u32 v31, 98304, v23
    v_xor_b32 v38, s31, v34
    v_lshl_add_u32 v24, v38, 6, v37
    v_add_u32 v28, 49152, v24
    v_add_u32 v32, 98304, v24
    v_xor_b32 v38, s32, v34
    v_lshl_add_u32 v25, v38, 6, v37
    v_add_u32 v29, 49152, v25
    v_add_u32 v33, 98304, v25
    v_mov_b32 v88, 0
    v_mov_b32 v89, 0
    v_mov_b32 v90, 0
    v_mov_b32 v91, 0
    v_mov_b32 v92, 0
    v_mov_b32 v93, 0
    v_mov_b32 v94, 0
    v_mov_b32 v95, 0
    v_mov_b32 v96, 0
    v_mov_b32 v97, 0
    v_mov_b32 v98, 0
    v_mov_b32 v99, 0
    v_mov_b32 v100, 0
    v_mov_b32 v101, 0
    v_mov_b32 v102, 0
    v_mov_b32 v103, 0
    v_mov_b32 v104, 0
    v_mov_b32 v105, 0
    v_mov_b32 v106, 0
    v_mov_b32 v107, 0
    v_mov_b32 v108, 0
    v_mov_b32 v109, 0
    v_mov_b32 v110, 0
    v_mov_b32 v111, 0
    v_mov_b32 v112, 0
    v_mov_b32 v113, 0
    v_mov_b32 v114, 0
    v_mov_b32 v115, 0
    v_mov_b32 v116, 0
    v_mov_b32 v117, 0
    v_mov_b32 v118, 0
    v_mov_b32 v119, 0
    v_mov_b32 v120, 0
    v_mov_b32 v121, 0
    v_mov_b32 v122, 0
    v_mov_b32 v123, 0
    v_mov_b32 v124, 0
    v_mov_b32 v125, 0
    v_mov_b32 v126, 0
    v_mov_b32 v127, 0
    v_mov_b32 v128, 0
    v_mov_b32 v129, 0
    v_mov_b32 v130, 0
    v_mov_b32 v131, 0
    v_mov_b32 v132, 0
    v_mov_b32 v133, 0
    v_mov_b32 v134, 0
    v_mov_b32 v135, 0
    v_mov_b32 v136, 0
    v_mov_b32 v137, 0
    v_mov_b32 v138, 0
    v_mov_b32 v139, 0
    v_mov_b32 v140, 0
    v_mov_b32 v141, 0
    v_mov_b32 v142, 0
    v_mov_b32 v143, 0
    v_mov_b32 v144, 0
    v_mov_b32 v145, 0
    v_mov_b32 v146, 0
    v_mov_b32 v147, 0
    v_mov_b32 v148, 0
    v_mov_b32 v149, 0
    v_mov_b32 v150, 0
    v_mov_b32 v151, 0
    s_waitcnt vmcnt(12)
    v_and_b32 v168, 0xffff0000, v152
    v_lshlrev_b32 v169, 16, v152
    v_and_b32 v170, 0xffff0000, v153
    v_lshlrev_b32 v171, 16, v153
    v_and_b32 v172, 0xffff0000, v154
    v_lshlrev_b32 v173, 16, v154
    v_and_b32 v174, 0xffff0000, v155
    v_lshlrev_b32 v175, 16, v155
    v_and_b32 v176, 0xffff0000, v156
    v_lshlrev_b32 v177, 16, v156
    v_add_f32 v178, v168, v169
    v_mul_f32 v179, v168, v168
    v_fmac_f32 v179, v169, v169
    v_add_f32 v178, v178, v170
    v_fmac_f32 v179, v170, v170
    v_add_f32 v178, v178, v171
    v_fmac_f32 v179, v171, v171
    v_add_f32 v178, v178, v172
    v_fmac_f32 v179, v172, v172
    v_add_f32 v178, v178, v173
    v_fmac_f32 v179, v173, v173
    v_add_f32 v178, v178, v174
    v_fmac_f32 v179, v174, v174
    v_add_f32 v178, v178, v175
    v_fmac_f32 v179, v175, v175
    v_add_f32 v178, v178, v176
    v_fmac_f32 v179, v176, v176
    v_add_f32 v178, v178, v177
    v_fmac_f32 v179, v177, v177
    s_nop 1
    v_add_f32_dpp v178, v178, v178 row_shr:1 row_mask:0xf bank_mask:0xf bound_ctrl:0
    v_add_f32_dpp v179, v179, v179 row_shr:1 row_mask:0xf bank_mask:0xf bound_ctrl:0
    s_nop 1
    v_add_f32_dpp v178, v178, v178 row_shr:2 row_mask:0xf bank_mask:0xf bound_ctrl:0
    v_add_f32_dpp v179, v179, v179 row_shr:2 row_mask:0xf bank_mask:0xf bound_ctrl:0
    s_nop 1
    v_add_f32_dpp v178, v178, v178 row_shr:4 row_mask:0xf bank_mask:0xf bound_ctrl:0
    v_add_f32_dpp v179, v179, v179 row_shr:4 row_mask:0xf bank_mask:0xf bound_ctrl:0
    s_nop 1
    v_add_f32_dpp v178, v178, v178 row_shr:8 row_mask:0xf bank_mask:0xf bound_ctrl:0
    v_add_f32_dpp v179, v179, v179 row_shr:8 row_mask:0xf bank_mask:0xf bound_ctrl:0
    s_nop 1
    v_add_f32_dpp v178, v178, v178 row_bcast:15 row_mask:0xa bank_mask:0xf
    v_add_f32_dpp v179, v179, v179 row_bcast:15 row_mask:0xa bank_mask:0xf
    s_nop 1
    v_add_f32_dpp v178, v178, v178 row_bcast:31 row_mask:0xc bank_mask:0xf
    v_add_f32_dpp v179, v179, v179 row_bcast:31 row_mask:0xc bank_mask:0xf
    s_lshl_b32 s48, s20, 3
    v_mov_b32 v168, s48
    v_add_u32 v168, 151552, v168
    s_mov_b32 s48, 0
    s_mov_b32 s49, 0x80000000
    s_mov_b64 exec, s[48:49]
    ds_write_b64 v168, v[178:179]
    s_mov_b64 exec, -1
    v_lshlrev_b32 v168, 16, v158
    v_and_b32 v169, 0xffff0000, v158
    v_lshlrev_b32 v170, 16, v159
    v_and_b32 v171, 0xffff0000, v159
    v_pk_add_f32 v[168:169], v[168:169], v[170:171]
    v_lshlrev_b32 v170, 16, v160
    v_and_b32 v171, 0xffff0000, v160
    v_pk_add_f32 v[168:169], v[168:169], v[170:171]
    v_lshlrev_b32 v170, 16, v161
    v_and_b32 v171, 0xffff0000, v161
    v_pk_add_f32 v[168:169], v[168:169], v[170:171]
    v_lshlrev_b32 v170, 16, v162
    v_and_b32 v171, 0xffff0000, v162
    v_pk_add_f32 v[168:169], v[168:169], v[170:171]
    v_lshlrev_b32 v170, 16, v163
    v_and_b32 v171, 0xffff0000, v163
    v_pk_add_f32 v[168:169], v[168:169], v[170:171]
    v_lshlrev_b32 v170, 16, v164
    v_and_b32 v171, 0xffff0000, v164
    v_pk_add_f32 v[168:169], v[168:169], v[170:171]
    v_lshlrev_b32 v170, 16, v165
    v_and_b32 v171, 0xffff0000, v165
    v_pk_add_f32 v[168:169], v[168:169], v[170:171]
    v_lshlrev_b32 v170, 16, v166
    v_and_b32 v171, 0xffff0000, v166
    v_pk_add_f32 v[168:169], v[168:169], v[170:171]
    v_lshlrev_b32 v170, 16, v167
    v_and_b32 v171, 0xffff0000, v167
    v_pk_add_f32 v[168:169], v[168:169], v[170:171]
    s_lshl_b32 s48, s20, 9
    v_lshlrev_b32 v172, 3, v1
    v_add_u32 v172, 147456, v172
    v_add_u32 v173, s48, v172
    ds_write_b64 v173, v[168:169]
    s_waitcnt vmcnt(6) lgkmcnt(0)
    s_barrier
    ds_read_b128 v[48:51], v10
    ds_read_b64_tr_b16 v[56:57], v22 offset:0
    ds_read_b64_tr_b16 v[58:59], v22 offset:1024
    ds_read_b64_tr_b16 v[60:61], v23 offset:0
    ds_read_b64_tr_b16 v[62:63], v23 offset:1024
    ds_read_b64_tr_b16 v[64:65], v24 offset:0
    ds_read_b64_tr_b16 v[66:67], v24 offset:1024
    ds_read_b64_tr_b16 v[68:69], v25 offset:0
    ds_read_b64_tr_b16 v[70:71], v25 offset:1024
    s_cmp_lg_u32 s20, 0
    s_cbranch_scc1 p1_kernel_QK_np
    v_lshlrev_b32 v168, 3, v1
    v_add_u32 v169, 147456, v168
    ds_read_b64 v[210:211], v169 offset:0
    ds_read_b64 v[212:213], v169 offset:512
    ds_read_b64 v[214:215], v169 offset:1024
    ds_read_b64 v[216:217], v169 offset:1536
    ds_read_b64 v[218:219], v169 offset:2048
    ds_read_b64 v[220:221], v169 offset:2560
    ds_read_b64 v[222:223], v169 offset:3072
    ds_read_b64 v[224:225], v169 offset:3584
    s_waitcnt lgkmcnt(0)
    v_pk_add_f32 v[210:211], v[210:211], v[212:213]
    v_pk_add_f32 v[210:211], v[210:211], v[214:215]
    v_pk_add_f32 v[210:211], v[210:211], v[216:217]
    v_pk_add_f32 v[210:211], v[210:211], v[218:219]
    v_pk_add_f32 v[210:211], v[210:211], v[220:221]
    v_pk_add_f32 v[210:211], v[210:211], v[222:223]
    v_pk_add_f32 v[210:211], v[210:211], v[224:225]
    s_lshl_b32 s48, s22, 3
    s_add_u32 s48, s48, s21
    s_lshl_b32 s48, s48, 9
    s_add_u32 s48, s48, 24182784
    buffer_store_dwordx2 v[210:211], v168, s[12:15], s48 offen sc0 sc1
    v_lshlrev_b32 v168, 3, v1
    v_add_u32 v169, 151552, v168
    s_mov_b64 exec, 0xff
    ds_read_b64 v[170:171], v169
    s_lshl_b32 s48, s21, 11
    s_lshl_b32 s49, s22, 6
    s_add_u32 s48, s48, s49
    s_add_u32 s48, s48, 24117248
    s_waitcnt lgkmcnt(0)
    buffer_store_dwordx2 v[170:171], v168, s[12:15], s48 offen sc0 sc1
    s_mov_b64 exec, -1
p1_kernel_QK_np:
    s_waitcnt lgkmcnt(6)
    s_add_u32 m0, s27, 98304
    v_mfma_f32_32x32x16_bf16 v[88:103], v[56:59], v[48:51], v[88:103]
    ds_read_b128 v[52:55], v11
    ds_read_b64_tr_b16 v[72:73], v22 offset:4096
    ds_read_b64_tr_b16 v[74:75], v22 offset:5120
    buffer_load_dwordx4 v4, s[4:7], s24 offen lds
    s_waitcnt lgkmcnt(7)
    v_mfma_f32_32x32x16_bf16 v[104:119], v[60:63], v[48:51], v[104:119]
    ds_read_b64_tr_b16 v[76:77], v23 offset:4096
    ds_read_b64_tr_b16 v[78:79], v23 offset:5120
    s_waitcnt lgkmcnt(7)
    s_add_u32 m0, s27, 99328
    v_mfma_f32_32x32x16_bf16 v[120:135], v[64:67], v[48:51], v[120:135]
    ds_read_b64_tr_b16 v[80:81], v24 offset:4096
    ds_read_b64_tr_b16 v[82:83], v24 offset:5120
    buffer_load_dwordx4 v5, s[4:7], s24 offen lds
    s_waitcnt lgkmcnt(7)
    v_mfma_f32_32x32x16_bf16 v[136:151], v[68:71], v[48:51], v[136:151]
    ds_read_b64_tr_b16 v[84:85], v25 offset:4096
    ds_read_b64_tr_b16 v[86:87], v25 offset:5120
    s_waitcnt lgkmcnt(6)
    s_add_u32 m0, s27, 100352
    v_mfma_f32_32x32x16_bf16 v[88:103], v[72:75], v[52:55], v[88:103]
    ds_read_b128 v[48:51], v12
    ds_read_b64_tr_b16 v[56:57], v22 offset:8192
    ds_read_b64_tr_b16 v[58:59], v22 offset:9216
    buffer_load_dwordx4 v6, s[4:7], s24 offen lds
    s_waitcnt lgkmcnt(7)
    v_mfma_f32_32x32x16_bf16 v[104:119], v[76:79], v[52:55], v[104:119]
    ds_read_b64_tr_b16 v[60:61], v23 offset:8192
    ds_read_b64_tr_b16 v[62:63], v23 offset:9216
    s_waitcnt lgkmcnt(7)
    s_add_u32 m0, s27, 101376
    v_mfma_f32_32x32x16_bf16 v[120:135], v[80:83], v[52:55], v[120:135]
    ds_read_b64_tr_b16 v[64:65], v24 offset:8192
    ds_read_b64_tr_b16 v[66:67], v24 offset:9216
    buffer_load_dwordx4 v7, s[4:7], s24 offen lds
    s_add_u32 s24, s24, 128
    s_cmp_eq_u32 s55, 7
    s_cselect_b32 s56, 1280, 0
    s_sub_u32 s24, s24, s56
    s_waitcnt lgkmcnt(7)
    v_mfma_f32_32x32x16_bf16 v[136:151], v[84:87], v[52:55], v[136:151]
    ds_read_b64_tr_b16 v[68:69], v25 offset:8192
    ds_read_b64_tr_b16 v[70:71], v25 offset:9216
    s_waitcnt lgkmcnt(6)
    s_add_u32 m0, s28, 98304
    v_mfma_f32_32x32x16_bf16 v[88:103], v[56:59], v[48:51], v[88:103]
    ds_read_b128 v[52:55], v13
    ds_read_b64_tr_b16 v[72:73], v22 offset:12288
    ds_read_b64_tr_b16 v[74:75], v22 offset:13312
    buffer_load_dwordx4 v8, s[8:11], s25 offen lds
    s_waitcnt lgkmcnt(7)
    v_mfma_f32_32x32x16_bf16 v[104:119], v[60:63], v[48:51], v[104:119]
    ds_read_b64_tr_b16 v[76:77], v23 offset:12288
    ds_read_b64_tr_b16 v[78:79], v23 offset:13312
    s_waitcnt lgkmcnt(7)
    s_add_u32 m0, s28, 99328
    v_mfma_f32_32x32x16_bf16 v[120:135], v[64:67], v[48:51], v[120:135]
    ds_read_b64_tr_b16 v[80:81], v24 offset:12288
    ds_read_b64_tr_b16 v[82:83], v24 offset:13312
    buffer_load_dwordx4 v9, s[8:11], s25 offen lds
    s_add_u32 s25, s25, 245760
    s_cmp_eq_u32 s55, 7
    s_cselect_b32 s56, 2457600, 0
    s_sub_u32 s25, s25, s56
    s_waitcnt lgkmcnt(7)
    v_mfma_f32_32x32x16_bf16 v[136:151], v[68:71], v[48:51], v[136:151]
    ds_read_b64_tr_b16 v[84:85], v25 offset:12288
    ds_read_b64_tr_b16 v[86:87], v25 offset:13312
    s_waitcnt lgkmcnt(6)
    v_mfma_f32_32x32x16_bf16 v[88:103], v[72:75], v[52:55], v[88:103]
    s_waitcnt vmcnt(6) lgkmcnt(0)
    s_cmp_lg_u32 s20, 0
    s_cbranch_scc1 p1_kernel_QK_ns
    s_mov_b64 exec, 1
    v_mov_b32 v168, 1
    v_mov_b32 v169, 0
    s_lshl_b32 s48, s21, 5
    s_add_u32 s48, s48, s22
    buffer_store_byte v168, v169, s[76:79], s48 offen sc0 sc1
    s_mov_b64 exec, -1
p1_kernel_QK_ns:
    s_barrier
    s_lshl_b32 s84, s2, 3
    s_add_u32 s84, s84, s20
    s_cmp_ge_u32 s84, 1920
    s_cselect_b32 s85, 1920, 0
    s_cselect_b32 s88, s82, s80
    s_cselect_b32 s89, s83, s81
    s_mov_b32 s90, 1966080
    s_mov_b32 s93, 27262976
    s_cselect_b32 s90, 819200, s90
    s_cselect_b32 s93, 30408704, s93
    s_cselect_b32 s94, 40, 96
    s_and_b32 s89, s89, 0xffff
    s_mov_b32 s91, 0x00020000
    s_sub_u32 s84, s84, s85
    s_mul_i32 s86, s84, 3277
    s_lshr_b32 s86, s86, 16
    s_mul_i32 s87, s86, 20
    s_sub_u32 s87, s84, s87
    s_mul_i32 s95, s87, 205
    s_lshr_b32 s95, s95, 10
    s_mul_i32 s96, s95, 5
    s_sub_u32 s96, s87, s96
    s_mul_i32 s95, s95, s94
    s_add_u32 s95, s95, s86
    s_mul_i32 s95, s95, 5
    s_add_u32 s95, s95, s96
    s_lshl_b32 s95, s95, 10
    s_add_u32 s92, s95, s93
    v_lshrrev_b32 v218, 2, v1
    s_mul_i32 s95, s86, 16
    s_cmp_eq_u32 s85, 0
    s_cbranch_scc1 p1_kernel_QK_tr0_rows
    s_cmp_ge_u32 s86, 32
    s_cbranch_scc1 p1_kernel_QK_tr0_tb
    s_mul_i32 s95, s86, 20
    v_lshrrev_b32 v219, 3, v218
    v_lshl_add_u32 v218, v219, 1, v218
    s_branch p1_kernel_QK_tr0_rows
p1_kernel_QK_tr0_tb:
    s_sub_u32 s95, s86, 32
    s_mul_i32 s95, s95, 80
    s_add_u32 s95, s95, 8
    v_lshrrev_b32 v219, 1, v218
    v_and_b32 v218, 1, v218
    v_mad_u32_u24 v218, v219, 10, v218
p1_kernel_QK_tr0_rows:
    s_mul_i32 s95, s95, 1280
    s_lshl_b32 s96, s87, 6
    s_add_u32 s95, s95, s96
    v_mul_u32_u24 v218, 1280, v218
    v_and_b32 v219, 3, v1
    v_lshl_add_u32 v218, v219, 4, v218
    s_lshl_b32 s96, s20, 10
    s_add_u32 m0, s96, 155136
    s_nop 0
    buffer_load_dwordx4 v218, s[88:91], s95 offen lds
p1_kernel_QK_tr0_end:
    s_add_u32 m0, s27, 0
    v_mfma_f32_32x32x16_bf16 v[104:119], v[76:79], v[52:55], v[104:119]
    ds_read_b128 v[48:51], v14
    ds_read_b64_tr_b16 v[56:57], v26 offset:0
    ds_read_b64_tr_b16 v[58:59], v26 offset:1024
    buffer_load_dwordx4 v4, s[4:7], s24 offen lds
    v_mfma_f32_32x32x16_bf16 v[120:135], v[80:83], v[52:55], v[120:135]
    ds_read_b64_tr_b16 v[60:61], v27 offset:0
    ds_read_b64_tr_b16 v[62:63], v27 offset:1024
    s_add_u32 m0, s27, 1024
    v_mfma_f32_32x32x16_bf16 v[136:151], v[84:87], v[52:55], v[136:151]
    ds_read_b64_tr_b16 v[64:65], v28 offset:0
    ds_read_b64_tr_b16 v[66:67], v28 offset:1024
    ds_read_b64_tr_b16 v[68:69], v29 offset:0
    ds_read_b64_tr_b16 v[70:71], v29 offset:1024
    buffer_load_dwordx4 v5, s[4:7], s24 offen lds
    s_waitcnt lgkmcnt(6)
    s_add_u32 m0, s27, 2048
    v_mfma_f32_32x32x16_bf16 v[88:103], v[56:59], v[48:51], v[88:103]
    ds_read_b128 v[52:55], v15
    ds_read_b64_tr_b16 v[72:73], v26 offset:4096
    ds_read_b64_tr_b16 v[74:75], v26 offset:5120
    buffer_load_dwordx4 v6, s[4:7], s24 offen lds
    s_waitcnt lgkmcnt(7)
    v_mfma_f32_32x32x16_bf16 v[104:119], v[60:63], v[48:51], v[104:119]
    ds_read_b64_tr_b16 v[76:77], v27 offset:4096
    ds_read_b64_tr_b16 v[78:79], v27 offset:5120
    s_waitcnt lgkmcnt(7)
    s_add_u32 m0, s27, 3072
    v_mfma_f32_32x32x16_bf16 v[120:135], v[64:67], v[48:51], v[120:135]
    ds_read_b64_tr_b16 v[80:81], v28 offset:4096
    ds_read_b64_tr_b16 v[82:83], v28 offset:5120
    buffer_load_dwordx4 v7, s[4:7], s24 offen lds
    s_add_u32 s24, s24, 128
    s_cmp_eq_u32 s55, 6
    s_cselect_b32 s56, 1280, 0
    s_sub_u32 s24, s24, s56
    s_waitcnt lgkmcnt(7)
    v_mfma_f32_32x32x16_bf16 v[136:151], v[68:71], v[48:51], v[136:151]
    ds_read_b64_tr_b16 v[84:85], v29 offset:4096
    ds_read_b64_tr_b16 v[86:87], v29 offset:5120
    s_waitcnt lgkmcnt(6)
    s_add_u32 m0, s28, 0
    v_mfma_f32_32x32x16_bf16 v[88:103], v[72:75], v[52:55], v[88:103]
    ds_read_b128 v[48:51], v16
    ds_read_b64_tr_b16 v[56:57], v26 offset:8192
    ds_read_b64_tr_b16 v[58:59], v26 offset:9216
    buffer_load_dwordx4 v8, s[8:11], s25 offen lds
    s_waitcnt lgkmcnt(7)
    v_mfma_f32_32x32x16_bf16 v[104:119], v[76:79], v[52:55], v[104:119]
    ds_read_b64_tr_b16 v[60:61], v27 offset:8192
    ds_read_b64_tr_b16 v[62:63], v27 offset:9216
    s_waitcnt lgkmcnt(7)
    s_add_u32 m0, s28, 1024
    v_mfma_f32_32x32x16_bf16 v[120:135], v[80:83], v[52:55], v[120:135]
    ds_read_b64_tr_b16 v[64:65], v28 offset:8192
    ds_read_b64_tr_b16 v[66:67], v28 offset:9216
    buffer_load_dwordx4 v9, s[8:11], s25 offen lds
    s_add_u32 s25, s25, 245760
    s_cmp_eq_u32 s55, 6
    s_cselect_b32 s56, 2457600, 0
    s_sub_u32 s25, s25, s56
    s_waitcnt lgkmcnt(7)
    v_mfma_f32_32x32x16_bf16 v[136:151], v[84:87], v[52:55], v[136:151]
    ds_read_b64_tr_b16 v[68:69], v29 offset:8192
    ds_read_b64_tr_b16 v[70:71], v29 offset:9216
    s_waitcnt lgkmcnt(6)
    v_mfma_f32_32x32x16_bf16 v[88:103], v[56:59], v[48:51], v[88:103]
    ds_read_b128 v[52:55], v17
    ds_read_b64_tr_b16 v[72:73], v26 offset:12288
    ds_read_b64_tr_b16 v[74:75], v26 offset:13312
    s_waitcnt lgkmcnt(7)
    v_mfma_f32_32x32x16_bf16 v[104:119], v[60:63], v[48:51], v[104:119]
    ds_read_b64_tr_b16 v[76:77], v27 offset:12288
    ds_read_b64_tr_b16 v[78:79], v27 offset:13312
    s_waitcnt lgkmcnt(7)
    v_mfma_f32_32x32x16_bf16 v[120:135], v[64:67], v[48:51], v[120:135]
    ds_read_b64_tr_b16 v[80:81], v28 offset:12288
    ds_read_b64_tr_b16 v[82:83], v28 offset:13312
    s_waitcnt lgkmcnt(7)
    v_mfma_f32_32x32x16_bf16 v[136:151], v[68:71], v[48:51], v[136:151]
    ds_read_b64_tr_b16 v[84:85], v29 offset:12288
    ds_read_b64_tr_b16 v[86:87], v29 offset:13312
    s_waitcnt lgkmcnt(6)
    v_mfma_f32_32x32x16_bf16 v[88:103], v[72:75], v[52:55], v[88:103]
    s_waitcnt vmcnt(6) lgkmcnt(0)
    s_cmp_eq_u32 s92, -1
    s_cbranch_scc1 p1_kernel_QK_tr0_fin
    v_bfe_u32 v218, v1, 2, 2
    v_lshl_add_u32 v218, v3, 3, v218
    v_lshlrev_b32 v218, 6, v218
    v_bfe_u32 v219, v1, 4, 1
    v_lshl_add_u32 v218, v219, 5, v218
    v_and_b32 v219, 3, v1
    v_lshl_add_u32 v218, v219, 3, v218
    s_lshl_b32 s96, s20, 10
    s_add_u32 s96, s96, 155136
    v_add_u32 v218, s96, v218
    ds_read_b64_tr_b16 v[220:221], v218
    ds_read_b64_tr_b16 v[222:223], v218 offset:256
    v_lshlrev_b32 v219, 4, v1
    s_waitcnt lgkmcnt(0)
    buffer_store_dwordx4 v[220:223], v219, s[12:15], s92 offen sc1
p1_kernel_QK_tr0_fin:
    s_barrier
    s_add_u32 m0, s27, 49152
    v_mfma_f32_32x32x16_bf16 v[104:119], v[76:79], v[52:55], v[104:119]
    ds_read_b128 v[48:51], v18
    ds_read_b64_tr_b16 v[56:57], v30 offset:0
    ds_read_b64_tr_b16 v[58:59], v30 offset:1024
    buffer_load_dwordx4 v4, s[4:7], s24 offen lds
    v_mfma_f32_32x32x16_bf16 v[120:135], v[80:83], v[52:55], v[120:135]
    ds_read_b64_tr_b16 v[60:61], v31 offset:0
    ds_read_b64_tr_b16 v[62:63], v31 offset:1024
    s_add_u32 m0, s27, 50176
    v_mfma_f32_32x32x16_bf16 v[136:151], v[84:87], v[52:55], v[136:151]
    ds_read_b64_tr_b16 v[64:65], v32 offset:0
    ds_read_b64_tr_b16 v[66:67], v32 offset:1024
    ds_read_b64_tr_b16 v[68:69], v33 offset:0
    ds_read_b64_tr_b16 v[70:71], v33 offset:1024
    buffer_load_dwordx4 v5, s[4:7], s24 offen lds
    s_waitcnt lgkmcnt(6)
    s_add_u32 m0, s27, 51200
    v_mfma_f32_32x32x16_bf16 v[88:103], v[56:59], v[48:51], v[88:103]
    ds_read_b128 v[52:55], v19
    ds_read_b64_tr_b16 v[72:73], v30 offset:4096
    ds_read_b64_tr_b16 v[74:75], v30 offset:5120
    buffer_load_dwordx4 v6, s[4:7], s24 offen lds
    s_waitcnt lgkmcnt(7)
    v_mfma_f32_32x32x16_bf16 v[104:119], v[60:63], v[48:51], v[104:119]
    ds_read_b64_tr_b16 v[76:77], v31 offset:4096
    ds_read_b64_tr_b16 v[78:79], v31 offset:5120
    s_waitcnt lgkmcnt(7)
    s_add_u32 m0, s27, 52224
    v_mfma_f32_32x32x16_bf16 v[120:135], v[64:67], v[48:51], v[120:135]
    ds_read_b64_tr_b16 v[80:81], v32 offset:4096
    ds_read_b64_tr_b16 v[82:83], v32 offset:5120
    buffer_load_dwordx4 v7, s[4:7], s24 offen lds
    s_add_u32 s24, s24, 128
    s_cmp_eq_u32 s55, 5
    s_cselect_b32 s56, 1280, 0
    s_sub_u32 s24, s24, s56
    s_waitcnt lgkmcnt(7)
    v_mfma_f32_32x32x16_bf16 v[136:151], v[68:71], v[48:51], v[136:151]
    ds_read_b64_tr_b16 v[84:85], v33 offset:4096
    ds_read_b64_tr_b16 v[86:87], v33 offset:5120
    s_waitcnt lgkmcnt(6)
    s_add_u32 m0, s28, 49152
    v_mfma_f32_32x32x16_bf16 v[88:103], v[72:75], v[52:55], v[88:103]
    ds_read_b128 v[48:51], v20
    ds_read_b64_tr_b16 v[56:57], v30 offset:8192
    ds_read_b64_tr_b16 v[58:59], v30 offset:9216
    buffer_load_dwordx4 v8, s[8:11], s25 offen lds
    s_waitcnt lgkmcnt(7)
    v_mfma_f32_32x32x16_bf16 v[104:119], v[76:79], v[52:55], v[104:119]
    ds_read_b64_tr_b16 v[60:61], v31 offset:8192
    ds_read_b64_tr_b16 v[62:63], v31 offset:9216
    s_waitcnt lgkmcnt(7)
    s_add_u32 m0, s28, 50176
    v_mfma_f32_32x32x16_bf16 v[120:135], v[80:83], v[52:55], v[120:135]
    ds_read_b64_tr_b16 v[64:65], v32 offset:8192
    ds_read_b64_tr_b16 v[66:67], v32 offset:9216
    buffer_load_dwordx4 v9, s[8:11], s25 offen lds
    s_add_u32 s25, s25, 245760
    s_cmp_eq_u32 s55, 5
    s_cselect_b32 s56, 2457600, 0
    s_sub_u32 s25, s25, s56
    s_waitcnt lgkmcnt(7)
    v_mfma_f32_32x32x16_bf16 v[136:151], v[84:87], v[52:55], v[136:151]
    ds_read_b64_tr_b16 v[68:69], v33 offset:8192
    ds_read_b64_tr_b16 v[70:71], v33 offset:9216
    s_waitcnt lgkmcnt(6)
    v_mfma_f32_32x32x16_bf16 v[88:103], v[56:59], v[48:51], v[88:103]
    ds_read_b128 v[52:55], v21
    ds_read_b64_tr_b16 v[72:73], v30 offset:12288
    ds_read_b64_tr_b16 v[74:75], v30 offset:13312
    s_waitcnt lgkmcnt(7)
    v_mfma_f32_32x32x16_bf16 v[104:119], v[60:63], v[48:51], v[104:119]
    ds_read_b64_tr_b16 v[76:77], v31 offset:12288
    ds_read_b64_tr_b16 v[78:79], v31 offset:13312
    s_waitcnt lgkmcnt(7)
    v_mfma_f32_32x32x16_bf16 v[120:135], v[64:67], v[48:51], v[120:135]
    ds_read_b64_tr_b16 v[80:81], v32 offset:12288
    ds_read_b64_tr_b16 v[82:83], v32 offset:13312
    s_waitcnt lgkmcnt(7)
    v_mfma_f32_32x32x16_bf16 v[136:151], v[68:71], v[48:51], v[136:151]
    ds_read_b64_tr_b16 v[84:85], v33 offset:12288
    ds_read_b64_tr_b16 v[86:87], v33 offset:13312
    s_waitcnt lgkmcnt(6)
    v_mfma_f32_32x32x16_bf16 v[88:103], v[72:75], v[52:55], v[88:103]
    s_waitcnt vmcnt(6) lgkmcnt(0)
    s_barrier
    s_lshl_b32 s84, s2, 3
    s_add_u32 s84, s84, s20
    s_mov_b32 s92, -1
    s_cmp_ge_u32 s84, 672
    s_cbranch_scc1 p1_kernel_QK_tr1_end
    s_add_u32 s84, s84, 2048
    s_cmp_ge_u32 s84, 1920
    s_cselect_b32 s85, 1920, 0
    s_cselect_b32 s88, s82, s80
    s_cselect_b32 s89, s83, s81
    s_mov_b32 s90, 1966080
    s_mov_b32 s93, 27262976
    s_cselect_b32 s90, 819200, s90
    s_cselect_b32 s93, 30408704, s93
    s_cselect_b32 s94, 40, 96
    s_and_b32 s89, s89, 0xffff
    s_mov_b32 s91, 0x00020000
    s_sub_u32 s84, s84, s85
    s_mul_i32 s86, s84, 3277
    s_lshr_b32 s86, s86, 16
    s_mul_i32 s87, s86, 20
    s_sub_u32 s87, s84, s87
    s_mul_i32 s95, s87, 205
    s_lshr_b32 s95, s95, 10
    s_mul_i32 s96, s95, 5
    s_sub_u32 s96, s87, s96
    s_mul_i32 s95, s95, s94
    s_add_u32 s95, s95, s86
    s_mul_i32 s95, s95, 5
    s_add_u32 s95, s95, s96
    s_lshl_b32 s95, s95, 10
    s_add_u32 s92, s95, s93
    v_lshrrev_b32 v218, 2, v1
    s_mul_i32 s95, s86, 16
    s_cmp_eq_u32 s85, 0
    s_cbranch_scc1 p1_kernel_QK_tr1_rows
    s_cmp_ge_u32 s86, 32
    s_cbranch_scc1 p1_kernel_QK_tr1_tb
    s_mul_i32 s95, s86, 20
    v_lshrrev_b32 v219, 3, v218
    v_lshl_add_u32 v218, v219, 1, v218
    s_branch p1_kernel_QK_tr1_rows
p1_kernel_QK_tr1_tb:
    s_sub_u32 s95, s86, 32
    s_mul_i32 s95, s95, 80
    s_add_u32 s95, s95, 8
    v_lshrrev_b32 v219, 1, v218
    v_and_b32 v218, 1, v218
    v_mad_u32_u24 v218, v219, 10, v218
p1_kernel_QK_tr1_rows:
    s_mul_i32 s95, s95, 1280
    s_lshl_b32 s96, s87, 6
    s_add_u32 s95, s95, s96
    v_mul_u32_u24 v218, 1280, v218
    v_and_b32 v219, 3, v1
    v_lshl_add_u32 v218, v219, 4, v218
    s_lshl_b32 s96, s20, 10
    s_add_u32 m0, s96, 155136
    s_nop 0
    buffer_load_dwordx4 v218, s[88:91], s95 offen lds
p1_kernel_QK_tr1_end:
    s_add_u32 m0, s27, 98304
    v_mfma_f32_32x32x16_bf16 v[104:119], v[76:79], v[52:55], v[104:119]
    ds_read_b128 v[48:51], v10
    ds_read_b64_tr_b16 v[56:57], v22 offset:0
    ds_read_b64_tr_b16 v[58:59], v22 offset:1024
    buffer_load_dwordx4 v4, s[4:7], s24 offen lds
    v_mfma_f32_32x32x16_bf16 v[120:135], v[80:83], v[52:55], v[120:135]
    ds_read_b64_tr_b16 v[60:61], v23 offset:0
    ds_read_b64_tr_b16 v[62:63], v23 offset:1024
    s_add_u32 m0, s27, 99328
    v_mfma_f32_32x32x16_bf16 v[136:151], v[84:87], v[52:55], v[136:151]
    ds_read_b64_tr_b16 v[64:65], v24 offset:0
    ds_read_b64_tr_b16 v[66:67], v24 offset:1024
    ds_read_b64_tr_b16 v[68:69], v25 offset:0
    ds_read_b64_tr_b16 v[70:71], v25 offset:1024
    buffer_load_dwordx4 v5, s[4:7], s24 offen lds
    s_waitcnt lgkmcnt(6)
    s_add_u32 m0, s27, 100352
    v_mfma_f32_32x32x16_bf16 v[88:103], v[56:59], v[48:51], v[88:103]
    ds_read_b128 v[52:55], v11
    ds_read_b64_tr_b16 v[72:73], v22 offset:4096
    ds_read_b64_tr_b16 v[74:75], v22 offset:5120
    buffer_load_dwordx4 v6, s[4:7], s24 offen lds
    s_waitcnt lgkmcnt(7)
    v_mfma_f32_32x32x16_bf16 v[104:119], v[60:63], v[48:51], v[104:119]
    ds_read_b64_tr_b16 v[76:77], v23 offset:4096
    ds_read_b64_tr_b16 v[78:79], v23 offset:5120
    s_waitcnt lgkmcnt(7)
    s_add_u32 m0, s27, 101376
    v_mfma_f32_32x32x16_bf16 v[120:135], v[64:67], v[48:51], v[120:135]
    ds_read_b64_tr_b16 v[80:81], v24 offset:4096
    ds_read_b64_tr_b16 v[82:83], v24 offset:5120
    buffer_load_dwordx4 v7, s[4:7], s24 offen lds
    s_add_u32 s24, s24, 128
    s_cmp_eq_u32 s55, 4
    s_cselect_b32 s56, 1280, 0
    s_sub_u32 s24, s24, s56
    s_waitcnt lgkmcnt(7)
    v_mfma_f32_32x32x16_bf16 v[136:151], v[68:71], v[48:51], v[136:151]
    ds_read_b64_tr_b16 v[84:85], v25 offset:4096
    ds_read_b64_tr_b16 v[86:87], v25 offset:5120
    s_waitcnt lgkmcnt(6)
    s_add_u32 m0, s28, 98304
    v_mfma_f32_32x32x16_bf16 v[88:103], v[72:75], v[52:55], v[88:103]
    ds_read_b128 v[48:51], v12
    ds_read_b64_tr_b16 v[56:57], v22 offset:8192
    ds_read_b64_tr_b16 v[58:59], v22 offset:9216
    buffer_load_dwordx4 v8, s[8:11], s25 offen lds
    s_waitcnt lgkmcnt(7)
    v_mfma_f32_32x32x16_bf16 v[104:119], v[76:79], v[52:55], v[104:119]
    ds_read_b64_tr_b16 v[60:61], v23 offset:8192
    ds_read_b64_tr_b16 v[62:63], v23 offset:9216
    s_waitcnt lgkmcnt(7)
    s_add_u32 m0, s28, 99328
    v_mfma_f32_32x32x16_bf16 v[120:135], v[80:83], v[52:55], v[120:135]
    ds_read_b64_tr_b16 v[64:65], v24 offset:8192
    ds_read_b64_tr_b16 v[66:67], v24 offset:9216
    buffer_load_dwordx4 v9, s[8:11], s25 offen lds
    s_add_u32 s25, s25, 245760
    s_cmp_eq_u32 s55, 4
    s_cselect_b32 s56, 2457600, 0
    s_sub_u32 s25, s25, s56
    s_waitcnt lgkmcnt(7)
    v_mfma_f32_32x32x16_bf16 v[136:151], v[84:87], v[52:55], v[136:151]
    ds_read_b64_tr_b16 v[68:69], v25 offset:8192
    ds_read_b64_tr_b16 v[70:71], v25 offset:9216
    s_waitcnt lgkmcnt(6)
    v_mfma_f32_32x32x16_bf16 v[88:103], v[56:59], v[48:51], v[88:103]
    ds_read_b128 v[52:55], v13
    ds_read_b64_tr_b16 v[72:73], v22 offset:12288
    ds_read_b64_tr_b16 v[74:75], v22 offset:13312
    s_waitcnt lgkmcnt(7)
    v_mfma_f32_32x32x16_bf16 v[104:119], v[60:63], v[48:51], v[104:119]
    ds_read_b64_tr_b16 v[76:77], v23 offset:12288
    ds_read_b64_tr_b16 v[78:79], v23 offset:13312
    s_waitcnt lgkmcnt(7)
    v_mfma_f32_32x32x16_bf16 v[120:135], v[64:67], v[48:51], v[120:135]
    ds_read_b64_tr_b16 v[80:81], v24 offset:12288
    ds_read_b64_tr_b16 v[82:83], v24 offset:13312
    s_waitcnt lgkmcnt(7)
    v_mfma_f32_32x32x16_bf16 v[136:151], v[68:71], v[48:51], v[136:151]
    ds_read_b64_tr_b16 v[84:85], v25 offset:12288
    ds_read_b64_tr_b16 v[86:87], v25 offset:13312
    s_waitcnt lgkmcnt(6)
    v_mfma_f32_32x32x16_bf16 v[88:103], v[72:75], v[52:55], v[88:103]
    s_waitcnt vmcnt(6) lgkmcnt(0)
    s_cmp_eq_u32 s92, -1
    s_cbranch_scc1 p1_kernel_QK_tr1_fin
    v_bfe_u32 v218, v1, 2, 2
    v_lshl_add_u32 v218, v3, 3, v218
    v_lshlrev_b32 v218, 6, v218
    v_bfe_u32 v219, v1, 4, 1
    v_lshl_add_u32 v218, v219, 5, v218
    v_and_b32 v219, 3, v1
    v_lshl_add_u32 v218, v219, 3, v218
    s_lshl_b32 s96, s20, 10
    s_add_u32 s96, s96, 155136
    v_add_u32 v218, s96, v218
    ds_read_b64_tr_b16 v[220:221], v218
    ds_read_b64_tr_b16 v[222:223], v218 offset:256
    v_lshlrev_b32 v219, 4, v1
    s_waitcnt lgkmcnt(0)
    buffer_store_dwordx4 v[220:223], v219, s[12:15], s92 offen sc1
p1_kernel_QK_tr1_fin:
    s_barrier
    s_add_u32 m0, s27, 0
    v_mfma_f32_32x32x16_bf16 v[104:119], v[76:79], v[52:55], v[104:119]
    ds_read_b128 v[48:51], v14
    ds_read_b64_tr_b16 v[56:57], v26 offset:0
    ds_read_b64_tr_b16 v[58:59], v26 offset:1024
    buffer_load_dwordx4 v4, s[4:7], s24 offen lds
    v_mfma_f32_32x32x16_bf16 v[120:135], v[80:83], v[52:55], v[120:135]
    ds_read_b64_tr_b16 v[60:61], v27 offset:0
    ds_read_b64_tr_b16 v[62:63], v27 offset:1024
    s_add_u32 m0, s27, 1024
    v_mfma_f32_32x32x16_bf16 v[136:151], v[84:87], v[52:55], v[136:151]
    ds_read_b64_tr_b16 v[64:65], v28 offset:0
    ds_read_b64_tr_b16 v[66:67], v28 offset:1024
    ds_read_b64_tr_b16 v[68:69], v29 offset:0
    ds_read_b64_tr_b16 v[70:71], v29 offset:1024
    buffer_load_dwordx4 v5, s[4:7], s24 offen lds
    s_waitcnt lgkmcnt(6)
    s_add_u32 m0, s27, 2048
    v_mfma_f32_32x32x16_bf16 v[88:103], v[56:59], v[48:51], v[88:103]
    ds_read_b128 v[52:55], v15
    ds_read_b64_tr_b16 v[72:73], v26 offset:4096
    ds_read_b64_tr_b16 v[74:75], v26 offset:5120
    buffer_load_dwordx4 v6, s[4:7], s24 offen lds
    s_waitcnt lgkmcnt(7)
    v_mfma_f32_32x32x16_bf16 v[104:119], v[60:63], v[48:51], v[104:119]
    ds_read_b64_tr_b16 v[76:77], v27 offset:4096
    ds_read_b64_tr_b16 v[78:79], v27 offset:5120
    s_waitcnt lgkmcnt(7)
    s_add_u32 m0, s27, 3072
    v_mfma_f32_32x32x16_bf16 v[120:135], v[64:67], v[48:51], v[120:135]
    ds_read_b64_tr_b16 v[80:81], v28 offset:4096
    ds_read_b64_tr_b16 v[82:83], v28 offset:5120
    buffer_load_dwordx4 v7, s[4:7], s24 offen lds
    s_add_u32 s24, s24, 128
    s_cmp_eq_u32 s55, 3
    s_cselect_b32 s56, 1280, 0
    s_sub_u32 s24, s24, s56
    s_waitcnt lgkmcnt(7)
    v_mfma_f32_32x32x16_bf16 v[136:151], v[68:71], v[48:51], v[136:151]
    ds_read_b64_tr_b16 v[84:85], v29 offset:4096
    ds_read_b64_tr_b16 v[86:87], v29 offset:5120
    s_waitcnt lgkmcnt(6)
    s_add_u32 m0, s28, 0
    v_mfma_f32_32x32x16_bf16 v[88:103], v[72:75], v[52:55], v[88:103]
    ds_read_b128 v[48:51], v16
    ds_read_b64_tr_b16 v[56:57], v26 offset:8192
    ds_read_b64_tr_b16 v[58:59], v26 offset:9216
    buffer_load_dwordx4 v8, s[8:11], s25 offen lds
    s_waitcnt lgkmcnt(7)
    v_mfma_f32_32x32x16_bf16 v[104:119], v[76:79], v[52:55], v[104:119]
    ds_read_b64_tr_b16 v[60:61], v27 offset:8192
    ds_read_b64_tr_b16 v[62:63], v27 offset:9216
    s_waitcnt lgkmcnt(7)
    s_add_u32 m0, s28, 1024
    v_mfma_f32_32x32x16_bf16 v[120:135], v[80:83], v[52:55], v[120:135]
    ds_read_b64_tr_b16 v[64:65], v28 offset:8192
    ds_read_b64_tr_b16 v[66:67], v28 offset:9216
    buffer_load_dwordx4 v9, s[8:11], s25 offen lds
    s_add_u32 s25, s25, 245760
    s_cmp_eq_u32 s55, 3
    s_cselect_b32 s56, 2457600, 0
    s_sub_u32 s25, s25, s56
    s_waitcnt lgkmcnt(7)
    v_mfma_f32_32x32x16_bf16 v[136:151], v[84:87], v[52:55], v[136:151]
    ds_read_b64_tr_b16 v[68:69], v29 offset:8192
    ds_read_b64_tr_b16 v[70:71], v29 offset:9216
    s_waitcnt lgkmcnt(6)
    v_mfma_f32_32x32x16_bf16 v[88:103], v[56:59], v[48:51], v[88:103]
    ds_read_b128 v[52:55], v17
    ds_read_b64_tr_b16 v[72:73], v26 offset:12288
    ds_read_b64_tr_b16 v[74:75], v26 offset:13312
    s_waitcnt lgkmcnt(7)
    v_mfma_f32_32x32x16_bf16 v[104:119], v[60:63], v[48:51], v[104:119]
    ds_read_b64_tr_b16 v[76:77], v27 offset:12288
    ds_read_b64_tr_b16 v[78:79], v27 offset:13312
    s_waitcnt lgkmcnt(7)
    v_mfma_f32_32x32x16_bf16 v[120:135], v[64:67], v[48:51], v[120:135]
    ds_read_b64_tr_b16 v[80:81], v28 offset:12288
    ds_read_b64_tr_b16 v[82:83], v28 offset:13312
    s_waitcnt lgkmcnt(7)
    v_mfma_f32_32x32x16_bf16 v[136:151], v[68:71], v[48:51], v[136:151]
    ds_read_b64_tr_b16 v[84:85], v29 offset:12288
    ds_read_b64_tr_b16 v[86:87], v29 offset:13312
    s_waitcnt lgkmcnt(6)
    v_mfma_f32_32x32x16_bf16 v[88:103], v[72:75], v[52:55], v[88:103]
    s_waitcnt vmcnt(6) lgkmcnt(0)
    s_barrier
    v_mov_b32 v218, -1
    v_mov_b32 v219, -1
    v_mov_b32 v220, -1
    v_mov_b32 v221, -1
    s_mul_i32 s48, s2, 10240
    s_add_u32 s48, s48, 16777216
    s_add_u32 s49, s48, 8192
    v_lshlrev_b32 v222, 4, v0
    v_lshlrev_b32 v223, 2, v0
    buffer_store_dwordx4 v[218:221], v222, s[12:15], s48 offen sc1
    buffer_store_dword v218, v223, s[12:15], s49 offen sc1
    s_add_u32 m0, s27, 49152
    v_mfma_f32_32x32x16_bf16 v[104:119], v[76:79], v[52:55], v[104:119]
    ds_read_b128 v[48:51], v18
    ds_read_b64_tr_b16 v[56:57], v30 offset:0
    ds_read_b64_tr_b16 v[58:59], v30 offset:1024
    buffer_load_dwordx4 v4, s[4:7], s24 offen lds
    v_mfma_f32_32x32x16_bf16 v[120:135], v[80:83], v[52:55], v[120:135]
    ds_read_b64_tr_b16 v[60:61], v31 offset:0
    ds_read_b64_tr_b16 v[62:63], v31 offset:1024
    s_add_u32 m0, s27, 50176
    v_mfma_f32_32x32x16_bf16 v[136:151], v[84:87], v[52:55], v[136:151]
    ds_read_b64_tr_b16 v[64:65], v32 offset:0
    ds_read_b64_tr_b16 v[66:67], v32 offset:1024
    ds_read_b64_tr_b16 v[68:69], v33 offset:0
    ds_read_b64_tr_b16 v[70:71], v33 offset:1024
    buffer_load_dwordx4 v5, s[4:7], s24 offen lds
    s_waitcnt lgkmcnt(6)
    s_add_u32 m0, s27, 51200
    v_mfma_f32_32x32x16_bf16 v[88:103], v[56:59], v[48:51], v[88:103]
    ds_read_b128 v[52:55], v19
    ds_read_b64_tr_b16 v[72:73], v30 offset:4096
    ds_read_b64_tr_b16 v[74:75], v30 offset:5120
    buffer_load_dwordx4 v6, s[4:7], s24 offen lds
    s_waitcnt lgkmcnt(7)
    v_mfma_f32_32x32x16_bf16 v[104:119], v[60:63], v[48:51], v[104:119]
    ds_read_b64_tr_b16 v[76:77], v31 offset:4096
    ds_read_b64_tr_b16 v[78:79], v31 offset:5120
    s_waitcnt lgkmcnt(7)
    s_add_u32 m0, s27, 52224
    v_mfma_f32_32x32x16_bf16 v[120:135], v[64:67], v[48:51], v[120:135]
    ds_read_b64_tr_b16 v[80:81], v32 offset:4096
    ds_read_b64_tr_b16 v[82:83], v32 offset:5120
    buffer_load_dwordx4 v7, s[4:7], s24 offen lds
    s_add_u32 s24, s24, 128
    s_cmp_eq_u32 s55, 2
    s_cselect_b32 s56, 1280, 0
    s_sub_u32 s24, s24, s56
    s_waitcnt lgkmcnt(7)
    v_mfma_f32_32x32x16_bf16 v[136:151], v[68:71], v[48:51], v[136:151]
    ds_read_b64_tr_b16 v[84:85], v33 offset:4096
    ds_read_b64_tr_b16 v[86:87], v33 offset:5120
    s_waitcnt lgkmcnt(6)
    s_add_u32 m0, s28, 49152
    v_mfma_f32_32x32x16_bf16 v[88:103], v[72:75], v[52:55], v[88:103]
    ds_read_b128 v[48:51], v20
    ds_read_b64_tr_b16 v[56:57], v30 offset:8192
    ds_read_b64_tr_b16 v[58:59], v30 offset:9216
    buffer_load_dwordx4 v8, s[8:11], s25 offen lds
    s_waitcnt lgkmcnt(7)
    v_mfma_f32_32x32x16_bf16 v[104:119], v[76:79], v[52:55], v[104:119]
    ds_read_b64_tr_b16 v[60:61], v31 offset:8192
    ds_read_b64_tr_b16 v[62:63], v31 offset:9216
    s_waitcnt lgkmcnt(7)
    s_add_u32 m0, s28, 50176
    v_mfma_f32_32x32x16_bf16 v[120:135], v[80:83], v[52:55], v[120:135]
    ds_read_b64_tr_b16 v[64:65], v32 offset:8192
    ds_read_b64_tr_b16 v[66:67], v32 offset:9216
    buffer_load_dwordx4 v9, s[8:11], s25 offen lds
    s_add_u32 s25, s25, 245760
    s_cmp_eq_u32 s55, 2
    s_cselect_b32 s56, 2457600, 0
    s_sub_u32 s25, s25, s56
    s_waitcnt lgkmcnt(7)
    v_mfma_f32_32x32x16_bf16 v[136:151], v[84:87], v[52:55], v[136:151]
    ds_read_b64_tr_b16 v[68:69], v33 offset:8192
    ds_read_b64_tr_b16 v[70:71], v33 offset:9216
    s_waitcnt lgkmcnt(6)
    v_mfma_f32_32x32x16_bf16 v[88:103], v[56:59], v[48:51], v[88:103]
    ds_read_b128 v[52:55], v21
    ds_read_b64_tr_b16 v[72:73], v30 offset:12288
    ds_read_b64_tr_b16 v[74:75], v30 offset:13312
    s_waitcnt lgkmcnt(7)
    v_mfma_f32_32x32x16_bf16 v[104:119], v[60:63], v[48:51], v[104:119]
    ds_read_b64_tr_b16 v[76:77], v31 offset:12288
    ds_read_b64_tr_b16 v[78:79], v31 offset:13312
    s_waitcnt lgkmcnt(7)
    v_mfma_f32_32x32x16_bf16 v[120:135], v[64:67], v[48:51], v[120:135]
    ds_read_b64_tr_b16 v[80:81], v32 offset:12288
    ds_read_b64_tr_b16 v[82:83], v32 offset:13312
    s_waitcnt lgkmcnt(7)
    v_mfma_f32_32x32x16_bf16 v[136:151], v[68:71], v[48:51], v[136:151]
    ds_read_b64_tr_b16 v[84:85], v33 offset:12288
    ds_read_b64_tr_b16 v[86:87], v33 offset:13312
    s_waitcnt lgkmcnt(6)
    v_mfma_f32_32x32x16_bf16 v[88:103], v[72:75], v[52:55], v[88:103]
    s_waitcnt vmcnt(6) lgkmcnt(0)
    s_barrier
    s_cmp_lg_u32 s20, 0
    s_cbranch_scc1 p1_kernel_QK_nq
    v_lshlrev_b32 v170, 2, v1
    v_lshrrev_b32 v171, 3, v1
    v_cmp_eq_u32 vcc, s21, v171
    v_mov_b32 v173, 0x01010101
    v_and_b32 v171, 7, v1
    v_cndmask_b32 v172, 0, v173, vcc
    s_lshr_b32 s48, s22, 2
    s_and_b32 s49, s22, 3
    s_lshl_b32 s49, s49, 3
    s_lshl_b32 s49, 1, s49
    v_cmp_eq_u32 vcc, s48, v171
    v_mov_b32 v173, s49
    s_nop 0
    v_cndmask_b32 v173, 0, v173, vcc
    v_or_b32 v172, v172, v173
    buffer_load_dword v169, v170, s[76:79], 0 offen sc0 sc1
p1_kernel_QK_nq:
    s_add_u32 m0, s27, 98304
    v_mfma_f32_32x32x16_bf16 v[104:119], v[76:79], v[52:55], v[104:119]
    ds_read_b128 v[48:51], v10
    ds_read_b64_tr_b16 v[56:57], v22 offset:0
    ds_read_b64_tr_b16 v[58:59], v22 offset:1024
    buffer_load_dwordx4 v4, s[4:7], s24 offen lds
    v_mfma_f32_32x32x16_bf16 v[120:135], v[80:83], v[52:55], v[120:135]
    ds_read_b64_tr_b16 v[60:61], v23 offset:0
    ds_read_b64_tr_b16 v[62:63], v23 offset:1024
    s_add_u32 m0, s27, 99328
    v_mfma_f32_32x32x16_bf16 v[136:151], v[84:87], v[52:55], v[136:151]
    ds_read_b64_tr_b16 v[64:65], v24 offset:0
    ds_read_b64_tr_b16 v[66:67], v24 offset:1024
    ds_read_b64_tr_b16 v[68:69], v25 offset:0
    ds_read_b64_tr_b16 v[70:71], v25 offset:1024
    buffer_load_dwordx4 v5, s[4:7], s24 offen lds
    s_waitcnt lgkmcnt(6)
    s_add_u32 m0, s27, 100352
    v_mfma_f32_32x32x16_bf16 v[88:103], v[56:59], v[48:51], v[88:103]
    ds_read_b128 v[52:55], v11
    ds_read_b64_tr_b16 v[72:73], v22 offset:4096
    ds_read_b64_tr_b16 v[74:75], v22 offset:5120
    buffer_load_dwordx4 v6, s[4:7], s24 offen lds
    s_waitcnt lgkmcnt(7)
    v_mfma_f32_32x32x16_bf16 v[104:119], v[60:63], v[48:51], v[104:119]
    ds_read_b64_tr_b16 v[76:77], v23 offset:4096
    ds_read_b64_tr_b16 v[78:79], v23 offset:5120
    s_waitcnt lgkmcnt(7)
    s_add_u32 m0, s27, 101376
    v_mfma_f32_32x32x16_bf16 v[120:135], v[64:67], v[48:51], v[120:135]
    ds_read_b64_tr_b16 v[80:81], v24 offset:4096
    ds_read_b64_tr_b16 v[82:83], v24 offset:5120
    buffer_load_dwordx4 v7, s[4:7], s24 offen lds
    s_add_u32 s24, s24, 128
    s_cmp_eq_u32 s55, 1
    s_cselect_b32 s56, 1280, 0
    s_sub_u32 s24, s24, s56
    s_waitcnt lgkmcnt(7)
    v_mfma_f32_32x32x16_bf16 v[136:151], v[68:71], v[48:51], v[136:151]
    ds_read_b64_tr_b16 v[84:85], v25 offset:4096
    ds_read_b64_tr_b16 v[86:87], v25 offset:5120
    s_waitcnt lgkmcnt(6)
    s_add_u32 m0, s28, 98304
    v_mfma_f32_32x32x16_bf16 v[88:103], v[72:75], v[52:55], v[88:103]
    ds_read_b128 v[48:51], v12
    ds_read_b64_tr_b16 v[56:57], v22 offset:8192
    ds_read_b64_tr_b16 v[58:59], v22 offset:9216
    buffer_load_dwordx4 v8, s[8:11], s25 offen lds
    s_waitcnt lgkmcnt(7)
    v_mfma_f32_32x32x16_bf16 v[104:119], v[76:79], v[52:55], v[104:119]
    ds_read_b64_tr_b16 v[60:61], v23 offset:8192
    ds_read_b64_tr_b16 v[62:63], v23 offset:9216
    s_waitcnt lgkmcnt(7)
    s_add_u32 m0, s28, 99328
    v_mfma_f32_32x32x16_bf16 v[120:135], v[80:83], v[52:55], v[120:135]
    ds_read_b64_tr_b16 v[64:65], v24 offset:8192
    ds_read_b64_tr_b16 v[66:67], v24 offset:9216
    buffer_load_dwordx4 v9, s[8:11], s25 offen lds
    s_add_u32 s25, s25, 245760
    s_cmp_eq_u32 s55, 1
    s_cselect_b32 s56, 2457600, 0
    s_sub_u32 s25, s25, s56
    s_waitcnt lgkmcnt(7)
    v_mfma_f32_32x32x16_bf16 v[136:151], v[84:87], v[52:55], v[136:151]
    ds_read_b64_tr_b16 v[68:69], v25 offset:8192
    ds_read_b64_tr_b16 v[70:71], v25 offset:9216
    s_waitcnt lgkmcnt(6)
    v_mfma_f32_32x32x16_bf16 v[88:103], v[56:59], v[48:51], v[88:103]
    ds_read_b128 v[52:55], v13
    ds_read_b64_tr_b16 v[72:73], v22 offset:12288
    ds_read_b64_tr_b16 v[74:75], v22 offset:13312
    s_waitcnt lgkmcnt(7)
    v_mfma_f32_32x32x16_bf16 v[104:119], v[60:63], v[48:51], v[104:119]
    ds_read_b64_tr_b16 v[76:77], v23 offset:12288
    ds_read_b64_tr_b16 v[78:79], v23 offset:13312
    s_waitcnt lgkmcnt(7)
    v_mfma_f32_32x32x16_bf16 v[120:135], v[64:67], v[48:51], v[120:135]
    ds_read_b64_tr_b16 v[80:81], v24 offset:12288
    ds_read_b64_tr_b16 v[82:83], v24 offset:13312
    s_waitcnt lgkmcnt(7)
    v_mfma_f32_32x32x16_bf16 v[136:151], v[68:71], v[48:51], v[136:151]
    ds_read_b64_tr_b16 v[84:85], v25 offset:12288
    ds_read_b64_tr_b16 v[86:87], v25 offset:13312
    s_waitcnt lgkmcnt(6)
    v_mfma_f32_32x32x16_bf16 v[88:103], v[72:75], v[52:55], v[88:103]
    s_waitcnt vmcnt(6) lgkmcnt(0)
    s_cmp_lg_u32 s20, 0
    s_cbranch_scc1 p1_kernel_QK_pd
    s_mov_b32 s54, 0
p1_kernel_QK_pl:
    v_and_b32 v169, v169, v172
    v_cmp_eq_u32 vcc, v169, v172
    s_add_u32 s54, s54, 1
    s_nop 0
    s_cmp_eq_u64 vcc, -1
    s_cbranch_scc1 p1_kernel_QK_pd
    s_cmp_gt_u32 s54, 0x40000
    s_cbranch_scc1 p1_kernel_QK_pd
    buffer_load_dword v169, v170, s[76:79], 0 offen sc0 sc1
    s_waitcnt vmcnt(0)
    s_branch p1_kernel_QK_pl
p1_kernel_QK_pd:
    s_barrier
    s_lshl_b32 s48, s34, 3
    s_add_u32 s48, s48, 24117248
    v_lshlrev_b32 v168, 3, v2
    buffer_load_dwordx2 v[208:209], v168, s[12:15], s48 offen sc0 sc1
    s_cmp_lg_u32 s20, 1
    s_cbranch_scc1 p1_kernel_QK_nf
    s_lshl_b32 s48, s22, 12
    s_add_u32 s48, s48, 24182784
    v_lshlrev_b32 v171, 3, v1
    buffer_load_dwordx2 v[210:211], v171, s[12:15], s48 offen offset:0 sc0 sc1
    buffer_load_dwordx2 v[212:213], v171, s[12:15], s48 offen offset:512 sc0 sc1
    buffer_load_dwordx2 v[214:215], v171, s[12:15], s48 offen offset:1024 sc0 sc1
    buffer_load_dwordx2 v[216:217], v171, s[12:15], s48 offen offset:1536 sc0 sc1
    buffer_load_dwordx2 v[218:219], v171, s[12:15], s48 offen offset:2048 sc0 sc1
    buffer_load_dwordx2 v[220:221], v171, s[12:15], s48 offen offset:2560 sc0 sc1
    buffer_load_dwordx2 v[222:223], v171, s[12:15], s48 offen offset:3072 sc0 sc1
    buffer_load_dwordx2 v[224:225], v171, s[12:15], s48 offen offset:3584 sc0 sc1
p1_kernel_QK_nf:
    s_add_u32 m0, s27, 0
    v_mfma_f32_32x32x16_bf16 v[104:119], v[76:79], v[52:55], v[104:119]
    ds_read_b128 v[48:51], v14
    ds_read_b64_tr_b16 v[56:57], v26 offset:0
    ds_read_b64_tr_b16 v[58:59], v26 offset:1024
    buffer_load_dwordx4 v4, s[4:7], s24 offen lds
    v_mfma_f32_32x32x16_bf16 v[120:135], v[80:83], v[52:55], v[120:135]
    ds_read_b64_tr_b16 v[60:61], v27 offset:0
    ds_read_b64_tr_b16 v[62:63], v27 offset:1024
    s_add_u32 m0, s27, 1024
    v_mfma_f32_32x32x16_bf16 v[136:151], v[84:87], v[52:55], v[136:151]
    ds_read_b64_tr_b16 v[64:65], v28 offset:0
    ds_read_b64_tr_b16 v[66:67], v28 offset:1024
    ds_read_b64_tr_b16 v[68:69], v29 offset:0
    ds_read_b64_tr_b16 v[70:71], v29 offset:1024
    buffer_load_dwordx4 v5, s[4:7], s24 offen lds
    s_waitcnt lgkmcnt(6)
    s_add_u32 m0, s27, 2048
    v_mfma_f32_32x32x16_bf16 v[88:103], v[56:59], v[48:51], v[88:103]
    ds_read_b128 v[52:55], v15
    ds_read_b64_tr_b16 v[72:73], v26 offset:4096
    ds_read_b64_tr_b16 v[74:75], v26 offset:5120
    buffer_load_dwordx4 v6, s[4:7], s24 offen lds
    s_waitcnt lgkmcnt(7)
    v_mfma_f32_32x32x16_bf16 v[104:119], v[60:63], v[48:51], v[104:119]
    ds_read_b64_tr_b16 v[76:77], v27 offset:4096
    ds_read_b64_tr_b16 v[78:79], v27 offset:5120
    s_waitcnt lgkmcnt(7)
    s_add_u32 m0, s27, 3072
    v_mfma_f32_32x32x16_bf16 v[120:135], v[64:67], v[48:51], v[120:135]
    ds_read_b64_tr_b16 v[80:81], v28 offset:4096
    ds_read_b64_tr_b16 v[82:83], v28 offset:5120
    buffer_load_dwordx4 v7, s[4:7], s24 offen lds
    s_add_u32 s24, s24, 128
    s_cmp_eq_u32 s55, 0
    s_cselect_b32 s56, 1280, 0
    s_sub_u32 s24, s24, s56
    s_waitcnt lgkmcnt(7)
    v_mfma_f32_32x32x16_bf16 v[136:151], v[68:71], v[48:51], v[136:151]
    ds_read_b64_tr_b16 v[84:85], v29 offset:4096
    ds_read_b64_tr_b16 v[86:87], v29 offset:5120
    s_waitcnt lgkmcnt(6)
    s_add_u32 m0, s28, 0
    v_mfma_f32_32x32x16_bf16 v[88:103], v[72:75], v[52:55], v[88:103]
    ds_read_b128 v[48:51], v16
    ds_read_b64_tr_b16 v[56:57], v26 offset:8192
    ds_read_b64_tr_b16 v[58:59], v26 offset:9216
    buffer_load_dwordx4 v8, s[8:11], s25 offen lds
    s_waitcnt lgkmcnt(7)
    v_mfma_f32_32x32x16_bf16 v[104:119], v[76:79], v[52:55], v[104:119]
    ds_read_b64_tr_b16 v[60:61], v27 offset:8192
    ds_read_b64_tr_b16 v[62:63], v27 offset:9216
    s_waitcnt lgkmcnt(7)
    s_add_u32 m0, s28, 1024
    v_mfma_f32_32x32x16_bf16 v[120:135], v[80:83], v[52:55], v[120:135]
    ds_read_b64_tr_b16 v[64:65], v28 offset:8192
    ds_read_b64_tr_b16 v[66:67], v28 offset:9216
    buffer_load_dwordx4 v9, s[8:11], s25 offen lds
    s_add_u32 s25, s25, 245760
    s_cmp_eq_u32 s55, 0
    s_cselect_b32 s56, 2457600, 0
    s_sub_u32 s25, s25, s56
    s_waitcnt lgkmcnt(7)
    v_mfma_f32_32x32x16_bf16 v[136:151], v[84:87], v[52:55], v[136:151]
    ds_read_b64_tr_b16 v[68:69], v29 offset:8192
    ds_read_b64_tr_b16 v[70:71], v29 offset:9216
    s_waitcnt lgkmcnt(6)
    v_mfma_f32_32x32x16_bf16 v[88:103], v[56:59], v[48:51], v[88:103]
    ds_read_b128 v[52:55], v17
    ds_read_b64_tr_b16 v[72:73], v26 offset:12288
    ds_read_b64_tr_b16 v[74:75], v26 offset:13312
    s_waitcnt lgkmcnt(7)
    v_mfma_f32_32x32x16_bf16 v[104:119], v[60:63], v[48:51], v[104:119]
    ds_read_b64_tr_b16 v[76:77], v27 offset:12288
    ds_read_b64_tr_b16 v[78:79], v27 offset:13312
    s_waitcnt lgkmcnt(7)
    v_mfma_f32_32x32x16_bf16 v[120:135], v[64:67], v[48:51], v[120:135]
    ds_read_b64_tr_b16 v[80:81], v28 offset:12288
    ds_read_b64_tr_b16 v[82:83], v28 offset:13312
    s_waitcnt lgkmcnt(7)
    v_mfma_f32_32x32x16_bf16 v[136:151], v[68:71], v[48:51], v[136:151]
    ds_read_b64_tr_b16 v[84:85], v29 offset:12288
    ds_read_b64_tr_b16 v[86:87], v29 offset:13312
    s_waitcnt lgkmcnt(6)
    v_mfma_f32_32x32x16_bf16 v[88:103], v[72:75], v[52:55], v[88:103]
    s_waitcnt vmcnt(6) lgkmcnt(0)
    s_barrier
    v_mfma_f32_32x32x16_bf16 v[104:119], v[76:79], v[52:55], v[104:119]
    ds_read_b128 v[48:51], v18
    ds_read_b64_tr_b16 v[56:57], v30 offset:0
    ds_read_b64_tr_b16 v[58:59], v30 offset:1024
    v_mfma_f32_32x32x16_bf16 v[120:135], v[80:83], v[52:55], v[120:135]
    ds_read_b64_tr_b16 v[60:61], v31 offset:0
    ds_read_b64_tr_b16 v[62:63], v31 offset:1024
    v_mfma_f32_32x32x16_bf16 v[136:151], v[84:87], v[52:55], v[136:151]
    ds_read_b64_tr_b16 v[64:65], v32 offset:0
    ds_read_b64_tr_b16 v[66:67], v32 offset:1024
    ds_read_b64_tr_b16 v[68:69], v33 offset:0
    ds_read_b64_tr_b16 v[70:71], v33 offset:1024
    s_waitcnt lgkmcnt(6)
    v_mfma_f32_32x32x16_bf16 v[88:103], v[56:59], v[48:51], v[88:103]
    ds_read_b128 v[52:55], v19
    ds_read_b64_tr_b16 v[72:73], v30 offset:4096
    ds_read_b64_tr_b16 v[74:75], v30 offset:5120
    s_waitcnt lgkmcnt(7)
    v_mfma_f32_32x32x16_bf16 v[104:119], v[60:63], v[48:51], v[104:119]
    ds_read_b64_tr_b16 v[76:77], v31 offset:4096
    ds_read_b64_tr_b16 v[78:79], v31 offset:5120
    s_waitcnt lgkmcnt(7)
    v_mfma_f32_32x32x16_bf16 v[120:135], v[64:67], v[48:51], v[120:135]
    ds_read_b64_tr_b16 v[80:81], v32 offset:4096
    ds_read_b64_tr_b16 v[82:83], v32 offset:5120
    s_waitcnt lgkmcnt(7)
    v_mfma_f32_32x32x16_bf16 v[136:151], v[68:71], v[48:51], v[136:151]
    ds_read_b64_tr_b16 v[84:85], v33 offset:4096
    ds_read_b64_tr_b16 v[86:87], v33 offset:5120
    s_waitcnt lgkmcnt(6)
    v_mfma_f32_32x32x16_bf16 v[88:103], v[72:75], v[52:55], v[88:103]
    ds_read_b128 v[48:51], v20
    ds_read_b64_tr_b16 v[56:57], v30 offset:8192
    ds_read_b64_tr_b16 v[58:59], v30 offset:9216
    s_waitcnt lgkmcnt(7)
    v_mfma_f32_32x32x16_bf16 v[104:119], v[76:79], v[52:55], v[104:119]
    ds_read_b64_tr_b16 v[60:61], v31 offset:8192
    ds_read_b64_tr_b16 v[62:63], v31 offset:9216
    s_waitcnt lgkmcnt(7)
    v_mfma_f32_32x32x16_bf16 v[120:135], v[80:83], v[52:55], v[120:135]
    ds_read_b64_tr_b16 v[64:65], v32 offset:8192
    ds_read_b64_tr_b16 v[66:67], v32 offset:9216
    s_waitcnt lgkmcnt(7)
    v_mfma_f32_32x32x16_bf16 v[136:151], v[84:87], v[52:55], v[136:151]
    ds_read_b64_tr_b16 v[68:69], v33 offset:8192
    ds_read_b64_tr_b16 v[70:71], v33 offset:9216
    s_waitcnt lgkmcnt(6)
    v_mfma_f32_32x32x16_bf16 v[88:103], v[56:59], v[48:51], v[88:103]
    ds_read_b128 v[52:55], v21
    ds_read_b64_tr_b16 v[72:73], v30 offset:12288
    ds_read_b64_tr_b16 v[74:75], v30 offset:13312
    s_waitcnt lgkmcnt(7)
    v_mfma_f32_32x32x16_bf16 v[104:119], v[60:63], v[48:51], v[104:119]
    ds_read_b64_tr_b16 v[76:77], v31 offset:12288
    ds_read_b64_tr_b16 v[78:79], v31 offset:13312
    s_waitcnt lgkmcnt(7)
    v_mfma_f32_32x32x16_bf16 v[120:135], v[64:67], v[48:51], v[120:135]
    ds_read_b64_tr_b16 v[80:81], v32 offset:12288
    ds_read_b64_tr_b16 v[82:83], v32 offset:13312
    s_waitcnt lgkmcnt(7)
    v_mfma_f32_32x32x16_bf16 v[136:151], v[68:71], v[48:51], v[136:151]
    ds_read_b64_tr_b16 v[84:85], v33 offset:12288
    ds_read_b64_tr_b16 v[86:87], v33 offset:13312
    s_waitcnt lgkmcnt(6)
    v_mfma_f32_32x32x16_bf16 v[88:103], v[72:75], v[52:55], v[88:103]
    s_waitcnt vmcnt(0) lgkmcnt(0)
    s_barrier
    v_mfma_f32_32x32x16_bf16 v[104:119], v[76:79], v[52:55], v[104:119]
    ds_read_b128 v[48:51], v10
    ds_read_b64_tr_b16 v[56:57], v22 offset:0
    ds_read_b64_tr_b16 v[58:59], v22 offset:1024
    v_mfma_f32_32x32x16_bf16 v[120:135], v[80:83], v[52:55], v[120:135]
    ds_read_b64_tr_b16 v[60:61], v23 offset:0
    ds_read_b64_tr_b16 v[62:63], v23 offset:1024
    v_mfma_f32_32x32x16_bf16 v[136:151], v[84:87], v[52:55], v[136:151]
    ds_read_b64_tr_b16 v[64:65], v24 offset:0
    ds_read_b64_tr_b16 v[66:67], v24 offset:1024
    ds_read_b64_tr_b16 v[68:69], v25 offset:0
    ds_read_b64_tr_b16 v[70:71], v25 offset:1024
    s_waitcnt lgkmcnt(6)
    v_mfma_f32_32x32x16_bf16 v[88:103], v[56:59], v[48:51], v[88:103]
    ds_read_b128 v[52:55], v11
    ds_read_b64_tr_b16 v[72:73], v22 offset:4096
    ds_read_b64_tr_b16 v[74:75], v22 offset:5120
    s_waitcnt lgkmcnt(7)
    v_mfma_f32_32x32x16_bf16 v[104:119], v[60:63], v[48:51], v[104:119]
    ds_read_b64_tr_b16 v[76:77], v23 offset:4096
    ds_read_b64_tr_b16 v[78:79], v23 offset:5120
    s_waitcnt lgkmcnt(7)
    v_mfma_f32_32x32x16_bf16 v[120:135], v[64:67], v[48:51], v[120:135]
    ds_read_b64_tr_b16 v[80:81], v24 offset:4096
    ds_read_b64_tr_b16 v[82:83], v24 offset:5120
    s_waitcnt lgkmcnt(7)
    v_mfma_f32_32x32x16_bf16 v[136:151], v[68:71], v[48:51], v[136:151]
    ds_read_b64_tr_b16 v[84:85], v25 offset:4096
    ds_read_b64_tr_b16 v[86:87], v25 offset:5120
    s_waitcnt lgkmcnt(6)
    v_mfma_f32_32x32x16_bf16 v[88:103], v[72:75], v[52:55], v[88:103]
    ds_read_b128 v[48:51], v12
    ds_read_b64_tr_b16 v[56:57], v22 offset:8192
    ds_read_b64_tr_b16 v[58:59], v22 offset:9216
    s_waitcnt lgkmcnt(7)
    v_mfma_f32_32x32x16_bf16 v[104:119], v[76:79], v[52:55], v[104:119]
    ds_read_b64_tr_b16 v[60:61], v23 offset:8192
    ds_read_b64_tr_b16 v[62:63], v23 offset:9216
    s_waitcnt lgkmcnt(7)
    v_mfma_f32_32x32x16_bf16 v[120:135], v[80:83], v[52:55], v[120:135]
    ds_read_b64_tr_b16 v[64:65], v24 offset:8192
    ds_read_b64_tr_b16 v[66:67], v24 offset:9216
    s_waitcnt lgkmcnt(7)
    v_mfma_f32_32x32x16_bf16 v[136:151], v[84:87], v[52:55], v[136:151]
    ds_read_b64_tr_b16 v[68:69], v25 offset:8192
    ds_read_b64_tr_b16 v[70:71], v25 offset:9216
    s_waitcnt lgkmcnt(6)
    v_mfma_f32_32x32x16_bf16 v[88:103], v[56:59], v[48:51], v[88:103]
    ds_read_b128 v[52:55], v13
    ds_read_b64_tr_b16 v[72:73], v22 offset:12288
    ds_read_b64_tr_b16 v[74:75], v22 offset:13312
    s_waitcnt lgkmcnt(7)
    v_mfma_f32_32x32x16_bf16 v[104:119], v[60:63], v[48:51], v[104:119]
    ds_read_b64_tr_b16 v[76:77], v23 offset:12288
    ds_read_b64_tr_b16 v[78:79], v23 offset:13312
    s_waitcnt lgkmcnt(7)
    v_mfma_f32_32x32x16_bf16 v[120:135], v[64:67], v[48:51], v[120:135]
    ds_read_b64_tr_b16 v[80:81], v24 offset:12288
    ds_read_b64_tr_b16 v[82:83], v24 offset:13312
    s_waitcnt lgkmcnt(7)
    v_mfma_f32_32x32x16_bf16 v[136:151], v[68:71], v[48:51], v[136:151]
    ds_read_b64_tr_b16 v[84:85], v25 offset:12288
    ds_read_b64_tr_b16 v[86:87], v25 offset:13312
    s_waitcnt lgkmcnt(6)
    v_mfma_f32_32x32x16_bf16 v[88:103], v[72:75], v[52:55], v[88:103]
    s_waitcnt lgkmcnt(4)
    v_mfma_f32_32x32x16_bf16 v[104:119], v[76:79], v[52:55], v[104:119]
    s_waitcnt lgkmcnt(2)
    v_mfma_f32_32x32x16_bf16 v[120:135], v[80:83], v[52:55], v[120:135]
    s_waitcnt lgkmcnt(0)
    v_mfma_f32_32x32x16_bf16 v[136:151], v[84:87], v[52:55], v[136:151]
    s_waitcnt vmcnt(0)
    s_cmp_lg_u32 s20, 1
    s_cbranch_scc1 p1_kernel_QK_nt
    v_pk_add_f32 v[210:211], v[210:211], v[212:213]
    v_pk_add_f32 v[210:211], v[210:211], v[214:215]
    v_pk_add_f32 v[210:211], v[210:211], v[216:217]
    v_pk_add_f32 v[210:211], v[210:211], v[218:219]
    v_pk_add_f32 v[210:211], v[210:211], v[220:221]
    v_pk_add_f32 v[210:211], v[210:211], v[222:223]
    v_pk_add_f32 v[210:211], v[210:211], v[224:225]
    v_add_u32 v171, 152064, v171
    ds_write_b64 v171, v[210:211]
p1_kernel_QK_nt:
    v_mul_f32 v208, 0x3acccccd, v208
    v_mul_f32 v209, 0x3acccccd, v209
    v_fma_f32 v209, -v208, v208, v209
    v_max_f32 v209, 0, v209
    v_add_f32 v35, 0x3727c5ac, v209
    v_rsq_f32 v42, v35
    s_nop 0
    s_cmp_lt_u32 s22, 5
    s_cselect_b32 s48, 0x3ea52b5c, 1.0
    v_mul_f32 v42, s48, v42
    v_mul_f32 v44, v208, v42
    v_sub_f32 v44, 0, v44
    v_mov_b32 v43, v42
    v_mov_b32 v45, v44
    s_cmp_lt_u32 s22, 5
    s_cselect_b32 s49, 0, 3145728
    s_cselect_b32 s50, 0, 640
    s_mul_i32 s51, s34, 80
    s_add_u32 s49, s49, s51
    s_sub_u32 s50, s33, s50
    s_lshr_b32 s50, s50, 3
    v_lshlrev_b32 v39, 4, v2
    s_mov_b32 s52, 161280
    v_add_u32 v38, s50, v3
    s_waitcnt lgkmcnt(0)
    s_barrier
    s_lshl_b32 s48, s29, 7
    s_add_u32 s48, s48, 147456
    v_lshl_add_u32 v34, v3, 4, s48
    ds_read_b128 v[152:155], v34 offset:4608
    ds_read_b128 v[156:159], v34 offset:4640
    ds_read_b128 v[160:163], v34 offset:4672
    ds_read_b128 v[164:167], v34 offset:4704
    v_add_u32 v37, 0, v38
    v_mul_u32_u24 v35, 205, v37
    v_lshrrev_b32 v35, 10, v35
    v_lshl_add_u32 v37, v37, 9, v39
    v_mad_u32_u24 v35, v35, s52, v37
    v_add_u32 v37, 2, v38
    v_mul_u32_u24 v36, 205, v37
    v_lshrrev_b32 v36, 10, v36
    v_lshl_add_u32 v37, v37, 9, v39
    v_mad_u32_u24 v36, v36, s52, v37
    v_pk_mul_f32 v[88:89], v[88:89], v[42:43]
    v_pk_mul_f32 v[90:91], v[90:91], v[42:43]
    v_pk_mul_f32 v[92:93], v[92:93], v[42:43]
    v_pk_mul_f32 v[94:95], v[94:95], v[42:43]
    v_pk_mul_f32 v[96:97], v[96:97], v[42:43]
    v_pk_mul_f32 v[98:99], v[98:99], v[42:43]
    v_pk_mul_f32 v[100:101], v[100:101], v[42:43]
    v_pk_mul_f32 v[102:103], v[102:103], v[42:43]
    s_waitcnt lgkmcnt(0)
    v_pk_fma_f32 v[88:89], v[152:153], v[44:45], v[88:89]
    v_pk_fma_f32 v[90:91], v[154:155], v[44:45], v[90:91]
    v_pk_fma_f32 v[92:93], v[156:157], v[44:45], v[92:93]
    v_pk_fma_f32 v[94:95], v[158:159], v[44:45], v[94:95]
    v_pk_fma_f32 v[96:97], v[160:161], v[44:45], v[96:97]
    v_pk_fma_f32 v[98:99], v[162:163], v[44:45], v[98:99]
    v_pk_fma_f32 v[100:101], v[164:165], v[44:45], v[100:101]
    v_pk_fma_f32 v[102:103], v[166:167], v[44:45], v[102:103]
    v_cvt_pk_bf16_f32 v184, v88, v89
    v_cvt_pk_bf16_f32 v185, v90, v91
    v_cvt_pk_bf16_f32 v186, v92, v93
    v_cvt_pk_bf16_f32 v187, v94, v95
    v_cvt_pk_bf16_f32 v188, v96, v97
    v_cvt_pk_bf16_f32 v189, v98, v99
    v_cvt_pk_bf16_f32 v190, v100, v101
    v_cvt_pk_bf16_f32 v191, v102, v103
    s_nop 1
    v_permlane32_swap_b32 v184, v186
    v_permlane32_swap_b32 v185, v187
    v_permlane32_swap_b32 v188, v190
    v_permlane32_swap_b32 v189, v191
    buffer_store_dwordx4 v[184:187], v35, s[12:15], s49 offen sc1
    buffer_store_dwordx4 v[188:191], v36, s[12:15], s49 offen sc1
    s_lshl_b32 s48, s30, 7
    s_add_u32 s48, s48, 147456
    v_lshl_add_u32 v34, v3, 4, s48
    ds_read_b128 v[152:155], v34 offset:4608
    ds_read_b128 v[156:159], v34 offset:4640
    ds_read_b128 v[160:163], v34 offset:4672
    ds_read_b128 v[164:167], v34 offset:4704
    v_add_u32 v37, 4, v38
    v_mul_u32_u24 v40, 205, v37
    v_lshrrev_b32 v40, 10, v40
    v_lshl_add_u32 v37, v37, 9, v39
    v_mad_u32_u24 v40, v40, s52, v37
    v_add_u32 v37, 6, v38
    v_mul_u32_u24 v41, 205, v37
    v_lshrrev_b32 v41, 10, v41
    v_lshl_add_u32 v37, v37, 9, v39
    v_mad_u32_u24 v41, v41, s52, v37
    v_pk_mul_f32 v[104:105], v[104:105], v[42:43]
    v_pk_mul_f32 v[106:107], v[106:107], v[42:43]
    v_pk_mul_f32 v[108:109], v[108:109], v[42:43]
    v_pk_mul_f32 v[110:111], v[110:111], v[42:43]
    v_pk_mul_f32 v[112:113], v[112:113], v[42:43]
    v_pk_mul_f32 v[114:115], v[114:115], v[42:43]
    v_pk_mul_f32 v[116:117], v[116:117], v[42:43]
    v_pk_mul_f32 v[118:119], v[118:119], v[42:43]
    s_waitcnt lgkmcnt(0)
    v_pk_fma_f32 v[104:105], v[152:153], v[44:45], v[104:105]
    v_pk_fma_f32 v[106:107], v[154:155], v[44:45], v[106:107]
    v_pk_fma_f32 v[108:109], v[156:157], v[44:45], v[108:109]
    v_pk_fma_f32 v[110:111], v[158:159], v[44:45], v[110:111]
    v_pk_fma_f32 v[112:113], v[160:161], v[44:45], v[112:113]
    v_pk_fma_f32 v[114:115], v[162:163], v[44:45], v[114:115]
    v_pk_fma_f32 v[116:117], v[164:165], v[44:45], v[116:117]
    v_pk_fma_f32 v[118:119], v[166:167], v[44:45], v[118:119]
    v_cvt_pk_bf16_f32 v192, v104, v105
    v_cvt_pk_bf16_f32 v193, v106, v107
    v_cvt_pk_bf16_f32 v194, v108, v109
    v_cvt_pk_bf16_f32 v195, v110, v111
    v_cvt_pk_bf16_f32 v196, v112, v113
    v_cvt_pk_bf16_f32 v197, v114, v115
    v_cvt_pk_bf16_f32 v198, v116, v117
    v_cvt_pk_bf16_f32 v199, v118, v119
    s_nop 1
    v_permlane32_swap_b32 v192, v194
    v_permlane32_swap_b32 v193, v195
    v_permlane32_swap_b32 v196, v198
    v_permlane32_swap_b32 v197, v199
    buffer_store_dwordx4 v[192:195], v40, s[12:15], s49 offen sc1
    buffer_store_dwordx4 v[196:199], v41, s[12:15], s49 offen sc1
    s_lshl_b32 s48, s31, 7
    s_add_u32 s48, s48, 147456
    v_lshl_add_u32 v34, v3, 4, s48
    ds_read_b128 v[152:155], v34 offset:4608
    ds_read_b128 v[156:159], v34 offset:4640
    ds_read_b128 v[160:163], v34 offset:4672
    ds_read_b128 v[164:167], v34 offset:4704
    v_add_u32 v37, 8, v38
    v_mul_u32_u24 v35, 205, v37
    v_lshrrev_b32 v35, 10, v35
    v_lshl_add_u32 v37, v37, 9, v39
    v_mad_u32_u24 v35, v35, s52, v37
    v_add_u32 v37, 10, v38
    v_mul_u32_u24 v36, 205, v37
    v_lshrrev_b32 v36, 10, v36
    v_lshl_add_u32 v37, v37, 9, v39
    v_mad_u32_u24 v36, v36, s52, v37
    v_pk_mul_f32 v[120:121], v[120:121], v[42:43]
    v_pk_mul_f32 v[122:123], v[122:123], v[42:43]
    v_pk_mul_f32 v[124:125], v[124:125], v[42:43]
    v_pk_mul_f32 v[126:127], v[126:127], v[42:43]
    v_pk_mul_f32 v[128:129], v[128:129], v[42:43]
    v_pk_mul_f32 v[130:131], v[130:131], v[42:43]
    v_pk_mul_f32 v[132:133], v[132:133], v[42:43]
    v_pk_mul_f32 v[134:135], v[134:135], v[42:43]
    s_waitcnt lgkmcnt(0)
    v_pk_fma_f32 v[120:121], v[152:153], v[44:45], v[120:121]
    v_pk_fma_f32 v[122:123], v[154:155], v[44:45], v[122:123]
    v_pk_fma_f32 v[124:125], v[156:157], v[44:45], v[124:125]
    v_pk_fma_f32 v[126:127], v[158:159], v[44:45], v[126:127]
    v_pk_fma_f32 v[128:129], v[160:161], v[44:45], v[128:129]
    v_pk_fma_f32 v[130:131], v[162:163], v[44:45], v[130:131]
    v_pk_fma_f32 v[132:133], v[164:165], v[44:45], v[132:133]
    v_pk_fma_f32 v[134:135], v[166:167], v[44:45], v[134:135]
    v_cvt_pk_bf16_f32 v184, v120, v121
    v_cvt_pk_bf16_f32 v185, v122, v123
    v_cvt_pk_bf16_f32 v186, v124, v125
    v_cvt_pk_bf16_f32 v187, v126, v127
    v_cvt_pk_bf16_f32 v188, v128, v129
    v_cvt_pk_bf16_f32 v189, v130, v131
    v_cvt_pk_bf16_f32 v190, v132, v133
    v_cvt_pk_bf16_f32 v191, v134, v135
    s_nop 1
    v_permlane32_swap_b32 v184, v186
    v_permlane32_swap_b32 v185, v187
    v_permlane32_swap_b32 v188, v190
    v_permlane32_swap_b32 v189, v191
    buffer_store_dwordx4 v[184:187], v35, s[12:15], s49 offen sc1
    buffer_store_dwordx4 v[188:191], v36, s[12:15], s49 offen sc1
    s_lshl_b32 s48, s32, 7
    s_add_u32 s48, s48, 147456
    v_lshl_add_u32 v34, v3, 4, s48
    ds_read_b128 v[152:155], v34 offset:4608
    ds_read_b128 v[156:159], v34 offset:4640
    ds_read_b128 v[160:163], v34 offset:4672
    ds_read_b128 v[164:167], v34 offset:4704
    v_add_u32 v37, 12, v38
    v_mul_u32_u24 v40, 205, v37
    v_lshrrev_b32 v40, 10, v40
    v_lshl_add_u32 v37, v37, 9, v39
    v_mad_u32_u24 v40, v40, s52, v37
    v_add_u32 v37, 14, v38
    v_mul_u32_u24 v41, 205, v37
    v_lshrrev_b32 v41, 10, v41
    v_lshl_add_u32 v37, v37, 9, v39
    v_mad_u32_u24 v41, v41, s52, v37
    v_pk_mul_f32 v[136:137], v[136:137], v[42:43]
    v_pk_mul_f32 v[138:139], v[138:139], v[42:43]
    v_pk_mul_f32 v[140:141], v[140:141], v[42:43]
    v_pk_mul_f32 v[142:143], v[142:143], v[42:43]
    v_pk_mul_f32 v[144:145], v[144:145], v[42:43]
    v_pk_mul_f32 v[146:147], v[146:147], v[42:43]
    v_pk_mul_f32 v[148:149], v[148:149], v[42:43]
    v_pk_mul_f32 v[150:151], v[150:151], v[42:43]
    s_waitcnt lgkmcnt(0)
    v_pk_fma_f32 v[136:137], v[152:153], v[44:45], v[136:137]
    v_pk_fma_f32 v[138:139], v[154:155], v[44:45], v[138:139]
    v_pk_fma_f32 v[140:141], v[156:157], v[44:45], v[140:141]
    v_pk_fma_f32 v[142:143], v[158:159], v[44:45], v[142:143]
    v_pk_fma_f32 v[144:145], v[160:161], v[44:45], v[144:145]
    v_pk_fma_f32 v[146:147], v[162:163], v[44:45], v[146:147]
    v_pk_fma_f32 v[148:149], v[164:165], v[44:45], v[148:149]
    v_pk_fma_f32 v[150:151], v[166:167], v[44:45], v[150:151]
    v_cvt_pk_bf16_f32 v192, v136, v137
    v_cvt_pk_bf16_f32 v193, v138, v139
    v_cvt_pk_bf16_f32 v194, v140, v141
    v_cvt_pk_bf16_f32 v195, v142, v143
    v_cvt_pk_bf16_f32 v196, v144, v145
    v_cvt_pk_bf16_f32 v197, v146, v147
    v_cvt_pk_bf16_f32 v198, v148, v149
    v_cvt_pk_bf16_f32 v199, v150, v151
    s_nop 1
    v_permlane32_swap_b32 v192, v194
    v_permlane32_swap_b32 v193, v195
    v_permlane32_swap_b32 v196, v198
    v_permlane32_swap_b32 v197, v199
    buffer_store_dwordx4 v[192:195], v40, s[12:15], s49 offen sc1
    buffer_store_dwordx4 v[196:199], v41, s[12:15], s49 offen sc1
    s_endpgm
p1_kernel_V:
    s_lshl_b32 s33, s22, 7
    s_mov_b32 s29, 0
    s_mov_b32 s30, 1
    s_mov_b32 s31, 2
    s_mov_b32 s32, 3
    v_lshrrev_b32 v34, 4, v1
    v_bfe_u32 v35, v1, 2, 2
    v_xor_b32 v35, v35, v34
    v_and_b32 v36, 3, v1
    v_mul_u32_u24 v34, 3840, v34
    v_lshl_add_u32 v34, v35, 6, v34
    v_lshl_add_u32 v8, v36, 4, v34
    v_add_u32 v9, 15360, v8
    s_lshl_b32 s28, s20, 11
    s_add_u32 s28, s28, 32768
    s_mul_i32 s25, s20, 30720
    s_lshl_b32 s48, s33, 1
    s_add_u32 s25, s25, s48
    s_and_b32 s55, s22, 7
    s_and_b32 s56, s21, 3
    s_mul_i32 s56, s56, 3
    s_add_u32 s55, s55, s56
    s_cmp_ge_u32 s55, 10
    s_cselect_b32 s56, 10, 0
    s_sub_u32 s55, s55, s56
    s_lshl_b32 s56, s55, 7
    s_add_u32 s24, s24, s56
    s_mul_i32 s56, s55, 245760
    s_add_u32 s25, s25, s56
    buffer_load_dwordx4 v[152:155], v182, s[4:7], s53 offen
    buffer_load_dword v156, v183, s[4:7], s53 offen offset:1024
    s_mul_i32 s48, s21, 80
    s_mul_i32 s49, s20, 10
    s_add_u32 s48, s48, s49
    s_mul_i32 s48, s48, 3840
    s_lshl_b32 s49, s33, 1
    s_add_u32 s48, s48, s49
    buffer_load_dword v158, v183, s[8:11], s48 offen
    s_add_u32 s48, s48, 3840
    buffer_load_dword v159, v183, s[8:11], s48 offen
    s_add_u32 s48, s48, 3840
    buffer_load_dword v160, v183, s[8:11], s48 offen
    s_add_u32 s48, s48, 3840
    buffer_load_dword v161, v183, s[8:11], s48 offen
    s_add_u32 s48, s48, 3840
    buffer_load_dword v162, v183, s[8:11], s48 offen
    s_add_u32 s48, s48, 3840
    buffer_load_dword v163, v183, s[8:11], s48 offen
    s_add_u32 s48, s48, 3840
    buffer_load_dword v164, v183, s[8:11], s48 offen
    s_add_u32 s48, s48, 3840
    buffer_load_dword v165, v183, s[8:11], s48 offen
    s_add_u32 s48, s48, 3840
    buffer_load_dword v166, v183, s[8:11], s48 offen
    s_add_u32 s48, s48, 3840
    buffer_load_dword v167, v183, s[8:11], s48 offen
    s_add_u32 s48, s48, 3840
    s_add_u32 m0, s27, 0
    s_nop 0
    buffer_load_dwordx4 v4, s[4:7], s24 offen lds
    s_add_u32 m0, s27, 1024
    s_nop 0
    buffer_load_dwordx4 v5, s[4:7], s24 offen lds
    s_add_u32 m0, s27, 2048
    s_nop 0
    buffer_load_dwordx4 v6, s[4:7], s24 offen lds
    s_add_u32 m0, s27, 3072
    s_nop 0
    buffer_load_dwordx4 v7, s[4:7], s24 offen lds
    s_add_u32 s24, s24, 128
    s_cmp_eq_u32 s55, 9
    s_cselect_b32 s56, 1280, 0
    s_sub_u32 s24, s24, s56
    s_add_u32 m0, s28, 0
    s_nop 0
    buffer_load_dwordx4 v8, s[8:11], s25 offen lds
    s_add_u32 m0, s28, 1024
    s_nop 0
    buffer_load_dwordx4 v9, s[8:11], s25 offen lds
    s_add_u32 s25, s25, 245760
    s_cmp_eq_u32 s55, 9
    s_cselect_b32 s56, 2457600, 0
    s_sub_u32 s25, s25, s56
    s_add_u32 m0, s27, 49152
    s_nop 0
    buffer_load_dwordx4 v4, s[4:7], s24 offen lds
    s_add_u32 m0, s27, 50176
    s_nop 0
    buffer_load_dwordx4 v5, s[4:7], s24 offen lds
    s_add_u32 m0, s27, 51200
    s_nop 0
    buffer_load_dwordx4 v6, s[4:7], s24 offen lds
    s_add_u32 m0, s27, 52224
    s_nop 0
    buffer_load_dwordx4 v7, s[4:7], s24 offen lds
    s_add_u32 s24, s24, 128
    s_cmp_eq_u32 s55, 8
    s_cselect_b32 s56, 1280, 0
    s_sub_u32 s24, s24, s56
    s_add_u32 m0, s28, 49152
    s_nop 0
    buffer_load_dwordx4 v8, s[8:11], s25 offen lds
    s_add_u32 m0, s28, 50176
    s_nop 0
    buffer_load_dwordx4 v9, s[8:11], s25 offen lds
    s_add_u32 s25, s25, 245760
    s_cmp_eq_u32 s55, 8
    s_cselect_b32 s56, 2457600, 0
    s_sub_u32 s25, s25, s56
    v_lshrrev_b32 v34, 1, v2
    v_and_b32 v34, 7, v34
    s_lshl_b32 s48, s20, 12
    v_lshlrev_b32 v35, 7, v2
    v_add_u32 v35, s48, v35
    v_add_u32 v36, 0, v3
    v_xor_b32 v36, v36, v34
    v_lshl_add_u32 v10, v36, 4, v35
    v_add_u32 v14, 49152, v10
    v_add_u32 v18, 98304, v10
    v_add_u32 v36, 2, v3
    v_xor_b32 v36, v36, v34
    v_lshl_add_u32 v11, v36, 4, v35
    v_add_u32 v15, 49152, v11
    v_add_u32 v19, 98304, v11
    v_add_u32 v36, 4, v3
    v_xor_b32 v36, v36, v34
    v_lshl_add_u32 v12, v36, 4, v35
    v_add_u32 v16, 49152, v12
    v_add_u32 v20, 98304, v12
    v_add_u32 v36, 6, v3
    v_xor_b32 v36, v36, v34
    v_lshl_add_u32 v13, v36, 4, v35
    v_add_u32 v17, 49152, v13
    v_add_u32 v21, 98304, v13
    v_bfe_u32 v34, v1, 2, 2
    v_and_b32 v35, 3, v1
    v_bfe_u32 v36, v1, 4, 1
    v_lshl_add_u32 v37, v3, 3, v34
    v_mul_u32_u24 v37, 256, v37
    v_lshl_add_u32 v37, v36, 5, v37
    v_lshl_add_u32 v37, v35, 3, v37
    v_add_u32 v37, 32768, v37
    v_xor_b32 v38, s29, v34
    v_lshl_add_u32 v22, v38, 6, v37
    v_add_u32 v26, 49152, v22
    v_add_u32 v30, 98304, v22
    v_xor_b32 v38, s30, v34
    v_lshl_add_u32 v23, v38, 6, v37
    v_add_u32 v27, 49152, v23
    v_add_u32 v31, 98304, v23
    v_xor_b32 v38, s31, v34
    v_lshl_add_u32 v24, v38, 6, v37
    v_add_u32 v28, 49152, v24
    v_add_u32 v32, 98304, v24
    v_xor_b32 v38, s32, v34
    v_lshl_add_u32 v25, v38, 6, v37
    v_add_u32 v29, 49152, v25
    v_add_u32 v33, 98304, v25
    v_mov_b32 v88, 0
    v_mov_b32 v89, 0
    v_mov_b32 v90, 0
    v_mov_b32 v91, 0
    v_mov_b32 v92, 0
    v_mov_b32 v93, 0
    v_mov_b32 v94, 0
    v_mov_b32 v95, 0
    v_mov_b32 v96, 0
    v_mov_b32 v97, 0
    v_mov_b32 v98, 0
    v_mov_b32 v99, 0
    v_mov_b32 v100, 0
    v_mov_b32 v101, 0
    v_mov_b32 v102, 0
    v_mov_b32 v103, 0
    v_mov_b32 v104, 0
    v_mov_b32 v105, 0
    v_mov_b32 v106, 0
    v_mov_b32 v107, 0
    v_mov_b32 v108, 0
    v_mov_b32 v109, 0
    v_mov_b32 v110, 0
    v_mov_b32 v111, 0
    v_mov_b32 v112, 0
    v_mov_b32 v113, 0
    v_mov_b32 v114, 0
    v_mov_b32 v115, 0
    v_mov_b32 v116, 0
    v_mov_b32 v117, 0
    v_mov_b32 v118, 0
    v_mov_b32 v119, 0
    v_mov_b32 v120, 0
    v_mov_b32 v121, 0
    v_mov_b32 v122, 0
    v_mov_b32 v123, 0
    v_mov_b32 v124, 0
    v_mov_b32 v125, 0
    v_mov_b32 v126, 0
    v_mov_b32 v127, 0
    v_mov_b32 v128, 0
    v_mov_b32 v129, 0
    v_mov_b32 v130, 0
    v_mov_b32 v131, 0
    v_mov_b32 v132, 0
    v_mov_b32 v133, 0
    v_mov_b32 v134, 0
    v_mov_b32 v135, 0
    v_mov_b32 v136, 0
    v_mov_b32 v137, 0
    v_mov_b32 v138, 0
    v_mov_b32 v139, 0
    v_mov_b32 v140, 0
    v_mov_b32 v141, 0
    v_mov_b32 v142, 0
    v_mov_b32 v143, 0
    v_mov_b32 v144, 0
    v_mov_b32 v145, 0
    v_mov_b32 v146, 0
    v_mov_b32 v147, 0
    v_mov_b32 v148, 0
    v_mov_b32 v149, 0
    v_mov_b32 v150, 0
    v_mov_b32 v151, 0
    s_waitcnt vmcnt(12)
    v_and_b32 v168, 0xffff0000, v152
    v_lshlrev_b32 v169, 16, v152
    v_and_b32 v170, 0xffff0000, v153
    v_lshlrev_b32 v171, 16, v153
    v_and_b32 v172, 0xffff0000, v154
    v_lshlrev_b32 v173, 16, v154
    v_and_b32 v174, 0xffff0000, v155
    v_lshlrev_b32 v175, 16, v155
    v_and_b32 v176, 0xffff0000, v156
    v_lshlrev_b32 v177, 16, v156
    v_add_f32 v178, v168, v169
    v_mul_f32 v179, v168, v168
    v_fmac_f32 v179, v169, v169
    v_add_f32 v178, v178, v170
    v_fmac_f32 v179, v170, v170
    v_add_f32 v178, v178, v171
    v_fmac_f32 v179, v171, v171
    v_add_f32 v178, v178, v172
    v_fmac_f32 v179, v172, v172
    v_add_f32 v178, v178, v173
    v_fmac_f32 v179, v173, v173
    v_add_f32 v178, v178, v174
    v_fmac_f32 v179, v174, v174
    v_add_f32 v178, v178, v175
    v_fmac_f32 v179, v175, v175
    v_add_f32 v178, v178, v176
    v_fmac_f32 v179, v176, v176
    v_add_f32 v178, v178, v177
    v_fmac_f32 v179, v177, v177
    s_nop 1
    v_add_f32_dpp v178, v178, v178 row_shr:1 row_mask:0xf bank_mask:0xf bound_ctrl:0
    v_add_f32_dpp v179, v179, v179 row_shr:1 row_mask:0xf bank_mask:0xf bound_ctrl:0
    s_nop 1
    v_add_f32_dpp v178, v178, v178 row_shr:2 row_mask:0xf bank_mask:0xf bound_ctrl:0
    v_add_f32_dpp v179, v179, v179 row_shr:2 row_mask:0xf bank_mask:0xf bound_ctrl:0
    s_nop 1
    v_add_f32_dpp v178, v178, v178 row_shr:4 row_mask:0xf bank_mask:0xf bound_ctrl:0
    v_add_f32_dpp v179, v179, v179 row_shr:4 row_mask:0xf bank_mask:0xf bound_ctrl:0
    s_nop 1
    v_add_f32_dpp v178, v178, v178 row_shr:8 row_mask:0xf bank_mask:0xf bound_ctrl:0
    v_add_f32_dpp v179, v179, v179 row_shr:8 row_mask:0xf bank_mask:0xf bound_ctrl:0
    s_nop 1
    v_add_f32_dpp v178, v178, v178 row_bcast:15 row_mask:0xa bank_mask:0xf
    v_add_f32_dpp v179, v179, v179 row_bcast:15 row_mask:0xa bank_mask:0xf
    s_nop 1
    v_add_f32_dpp v178, v178, v178 row_bcast:31 row_mask:0xc bank_mask:0xf
    v_add_f32_dpp v179, v179, v179 row_bcast:31 row_mask:0xc bank_mask:0xf
    s_lshl_b32 s48, s20, 3
    v_mov_b32 v168, s48
    v_add_u32 v168, 151552, v168
    s_mov_b32 s48, 0
    s_mov_b32 s49, 0x80000000
    s_mov_b64 exec, s[48:49]
    ds_write_b64 v168, v[178:179]
    s_mov_b64 exec, -1
    v_lshlrev_b32 v168, 16, v158
    v_and_b32 v169, 0xffff0000, v158
    v_lshlrev_b32 v170, 16, v159
    v_and_b32 v171, 0xffff0000, v159
    v_pk_add_f32 v[168:169], v[168:169], v[170:171]
    v_lshlrev_b32 v170, 16, v160
    v_and_b32 v171, 0xffff0000, v160
    v_pk_add_f32 v[168:169], v[168:169], v[170:171]
    v_lshlrev_b32 v170, 16, v161
    v_and_b32 v171, 0xffff0000, v161
    v_pk_add_f32 v[168:169], v[168:169], v[170:171]
    v_lshlrev_b32 v170, 16, v162
    v_and_b32 v171, 0xffff0000, v162
    v_pk_add_f32 v[168:169], v[168:169], v[170:171]
    v_lshlrev_b32 v170, 16, v163
    v_and_b32 v171, 0xffff0000, v163
    v_pk_add_f32 v[168:169], v[168:169], v[170:171]
    v_lshlrev_b32 v170, 16, v164
    v_and_b32 v171, 0xffff0000, v164
    v_pk_add_f32 v[168:169], v[168:169], v[170:171]
    v_lshlrev_b32 v170, 16, v165
    v_and_b32 v171, 0xffff0000, v165
    v_pk_add_f32 v[168:169], v[168:169], v[170:171]
    v_lshlrev_b32 v170, 16, v166
    v_and_b32 v171, 0xffff0000, v166
    v_pk_add_f32 v[168:169], v[168:169], v[170:171]
    v_lshlrev_b32 v170, 16, v167
    v_and_b32 v171, 0xffff0000, v167
    v_pk_add_f32 v[168:169], v[168:169], v[170:171]
    s_lshl_b32 s48, s20, 9
    v_lshlrev_b32 v172, 3, v1
    v_add_u32 v172, 147456, v172
    v_add_u32 v173, s48, v172
    ds_write_b64 v173, v[168:169]
    s_waitcnt vmcnt(6) lgkmcnt(0)
    s_barrier
    ds_read_b128 v[48:51], v10
    ds_read_b64_tr_b16 v[56:57], v22 offset:0
    ds_read_b64_tr_b16 v[58:59], v22 offset:1024
    ds_read_b64_tr_b16 v[60:61], v23 offset:0
    ds_read_b64_tr_b16 v[62:63], v23 offset:1024
    ds_read_b64_tr_b16 v[64:65], v24 offset:0
    ds_read_b64_tr_b16 v[66:67], v24 offset:1024
    ds_read_b64_tr_b16 v[68:69], v25 offset:0
    ds_read_b64_tr_b16 v[70:71], v25 offset:1024
    s_cmp_lg_u32 s20, 0
    s_cbranch_scc1 p1_kernel_V_np
    v_lshlrev_b32 v168, 3, v1
    v_add_u32 v169, 147456, v168
    ds_read_b64 v[210:211], v169 offset:0
    ds_read_b64 v[212:213], v169 offset:512
    ds_read_b64 v[214:215], v169 offset:1024
    ds_read_b64 v[216:217], v169 offset:1536
    ds_read_b64 v[218:219], v169 offset:2048
    ds_read_b64 v[220:221], v169 offset:2560
    ds_read_b64 v[222:223], v169 offset:3072
    ds_read_b64 v[224:225], v169 offset:3584
    s_waitcnt lgkmcnt(0)
    v_pk_add_f32 v[210:211], v[210:211], v[212:213]
    v_pk_add_f32 v[210:211], v[210:211], v[214:215]
    v_pk_add_f32 v[210:211], v[210:211], v[216:217]
    v_pk_add_f32 v[210:211], v[210:211], v[218:219]
    v_pk_add_f32 v[210:211], v[210:211], v[220:221]
    v_pk_add_f32 v[210:211], v[210:211], v[222:223]
    v_pk_add_f32 v[210:211], v[210:211], v[224:225]
    s_lshl_b32 s48, s22, 3
    s_add_u32 s48, s48, s21
    s_lshl_b32 s48, s48, 9
    s_add_u32 s48, s48, 24182784
    buffer_store_dwordx2 v[210:211], v168, s[12:15], s48 offen sc0 sc1
    v_lshlrev_b32 v168, 3, v1
    v_add_u32 v169, 151552, v168
    s_mov_b64 exec, 0xff
    ds_read_b64 v[170:171], v169
    s_lshl_b32 s48, s21, 11
    s_lshl_b32 s49, s22, 6
    s_add_u32 s48, s48, s49
    s_add_u32 s48, s48, 24117248
    s_waitcnt lgkmcnt(0)
    buffer_store_dwordx2 v[170:171], v168, s[12:15], s48 offen sc0 sc1
    s_mov_b64 exec, -1
p1_kernel_V_np:
    s_waitcnt lgkmcnt(6)
    s_add_u32 m0, s27, 98304
    v_mfma_f32_32x32x16_bf16 v[88:103], v[48:51], v[56:59], v[88:103]
    ds_read_b128 v[52:55], v11
    ds_read_b64_tr_b16 v[72:73], v22 offset:4096
    ds_read_b64_tr_b16 v[74:75], v22 offset:5120
    buffer_load_dwordx4 v4, s[4:7], s24 offen lds
    s_waitcnt lgkmcnt(7)
    v_mfma_f32_32x32x16_bf16 v[104:119], v[48:51], v[60:63], v[104:119]
    ds_read_b64_tr_b16 v[76:77], v23 offset:4096
    ds_read_b64_tr_b16 v[78:79], v23 offset:5120
    s_waitcnt lgkmcnt(7)
    s_add_u32 m0, s27, 99328
    v_mfma_f32_32x32x16_bf16 v[120:135], v[48:51], v[64:67], v[120:135]
    ds_read_b64_tr_b16 v[80:81], v24 offset:4096
    ds_read_b64_tr_b16 v[82:83], v24 offset:5120
    buffer_load_dwordx4 v5, s[4:7], s24 offen lds
    s_waitcnt lgkmcnt(7)
    v_mfma_f32_32x32x16_bf16 v[136:151], v[48:51], v[68:71], v[136:151]
    ds_read_b64_tr_b16 v[84:85], v25 offset:4096
    ds_read_b64_tr_b16 v[86:87], v25 offset:5120
    s_waitcnt lgkmcnt(6)
    s_add_u32 m0, s27, 100352
    v_mfma_f32_32x32x16_bf16 v[88:103], v[52:55], v[72:75], v[88:103]
    ds_read_b128 v[48:51], v12
    ds_read_b64_tr_b16 v[56:57], v22 offset:8192
    ds_read_b64_tr_b16 v[58:59], v22 offset:9216
    buffer_load_dwordx4 v6, s[4:7], s24 offen lds
    s_waitcnt lgkmcnt(7)
    v_mfma_f32_32x32x16_bf16 v[104:119], v[52:55], v[76:79], v[104:119]
    ds_read_b64_tr_b16 v[60:61], v23 offset:8192
    ds_read_b64_tr_b16 v[62:63], v23 offset:9216
    s_waitcnt lgkmcnt(7)
    s_add_u32 m0, s27, 101376
    v_mfma_f32_32x32x16_bf16 v[120:135], v[52:55], v[80:83], v[120:135]
    ds_read_b64_tr_b16 v[64:65], v24 offset:8192
    ds_read_b64_tr_b16 v[66:67], v24 offset:9216
    buffer_load_dwordx4 v7, s[4:7], s24 offen lds
    s_add_u32 s24, s24, 128
    s_cmp_eq_u32 s55, 7
    s_cselect_b32 s56, 1280, 0
    s_sub_u32 s24, s24, s56
    s_waitcnt lgkmcnt(7)
    v_mfma_f32_32x32x16_bf16 v[136:151], v[52:55], v[84:87], v[136:151]
    ds_read_b64_tr_b16 v[68:69], v25 offset:8192
    ds_read_b64_tr_b16 v[70:71], v25 offset:9216
    s_waitcnt lgkmcnt(6)
    s_add_u32 m0, s28, 98304
    v_mfma_f32_32x32x16_bf16 v[88:103], v[48:51], v[56:59], v[88:103]
    ds_read_b128 v[52:55], v13
    ds_read_b64_tr_b16 v[72:73], v22 offset:12288
    ds_read_b64_tr_b16 v[74:75], v22 offset:13312
    buffer_load_dwordx4 v8, s[8:11], s25 offen lds
    s_waitcnt lgkmcnt(7)
    v_mfma_f32_32x32x16_bf16 v[104:119], v[48:51], v[60:63], v[104:119]
    ds_read_b64_tr_b16 v[76:77], v23 offset:12288
    ds_read_b64_tr_b16 v[78:79], v23 offset:13312
    s_waitcnt lgkmcnt(7)
    s_add_u32 m0, s28, 99328
    v_mfma_f32_32x32x16_bf16 v[120:135], v[48:51], v[64:67], v[120:135]
    ds_read_b64_tr_b16 v[80:81], v24 offset:12288
    ds_read_b64_tr_b16 v[82:83], v24 offset:13312
    buffer_load_dwordx4 v9, s[8:11], s25 offen lds
    s_add_u32 s25, s25, 245760
    s_cmp_eq_u32 s55, 7
    s_cselect_b32 s56, 2457600, 0
    s_sub_u32 s25, s25, s56
    s_waitcnt lgkmcnt(7)
    v_mfma_f32_32x32x16_bf16 v[136:151], v[48:51], v[68:71], v[136:151]
    ds_read_b64_tr_b16 v[84:85], v25 offset:12288
    ds_read_b64_tr_b16 v[86:87], v25 offset:13312
    s_waitcnt lgkmcnt(6)
    v_mfma_f32_32x32x16_bf16 v[88:103], v[52:55], v[72:75], v[88:103]
    s_waitcnt vmcnt(6) lgkmcnt(0)
    s_cmp_lg_u32 s20, 0
    s_cbranch_scc1 p1_kernel_V_ns
    s_mov_b64 exec, 1
    v_mov_b32 v168, 1
    v_mov_b32 v169, 0
    s_lshl_b32 s48, s21, 5
    s_add_u32 s48, s48, s22
    buffer_store_byte v168, v169, s[76:79], s48 offen sc0 sc1
    s_mov_b64 exec, -1
p1_kernel_V_ns:
    s_barrier
    s_lshl_b32 s84, s2, 3
    s_add_u32 s84, s84, s20
    s_cmp_ge_u32 s84, 1920
    s_cselect_b32 s85, 1920, 0
    s_cselect_b32 s88, s82, s80
    s_cselect_b32 s89, s83, s81
    s_mov_b32 s90, 1966080
    s_mov_b32 s93, 27262976
    s_cselect_b32 s90, 819200, s90
    s_cselect_b32 s93, 30408704, s93
    s_cselect_b32 s94, 40, 96
    s_and_b32 s89, s89, 0xffff
    s_mov_b32 s91, 0x00020000
    s_sub_u32 s84, s84, s85
    s_mul_i32 s86, s84, 3277
    s_lshr_b32 s86, s86, 16
    s_mul_i32 s87, s86, 20
    s_sub_u32 s87, s84, s87
    s_mul_i32 s95, s87, 205
    s_lshr_b32 s95, s95, 10
    s_mul_i32 s96, s95, 5
    s_sub_u32 s96, s87, s96
    s_mul_i32 s95, s95, s94
    s_add_u32 s95, s95, s86
    s_mul_i32 s95, s95, 5
    s_add_u32 s95, s95, s96
    s_lshl_b32 s95, s95, 10
    s_add_u32 s92, s95, s93
    v_lshrrev_b32 v218, 2, v1
    s_mul_i32 s95, s86, 16
    s_cmp_eq_u32 s85, 0
    s_cbranch_scc1 p1_kernel_V_tr0_rows
    s_cmp_ge_u32 s86, 32
    s_cbranch_scc1 p1_kernel_V_tr0_tb
    s_mul_i32 s95, s86, 20
    v_lshrrev_b32 v219, 3, v218
    v_lshl_add_u32 v218, v219, 1, v218
    s_branch p1_kernel_V_tr0_rows
p1_kernel_V_tr0_tb:
    s_sub_u32 s95, s86, 32
    s_mul_i32 s95, s95, 80
    s_add_u32 s95, s95, 8
    v_lshrrev_b32 v219, 1, v218
    v_and_b32 v218, 1, v218
    v_mad_u32_u24 v218, v219, 10, v218
p1_kernel_V_tr0_rows:
    s_mul_i32 s95, s95, 1280
    s_lshl_b32 s96, s87, 6
    s_add_u32 s95, s95, s96
    v_mul_u32_u24 v218, 1280, v218
    v_and_b32 v219, 3, v1
    v_lshl_add_u32 v218, v219, 4, v218
    s_lshl_b32 s96, s20, 10
    s_add_u32 m0, s96, 155136
    s_nop 0
    buffer_load_dwordx4 v218, s[88:91], s95 offen lds
p1_kernel_V_tr0_end:
    s_add_u32 m0, s27, 0
    v_mfma_f32_32x32x16_bf16 v[104:119], v[52:55], v[76:79], v[104:119]
    ds_read_b128 v[48:51], v14
    ds_read_b64_tr_b16 v[56:57], v26 offset:0
    ds_read_b64_tr_b16 v[58:59], v26 offset:1024
    buffer_load_dwordx4 v4, s[4:7], s24 offen lds
    v_mfma_f32_32x32x16_bf16 v[120:135], v[52:55], v[80:83], v[120:135]
    ds_read_b64_tr_b16 v[60:61], v27 offset:0
    ds_read_b64_tr_b16 v[62:63], v27 offset:1024
    s_add_u32 m0, s27, 1024
    v_mfma_f32_32x32x16_bf16 v[136:151], v[52:55], v[84:87], v[136:151]
    ds_read_b64_tr_b16 v[64:65], v28 offset:0
    ds_read_b64_tr_b16 v[66:67], v28 offset:1024
    ds_read_b64_tr_b16 v[68:69], v29 offset:0
    ds_read_b64_tr_b16 v[70:71], v29 offset:1024
    buffer_load_dwordx4 v5, s[4:7], s24 offen lds
    s_waitcnt lgkmcnt(6)
    s_add_u32 m0, s27, 2048
    v_mfma_f32_32x32x16_bf16 v[88:103], v[48:51], v[56:59], v[88:103]
    ds_read_b128 v[52:55], v15
    ds_read_b64_tr_b16 v[72:73], v26 offset:4096
    ds_read_b64_tr_b16 v[74:75], v26 offset:5120
    buffer_load_dwordx4 v6, s[4:7], s24 offen lds
    s_waitcnt lgkmcnt(7)
    v_mfma_f32_32x32x16_bf16 v[104:119], v[48:51], v[60:63], v[104:119]
    ds_read_b64_tr_b16 v[76:77], v27 offset:4096
    ds_read_b64_tr_b16 v[78:79], v27 offset:5120
    s_waitcnt lgkmcnt(7)
    s_add_u32 m0, s27, 3072
    v_mfma_f32_32x32x16_bf16 v[120:135], v[48:51], v[64:67], v[120:135]
    ds_read_b64_tr_b16 v[80:81], v28 offset:4096
    ds_read_b64_tr_b16 v[82:83], v28 offset:5120
    buffer_load_dwordx4 v7, s[4:7], s24 offen lds
    s_add_u32 s24, s24, 128
    s_cmp_eq_u32 s55, 6
    s_cselect_b32 s56, 1280, 0
    s_sub_u32 s24, s24, s56
    s_waitcnt lgkmcnt(7)
    v_mfma_f32_32x32x16_bf16 v[136:151], v[48:51], v[68:71], v[136:151]
    ds_read_b64_tr_b16 v[84:85], v29 offset:4096
    ds_read_b64_tr_b16 v[86:87], v29 offset:5120
    s_waitcnt lgkmcnt(6)
    s_add_u32 m0, s28, 0
    v_mfma_f32_32x32x16_bf16 v[88:103], v[52:55], v[72:75], v[88:103]
    ds_read_b128 v[48:51], v16
    ds_read_b64_tr_b16 v[56:57], v26 offset:8192
    ds_read_b64_tr_b16 v[58:59], v26 offset:9216
    buffer_load_dwordx4 v8, s[8:11], s25 offen lds
    s_waitcnt lgkmcnt(7)
    v_mfma_f32_32x32x16_bf16 v[104:119], v[52:55], v[76:79], v[104:119]
    ds_read_b64_tr_b16 v[60:61], v27 offset:8192
    ds_read_b64_tr_b16 v[62:63], v27 offset:9216
    s_waitcnt lgkmcnt(7)
    s_add_u32 m0, s28, 1024
    v_mfma_f32_32x32x16_bf16 v[120:135], v[52:55], v[80:83], v[120:135]
    ds_read_b64_tr_b16 v[64:65], v28 offset:8192
    ds_read_b64_tr_b16 v[66:67], v28 offset:9216
    buffer_load_dwordx4 v9, s[8:11], s25 offen lds
    s_add_u32 s25, s25, 245760
    s_cmp_eq_u32 s55, 6
    s_cselect_b32 s56, 2457600, 0
    s_sub_u32 s25, s25, s56
    s_waitcnt lgkmcnt(7)
    v_mfma_f32_32x32x16_bf16 v[136:151], v[52:55], v[84:87], v[136:151]
    ds_read_b64_tr_b16 v[68:69], v29 offset:8192
    ds_read_b64_tr_b16 v[70:71], v29 offset:9216
    s_waitcnt lgkmcnt(6)
    v_mfma_f32_32x32x16_bf16 v[88:103], v[48:51], v[56:59], v[88:103]
    ds_read_b128 v[52:55], v17
    ds_read_b64_tr_b16 v[72:73], v26 offset:12288
    ds_read_b64_tr_b16 v[74:75], v26 offset:13312
    s_waitcnt lgkmcnt(7)
    v_mfma_f32_32x32x16_bf16 v[104:119], v[48:51], v[60:63], v[104:119]
    ds_read_b64_tr_b16 v[76:77], v27 offset:12288
    ds_read_b64_tr_b16 v[78:79], v27 offset:13312
    s_waitcnt lgkmcnt(7)
    v_mfma_f32_32x32x16_bf16 v[120:135], v[48:51], v[64:67], v[120:135]
    ds_read_b64_tr_b16 v[80:81], v28 offset:12288
    ds_read_b64_tr_b16 v[82:83], v28 offset:13312
    s_waitcnt lgkmcnt(7)
    v_mfma_f32_32x32x16_bf16 v[136:151], v[48:51], v[68:71], v[136:151]
    ds_read_b64_tr_b16 v[84:85], v29 offset:12288
    ds_read_b64_tr_b16 v[86:87], v29 offset:13312
    s_waitcnt lgkmcnt(6)
    v_mfma_f32_32x32x16_bf16 v[88:103], v[52:55], v[72:75], v[88:103]
    s_waitcnt vmcnt(6) lgkmcnt(0)
    s_cmp_eq_u32 s92, -1
    s_cbranch_scc1 p1_kernel_V_tr0_fin
    v_bfe_u32 v218, v1, 2, 2
    v_lshl_add_u32 v218, v3, 3, v218
    v_lshlrev_b32 v218, 6, v218
    v_bfe_u32 v219, v1, 4, 1
    v_lshl_add_u32 v218, v219, 5, v218
    v_and_b32 v219, 3, v1
    v_lshl_add_u32 v218, v219, 3, v218
    s_lshl_b32 s96, s20, 10
    s_add_u32 s96, s96, 155136
    v_add_u32 v218, s96, v218
    ds_read_b64_tr_b16 v[220:221], v218
    ds_read_b64_tr_b16 v[222:223], v218 offset:256
    v_lshlrev_b32 v219, 4, v1
    s_waitcnt lgkmcnt(0)
    buffer_store_dwordx4 v[220:223], v219, s[12:15], s92 offen sc1
p1_kernel_V_tr0_fin:
    s_barrier
    s_add_u32 m0, s27, 49152
    v_mfma_f32_32x32x16_bf16 v[104:119], v[52:55], v[76:79], v[104:119]
    ds_read_b128 v[48:51], v18
    ds_read_b64_tr_b16 v[56:57], v30 offset:0
    ds_read_b64_tr_b16 v[58:59], v30 offset:1024
    buffer_load_dwordx4 v4, s[4:7], s24 offen lds
    v_mfma_f32_32x32x16_bf16 v[120:135], v[52:55], v[80:83], v[120:135]
    ds_read_b64_tr_b16 v[60:61], v31 offset:0
    ds_read_b64_tr_b16 v[62:63], v31 offset:1024
    s_add_u32 m0, s27, 50176
    v_mfma_f32_32x32x16_bf16 v[136:151], v[52:55], v[84:87], v[136:151]
    ds_read_b64_tr_b16 v[64:65], v32 offset:0
    ds_read_b64_tr_b16 v[66:67], v32 offset:1024
    ds_read_b64_tr_b16 v[68:69], v33 offset:0
    ds_read_b64_tr_b16 v[70:71], v33 offset:1024
    buffer_load_dwordx4 v5, s[4:7], s24 offen lds
    s_waitcnt lgkmcnt(6)
    s_add_u32 m0, s27, 51200
    v_mfma_f32_32x32x16_bf16 v[88:103], v[48:51], v[56:59], v[88:103]
    ds_read_b128 v[52:55], v19
    ds_read_b64_tr_b16 v[72:73], v30 offset:4096
    ds_read_b64_tr_b16 v[74:75], v30 offset:5120
    buffer_load_dwordx4 v6, s[4:7], s24 offen lds
    s_waitcnt lgkmcnt(7)
    v_mfma_f32_32x32x16_bf16 v[104:119], v[48:51], v[60:63], v[104:119]
    ds_read_b64_tr_b16 v[76:77], v31 offset:4096
    ds_read_b64_tr_b16 v[78:79], v31 offset:5120
    s_waitcnt lgkmcnt(7)
    s_add_u32 m0, s27, 52224
    v_mfma_f32_32x32x16_bf16 v[120:135], v[48:51], v[64:67], v[120:135]
    ds_read_b64_tr_b16 v[80:81], v32 offset:4096
    ds_read_b64_tr_b16 v[82:83], v32 offset:5120
    buffer_load_dwordx4 v7, s[4:7], s24 offen lds
    s_add_u32 s24, s24, 128
    s_cmp_eq_u32 s55, 5
    s_cselect_b32 s56, 1280, 0
    s_sub_u32 s24, s24, s56
    s_waitcnt lgkmcnt(7)
    v_mfma_f32_32x32x16_bf16 v[136:151], v[48:51], v[68:71], v[136:151]
    ds_read_b64_tr_b16 v[84:85], v33 offset:4096
    ds_read_b64_tr_b16 v[86:87], v33 offset:5120
    s_waitcnt lgkmcnt(6)
    s_add_u32 m0, s28, 49152
    v_mfma_f32_32x32x16_bf16 v[88:103], v[52:55], v[72:75], v[88:103]
    ds_read_b128 v[48:51], v20
    ds_read_b64_tr_b16 v[56:57], v30 offset:8192
    ds_read_b64_tr_b16 v[58:59], v30 offset:9216
    buffer_load_dwordx4 v8, s[8:11], s25 offen lds
    s_waitcnt lgkmcnt(7)
    v_mfma_f32_32x32x16_bf16 v[104:119], v[52:55], v[76:79], v[104:119]
    ds_read_b64_tr_b16 v[60:61], v31 offset:8192
    ds_read_b64_tr_b16 v[62:63], v31 offset:9216
    s_waitcnt lgkmcnt(7)
    s_add_u32 m0, s28, 50176
    v_mfma_f32_32x32x16_bf16 v[120:135], v[52:55], v[80:83], v[120:135]
    ds_read_b64_tr_b16 v[64:65], v32 offset:8192
    ds_read_b64_tr_b16 v[66:67], v32 offset:9216
    buffer_load_dwordx4 v9, s[8:11], s25 offen lds
    s_add_u32 s25, s25, 245760
    s_cmp_eq_u32 s55, 5
    s_cselect_b32 s56, 2457600, 0
    s_sub_u32 s25, s25, s56
    s_waitcnt lgkmcnt(7)
    v_mfma_f32_32x32x16_bf16 v[136:151], v[52:55], v[84:87], v[136:151]
    ds_read_b64_tr_b16 v[68:69], v33 offset:8192
    ds_read_b64_tr_b16 v[70:71], v33 offset:9216
    s_waitcnt lgkmcnt(6)
    v_mfma_f32_32x32x16_bf16 v[88:103], v[48:51], v[56:59], v[88:103]
    ds_read_b128 v[52:55], v21
    ds_read_b64_tr_b16 v[72:73], v30 offset:12288
    ds_read_b64_tr_b16 v[74:75], v30 offset:13312
    s_waitcnt lgkmcnt(7)
    v_mfma_f32_32x32x16_bf16 v[104:119], v[48:51], v[60:63], v[104:119]
    ds_read_b64_tr_b16 v[76:77], v31 offset:12288
    ds_read_b64_tr_b16 v[78:79], v31 offset:13312
    s_waitcnt lgkmcnt(7)
    v_mfma_f32_32x32x16_bf16 v[120:135], v[48:51], v[64:67], v[120:135]
    ds_read_b64_tr_b16 v[80:81], v32 offset:12288
    ds_read_b64_tr_b16 v[82:83], v32 offset:13312
    s_waitcnt lgkmcnt(7)
    v_mfma_f32_32x32x16_bf16 v[136:151], v[48:51], v[68:71], v[136:151]
    ds_read_b64_tr_b16 v[84:85], v33 offset:12288
    ds_read_b64_tr_b16 v[86:87], v33 offset:13312
    s_waitcnt lgkmcnt(6)
    v_mfma_f32_32x32x16_bf16 v[88:103], v[52:55], v[72:75], v[88:103]
    s_waitcnt vmcnt(6) lgkmcnt(0)
    s_barrier
    s_lshl_b32 s84, s2, 3
    s_add_u32 s84, s84, s20
    s_mov_b32 s92, -1
    s_cmp_ge_u32 s84, 672
    s_cbranch_scc1 p1_kernel_V_tr1_end
    s_add_u32 s84, s84, 2048
    s_cmp_ge_u32 s84, 1920
    s_cselect_b32 s85, 1920, 0
    s_cselect_b32 s88, s82, s80
    s_cselect_b32 s89, s83, s81
    s_mov_b32 s90, 1966080
    s_mov_b32 s93, 27262976
    s_cselect_b32 s90, 819200, s90
    s_cselect_b32 s93, 30408704, s93
    s_cselect_b32 s94, 40, 96
    s_and_b32 s89, s89, 0xffff
    s_mov_b32 s91, 0x00020000
    s_sub_u32 s84, s84, s85
    s_mul_i32 s86, s84, 3277
    s_lshr_b32 s86, s86, 16
    s_mul_i32 s87, s86, 20
    s_sub_u32 s87, s84, s87
    s_mul_i32 s95, s87, 205
    s_lshr_b32 s95, s95, 10
    s_mul_i32 s96, s95, 5
    s_sub_u32 s96, s87, s96
    s_mul_i32 s95, s95, s94
    s_add_u32 s95, s95, s86
    s_mul_i32 s95, s95, 5
    s_add_u32 s95, s95, s96
    s_lshl_b32 s95, s95, 10
    s_add_u32 s92, s95, s93
    v_lshrrev_b32 v218, 2, v1
    s_mul_i32 s95, s86, 16
    s_cmp_eq_u32 s85, 0
    s_cbranch_scc1 p1_kernel_V_tr1_rows
    s_cmp_ge_u32 s86, 32
    s_cbranch_scc1 p1_kernel_V_tr1_tb
    s_mul_i32 s95, s86, 20
    v_lshrrev_b32 v219, 3, v218
    v_lshl_add_u32 v218, v219, 1, v218
    s_branch p1_kernel_V_tr1_rows
p1_kernel_V_tr1_tb:
    s_sub_u32 s95, s86, 32
    s_mul_i32 s95, s95, 80
    s_add_u32 s95, s95, 8
    v_lshrrev_b32 v219, 1, v218
    v_and_b32 v218, 1, v218
    v_mad_u32_u24 v218, v219, 10, v218
p1_kernel_V_tr1_rows:
    s_mul_i32 s95, s95, 1280
    s_lshl_b32 s96, s87, 6
    s_add_u32 s95, s95, s96
    v_mul_u32_u24 v218, 1280, v218
    v_and_b32 v219, 3, v1
    v_lshl_add_u32 v218, v219, 4, v218
    s_lshl_b32 s96, s20, 10
    s_add_u32 m0, s96, 155136
    s_nop 0
    buffer_load_dwordx4 v218, s[88:91], s95 offen lds
p1_kernel_V_tr1_end:
    s_add_u32 m0, s27, 98304
    v_mfma_f32_32x32x16_bf16 v[104:119], v[52:55], v[76:79], v[104:119]
    ds_read_b128 v[48:51], v10
    ds_read_b64_tr_b16 v[56:57], v22 offset:0
    ds_read_b64_tr_b16 v[58:59], v22 offset:1024
    buffer_load_dwordx4 v4, s[4:7], s24 offen lds
    v_mfma_f32_32x32x16_bf16 v[120:135], v[52:55], v[80:83], v[120:135]
    ds_read_b64_tr_b16 v[60:61], v23 offset:0
    ds_read_b64_tr_b16 v[62:63], v23 offset:1024
    s_add_u32 m0, s27, 99328
    v_mfma_f32_32x32x16_bf16 v[136:151], v[52:55], v[84:87], v[136:151]
    ds_read_b64_tr_b16 v[64:65], v24 offset:0
    ds_read_b64_tr_b16 v[66:67], v24 offset:1024
    ds_read_b64_tr_b16 v[68:69], v25 offset:0
    ds_read_b64_tr_b16 v[70:71], v25 offset:1024
    buffer_load_dwordx4 v5, s[4:7], s24 offen lds
    s_waitcnt lgkmcnt(6)
    s_add_u32 m0, s27, 100352
    v_mfma_f32_32x32x16_bf16 v[88:103], v[48:51], v[56:59], v[88:103]
    ds_read_b128 v[52:55], v11
    ds_read_b64_tr_b16 v[72:73], v22 offset:4096
    ds_read_b64_tr_b16 v[74:75], v22 offset:5120
    buffer_load_dwordx4 v6, s[4:7], s24 offen lds
    s_waitcnt lgkmcnt(7)
    v_mfma_f32_32x32x16_bf16 v[104:119], v[48:51], v[60:63], v[104:119]
    ds_read_b64_tr_b16 v[76:77], v23 offset:4096
    ds_read_b64_tr_b16 v[78:79], v23 offset:5120
    s_waitcnt lgkmcnt(7)
    s_add_u32 m0, s27, 101376
    v_mfma_f32_32x32x16_bf16 v[120:135], v[48:51], v[64:67], v[120:135]
    ds_read_b64_tr_b16 v[80:81], v24 offset:4096
    ds_read_b64_tr_b16 v[82:83], v24 offset:5120
    buffer_load_dwordx4 v7, s[4:7], s24 offen lds
    s_add_u32 s24, s24, 128
    s_cmp_eq_u32 s55, 4
    s_cselect_b32 s56, 1280, 0
    s_sub_u32 s24, s24, s56
    s_waitcnt lgkmcnt(7)
    v_mfma_f32_32x32x16_bf16 v[136:151], v[48:51], v[68:71], v[136:151]
    ds_read_b64_tr_b16 v[84:85], v25 offset:4096
    ds_read_b64_tr_b16 v[86:87], v25 offset:5120
    s_waitcnt lgkmcnt(6)
    s_add_u32 m0, s28, 98304
    v_mfma_f32_32x32x16_bf16 v[88:103], v[52:55], v[72:75], v[88:103]
    ds_read_b128 v[48:51], v12
    ds_read_b64_tr_b16 v[56:57], v22 offset:8192
    ds_read_b64_tr_b16 v[58:59], v22 offset:9216
    buffer_load_dwordx4 v8, s[8:11], s25 offen lds
    s_waitcnt lgkmcnt(7)
    v_mfma_f32_32x32x16_bf16 v[104:119], v[52:55], v[76:79], v[104:119]
    ds_read_b64_tr_b16 v[60:61], v23 offset:8192
    ds_read_b64_tr_b16 v[62:63], v23 offset:9216
    s_waitcnt lgkmcnt(7)
    s_add_u32 m0, s28, 99328
    v_mfma_f32_32x32x16_bf16 v[120:135], v[52:55], v[80:83], v[120:135]
    ds_read_b64_tr_b16 v[64:65], v24 offset:8192
    ds_read_b64_tr_b16 v[66:67], v24 offset:9216
    buffer_load_dwordx4 v9, s[8:11], s25 offen lds
    s_add_u32 s25, s25, 245760
    s_cmp_eq_u32 s55, 4
    s_cselect_b32 s56, 2457600, 0
    s_sub_u32 s25, s25, s56
    s_waitcnt lgkmcnt(7)
    v_mfma_f32_32x32x16_bf16 v[136:151], v[52:55], v[84:87], v[136:151]
    ds_read_b64_tr_b16 v[68:69], v25 offset:8192
    ds_read_b64_tr_b16 v[70:71], v25 offset:9216
    s_waitcnt lgkmcnt(6)
    v_mfma_f32_32x32x16_bf16 v[88:103], v[48:51], v[56:59], v[88:103]
    ds_read_b128 v[52:55], v13
    ds_read_b64_tr_b16 v[72:73], v22 offset:12288
    ds_read_b64_tr_b16 v[74:75], v22 offset:13312
    s_waitcnt lgkmcnt(7)
    v_mfma_f32_32x32x16_bf16 v[104:119], v[48:51], v[60:63], v[104:119]
    ds_read_b64_tr_b16 v[76:77], v23 offset:12288
    ds_read_b64_tr_b16 v[78:79], v23 offset:13312
    s_waitcnt lgkmcnt(7)
    v_mfma_f32_32x32x16_bf16 v[120:135], v[48:51], v[64:67], v[120:135]
    ds_read_b64_tr_b16 v[80:81], v24 offset:12288
    ds_read_b64_tr_b16 v[82:83], v24 offset:13312
    s_waitcnt lgkmcnt(7)
    v_mfma_f32_32x32x16_bf16 v[136:151], v[48:51], v[68:71], v[136:151]
    ds_read_b64_tr_b16 v[84:85], v25 offset:12288
    ds_read_b64_tr_b16 v[86:87], v25 offset:13312
    s_waitcnt lgkmcnt(6)
    v_mfma_f32_32x32x16_bf16 v[88:103], v[52:55], v[72:75], v[88:103]
    s_waitcnt vmcnt(6) lgkmcnt(0)
    s_cmp_eq_u32 s92, -1
    s_cbranch_scc1 p1_kernel_V_tr1_fin
    v_bfe_u32 v218, v1, 2, 2
    v_lshl_add_u32 v218, v3, 3, v218
    v_lshlrev_b32 v218, 6, v218
    v_bfe_u32 v219, v1, 4, 1
    v_lshl_add_u32 v218, v219, 5, v218
    v_and_b32 v219, 3, v1
    v_lshl_add_u32 v218, v219, 3, v218
    s_lshl_b32 s96, s20, 10
    s_add_u32 s96, s96, 155136
    v_add_u32 v218, s96, v218
    ds_read_b64_tr_b16 v[220:221], v218
    ds_read_b64_tr_b16 v[222:223], v218 offset:256
    v_lshlrev_b32 v219, 4, v1
    s_waitcnt lgkmcnt(0)
    buffer_store_dwordx4 v[220:223], v219, s[12:15], s92 offen sc1
p1_kernel_V_tr1_fin:
    s_barrier
    s_add_u32 m0, s27, 0
    v_mfma_f32_32x32x16_bf16 v[104:119], v[52:55], v[76:79], v[104:119]
    ds_read_b128 v[48:51], v14
    ds_read_b64_tr_b16 v[56:57], v26 offset:0
    ds_read_b64_tr_b16 v[58:59], v26 offset:1024
    buffer_load_dwordx4 v4, s[4:7], s24 offen lds
    v_mfma_f32_32x32x16_bf16 v[120:135], v[52:55], v[80:83], v[120:135]
    ds_read_b64_tr_b16 v[60:61], v27 offset:0
    ds_read_b64_tr_b16 v[62:63], v27 offset:1024
    s_add_u32 m0, s27, 1024
    v_mfma_f32_32x32x16_bf16 v[136:151], v[52:55], v[84:87], v[136:151]
    ds_read_b64_tr_b16 v[64:65], v28 offset:0
    ds_read_b64_tr_b16 v[66:67], v28 offset:1024
    ds_read_b64_tr_b16 v[68:69], v29 offset:0
    ds_read_b64_tr_b16 v[70:71], v29 offset:1024
    buffer_load_dwordx4 v5, s[4:7], s24 offen lds
    s_waitcnt lgkmcnt(6)
    s_add_u32 m0, s27, 2048
    v_mfma_f32_32x32x16_bf16 v[88:103], v[48:51], v[56:59], v[88:103]
    ds_read_b128 v[52:55], v15
    ds_read_b64_tr_b16 v[72:73], v26 offset:4096
    ds_read_b64_tr_b16 v[74:75], v26 offset:5120
    buffer_load_dwordx4 v6, s[4:7], s24 offen lds
    s_waitcnt lgkmcnt(7)
    v_mfma_f32_32x32x16_bf16 v[104:119], v[48:51], v[60:63], v[104:119]
    ds_read_b64_tr_b16 v[76:77], v27 offset:4096
    ds_read_b64_tr_b16 v[78:79], v27 offset:5120
    s_waitcnt lgkmcnt(7)
    s_add_u32 m0, s27, 3072
    v_mfma_f32_32x32x16_bf16 v[120:135], v[48:51], v[64:67], v[120:135]
    ds_read_b64_tr_b16 v[80:81], v28 offset:4096
    ds_read_b64_tr_b16 v[82:83], v28 offset:5120
    buffer_load_dwordx4 v7, s[4:7], s24 offen lds
    s_add_u32 s24, s24, 128
    s_cmp_eq_u32 s55, 3
    s_cselect_b32 s56, 1280, 0
    s_sub_u32 s24, s24, s56
    s_waitcnt lgkmcnt(7)
    v_mfma_f32_32x32x16_bf16 v[136:151], v[48:51], v[68:71], v[136:151]
    ds_read_b64_tr_b16 v[84:85], v29 offset:4096
    ds_read_b64_tr_b16 v[86:87], v29 offset:5120
    s_waitcnt lgkmcnt(6)
    s_add_u32 m0, s28, 0
    v_mfma_f32_32x32x16_bf16 v[88:103], v[52:55], v[72:75], v[88:103]
    ds_read_b128 v[48:51], v16
    ds_read_b64_tr_b16 v[56:57], v26 offset:8192
    ds_read_b64_tr_b16 v[58:59], v26 offset:9216
    buffer_load_dwordx4 v8, s[8:11], s25 offen lds
    s_waitcnt lgkmcnt(7)
    v_mfma_f32_32x32x16_bf16 v[104:119], v[52:55], v[76:79], v[104:119]
    ds_read_b64_tr_b16 v[60:61], v27 offset:8192
    ds_read_b64_tr_b16 v[62:63], v27 offset:9216
    s_waitcnt lgkmcnt(7)
    s_add_u32 m0, s28, 1024
    v_mfma_f32_32x32x16_bf16 v[120:135], v[52:55], v[80:83], v[120:135]
    ds_read_b64_tr_b16 v[64:65], v28 offset:8192
    ds_read_b64_tr_b16 v[66:67], v28 offset:9216
    buffer_load_dwordx4 v9, s[8:11], s25 offen lds
    s_add_u32 s25, s25, 245760
    s_cmp_eq_u32 s55, 3
    s_cselect_b32 s56, 2457600, 0
    s_sub_u32 s25, s25, s56
    s_waitcnt lgkmcnt(7)
    v_mfma_f32_32x32x16_bf16 v[136:151], v[52:55], v[84:87], v[136:151]
    ds_read_b64_tr_b16 v[68:69], v29 offset:8192
    ds_read_b64_tr_b16 v[70:71], v29 offset:9216
    s_waitcnt lgkmcnt(6)
    v_mfma_f32_32x32x16_bf16 v[88:103], v[48:51], v[56:59], v[88:103]
    ds_read_b128 v[52:55], v17
    ds_read_b64_tr_b16 v[72:73], v26 offset:12288
    ds_read_b64_tr_b16 v[74:75], v26 offset:13312
    s_waitcnt lgkmcnt(7)
    v_mfma_f32_32x32x16_bf16 v[104:119], v[48:51], v[60:63], v[104:119]
    ds_read_b64_tr_b16 v[76:77], v27 offset:12288
    ds_read_b64_tr_b16 v[78:79], v27 offset:13312
    s_waitcnt lgkmcnt(7)
    v_mfma_f32_32x32x16_bf16 v[120:135], v[48:51], v[64:67], v[120:135]
    ds_read_b64_tr_b16 v[80:81], v28 offset:12288
    ds_read_b64_tr_b16 v[82:83], v28 offset:13312
    s_waitcnt lgkmcnt(7)
    v_mfma_f32_32x32x16_bf16 v[136:151], v[48:51], v[68:71], v[136:151]
    ds_read_b64_tr_b16 v[84:85], v29 offset:12288
    ds_read_b64_tr_b16 v[86:87], v29 offset:13312
    s_waitcnt lgkmcnt(6)
    v_mfma_f32_32x32x16_bf16 v[88:103], v[52:55], v[72:75], v[88:103]
    s_waitcnt vmcnt(6) lgkmcnt(0)
    s_barrier
    v_mov_b32 v218, -1
    v_mov_b32 v219, -1
    v_mov_b32 v220, -1
    v_mov_b32 v221, -1
    s_mul_i32 s48, s2, 10240
    s_add_u32 s48, s48, 16777216
    s_add_u32 s49, s48, 8192
    v_lshlrev_b32 v222, 4, v0
    v_lshlrev_b32 v223, 2, v0
    buffer_store_dwordx4 v[218:221], v222, s[12:15], s48 offen sc1
    buffer_store_dword v218, v223, s[12:15], s49 offen sc1
    s_add_u32 m0, s27, 49152
    v_mfma_f32_32x32x16_bf16 v[104:119], v[52:55], v[76:79], v[104:119]
    ds_read_b128 v[48:51], v18
    ds_read_b64_tr_b16 v[56:57], v30 offset:0
    ds_read_b64_tr_b16 v[58:59], v30 offset:1024
    buffer_load_dwordx4 v4, s[4:7], s24 offen lds
    v_mfma_f32_32x32x16_bf16 v[120:135], v[52:55], v[80:83], v[120:135]
    ds_read_b64_tr_b16 v[60:61], v31 offset:0
    ds_read_b64_tr_b16 v[62:63], v31 offset:1024
    s_add_u32 m0, s27, 50176
    v_mfma_f32_32x32x16_bf16 v[136:151], v[52:55], v[84:87], v[136:151]
    ds_read_b64_tr_b16 v[64:65], v32 offset:0
    ds_read_b64_tr_b16 v[66:67], v32 offset:1024
    ds_read_b64_tr_b16 v[68:69], v33 offset:0
    ds_read_b64_tr_b16 v[70:71], v33 offset:1024
    buffer_load_dwordx4 v5, s[4:7], s24 offen lds
    s_waitcnt lgkmcnt(6)
    s_add_u32 m0, s27, 51200
    v_mfma_f32_32x32x16_bf16 v[88:103], v[48:51], v[56:59], v[88:103]
    ds_read_b128 v[52:55], v19
    ds_read_b64_tr_b16 v[72:73], v30 offset:4096
    ds_read_b64_tr_b16 v[74:75], v30 offset:5120
    buffer_load_dwordx4 v6, s[4:7], s24 offen lds
    s_waitcnt lgkmcnt(7)
    v_mfma_f32_32x32x16_bf16 v[104:119], v[48:51], v[60:63], v[104:119]
    ds_read_b64_tr_b16 v[76:77], v31 offset:4096
    ds_read_b64_tr_b16 v[78:79], v31 offset:5120
    s_waitcnt lgkmcnt(7)
    s_add_u32 m0, s27, 52224
    v_mfma_f32_32x32x16_bf16 v[120:135], v[48:51], v[64:67], v[120:135]
    ds_read_b64_tr_b16 v[80:81], v32 offset:4096
    ds_read_b64_tr_b16 v[82:83], v32 offset:5120
    buffer_load_dwordx4 v7, s[4:7], s24 offen lds
    s_add_u32 s24, s24, 128
    s_cmp_eq_u32 s55, 2
    s_cselect_b32 s56, 1280, 0
    s_sub_u32 s24, s24, s56
    s_waitcnt lgkmcnt(7)
    v_mfma_f32_32x32x16_bf16 v[136:151], v[48:51], v[68:71], v[136:151]
    ds_read_b64_tr_b16 v[84:85], v33 offset:4096
    ds_read_b64_tr_b16 v[86:87], v33 offset:5120
    s_waitcnt lgkmcnt(6)
    s_add_u32 m0, s28, 49152
    v_mfma_f32_32x32x16_bf16 v[88:103], v[52:55], v[72:75], v[88:103]
    ds_read_b128 v[48:51], v20
    ds_read_b64_tr_b16 v[56:57], v30 offset:8192
    ds_read_b64_tr_b16 v[58:59], v30 offset:9216
    buffer_load_dwordx4 v8, s[8:11], s25 offen lds
    s_waitcnt lgkmcnt(7)
    v_mfma_f32_32x32x16_bf16 v[104:119], v[52:55], v[76:79], v[104:119]
    ds_read_b64_tr_b16 v[60:61], v31 offset:8192
    ds_read_b64_tr_b16 v[62:63], v31 offset:9216
    s_waitcnt lgkmcnt(7)
    s_add_u32 m0, s28, 50176
    v_mfma_f32_32x32x16_bf16 v[120:135], v[52:55], v[80:83], v[120:135]
    ds_read_b64_tr_b16 v[64:65], v32 offset:8192
    ds_read_b64_tr_b16 v[66:67], v32 offset:9216
    buffer_load_dwordx4 v9, s[8:11], s25 offen lds
    s_add_u32 s25, s25, 245760
    s_cmp_eq_u32 s55, 2
    s_cselect_b32 s56, 2457600, 0
    s_sub_u32 s25, s25, s56
    s_waitcnt lgkmcnt(7)
    v_mfma_f32_32x32x16_bf16 v[136:151], v[52:55], v[84:87], v[136:151]
    ds_read_b64_tr_b16 v[68:69], v33 offset:8192
    ds_read_b64_tr_b16 v[70:71], v33 offset:9216
    s_waitcnt lgkmcnt(6)
    v_mfma_f32_32x32x16_bf16 v[88:103], v[48:51], v[56:59], v[88:103]
    ds_read_b128 v[52:55], v21
    ds_read_b64_tr_b16 v[72:73], v30 offset:12288
    ds_read_b64_tr_b16 v[74:75], v30 offset:13312
    s_waitcnt lgkmcnt(7)
    v_mfma_f32_32x32x16_bf16 v[104:119], v[48:51], v[60:63], v[104:119]
    ds_read_b64_tr_b16 v[76:77], v31 offset:12288
    ds_read_b64_tr_b16 v[78:79], v31 offset:13312
    s_waitcnt lgkmcnt(7)
    v_mfma_f32_32x32x16_bf16 v[120:135], v[48:51], v[64:67], v[120:135]
    ds_read_b64_tr_b16 v[80:81], v32 offset:12288
    ds_read_b64_tr_b16 v[82:83], v32 offset:13312
    s_waitcnt lgkmcnt(7)
    v_mfma_f32_32x32x16_bf16 v[136:151], v[48:51], v[68:71], v[136:151]
    ds_read_b64_tr_b16 v[84:85], v33 offset:12288
    ds_read_b64_tr_b16 v[86:87], v33 offset:13312
    s_waitcnt lgkmcnt(6)
    v_mfma_f32_32x32x16_bf16 v[88:103], v[52:55], v[72:75], v[88:103]
    s_waitcnt vmcnt(6) lgkmcnt(0)
    s_barrier
    s_cmp_lg_u32 s20, 0
    s_cbranch_scc1 p1_kernel_V_nq
    v_lshlrev_b32 v170, 2, v1
    v_lshrrev_b32 v171, 3, v1
    v_cmp_eq_u32 vcc, s21, v171
    v_mov_b32 v173, 0x01010101
    v_and_b32 v171, 7, v1
    v_cndmask_b32 v172, 0, v173, vcc
    s_lshr_b32 s48, s22, 2
    s_and_b32 s49, s22, 3
    s_lshl_b32 s49, s49, 3
    s_lshl_b32 s49, 1, s49
    v_cmp_eq_u32 vcc, s48, v171
    v_mov_b32 v173, s49
    s_nop 0
    v_cndmask_b32 v173, 0, v173, vcc
    v_or_b32 v172, v172, v173
    buffer_load_dword v169, v170, s[76:79], 0 offen sc0 sc1
p1_kernel_V_nq:
    s_add_u32 m0, s27, 98304
    v_mfma_f32_32x32x16_bf16 v[104:119], v[52:55], v[76:79], v[104:119]
    ds_read_b128 v[48:51], v10
    ds_read_b64_tr_b16 v[56:57], v22 offset:0
    ds_read_b64_tr_b16 v[58:59], v22 offset:1024
    buffer_load_dwordx4 v4, s[4:7], s24 offen lds
    v_mfma_f32_32x32x16_bf16 v[120:135], v[52:55], v[80:83], v[120:135]
    ds_read_b64_tr_b16 v[60:61], v23 offset:0
    ds_read_b64_tr_b16 v[62:63], v23 offset:1024
    s_add_u32 m0, s27, 99328
    v_mfma_f32_32x32x16_bf16 v[136:151], v[52:55], v[84:87], v[136:151]
    ds_read_b64_tr_b16 v[64:65], v24 offset:0
    ds_read_b64_tr_b16 v[66:67], v24 offset:1024
    ds_read_b64_tr_b16 v[68:69], v25 offset:0
    ds_read_b64_tr_b16 v[70:71], v25 offset:1024
    buffer_load_dwordx4 v5, s[4:7], s24 offen lds
    s_waitcnt lgkmcnt(6)
    s_add_u32 m0, s27, 100352
    v_mfma_f32_32x32x16_bf16 v[88:103], v[48:51], v[56:59], v[88:103]
    ds_read_b128 v[52:55], v11
    ds_read_b64_tr_b16 v[72:73], v22 offset:4096
    ds_read_b64_tr_b16 v[74:75], v22 offset:5120
    buffer_load_dwordx4 v6, s[4:7], s24 offen lds
    s_waitcnt lgkmcnt(7)
    v_mfma_f32_32x32x16_bf16 v[104:119], v[48:51], v[60:63], v[104:119]
    ds_read_b64_tr_b16 v[76:77], v23 offset:4096
    ds_read_b64_tr_b16 v[78:79], v23 offset:5120
    s_waitcnt lgkmcnt(7)
    s_add_u32 m0, s27, 101376
    v_mfma_f32_32x32x16_bf16 v[120:135], v[48:51], v[64:67], v[120:135]
    ds_read_b64_tr_b16 v[80:81], v24 offset:4096
    ds_read_b64_tr_b16 v[82:83], v24 offset:5120
    buffer_load_dwordx4 v7, s[4:7], s24 offen lds
    s_add_u32 s24, s24, 128
    s_cmp_eq_u32 s55, 1
    s_cselect_b32 s56, 1280, 0
    s_sub_u32 s24, s24, s56
    s_waitcnt lgkmcnt(7)
    v_mfma_f32_32x32x16_bf16 v[136:151], v[48:51], v[68:71], v[136:151]
    ds_read_b64_tr_b16 v[84:85], v25 offset:4096
    ds_read_b64_tr_b16 v[86:87], v25 offset:5120
    s_waitcnt lgkmcnt(6)
    s_add_u32 m0, s28, 98304
    v_mfma_f32_32x32x16_bf16 v[88:103], v[52:55], v[72:75], v[88:103]
    ds_read_b128 v[48:51], v12
    ds_read_b64_tr_b16 v[56:57], v22 offset:8192
    ds_read_b64_tr_b16 v[58:59], v22 offset:9216
    buffer_load_dwordx4 v8, s[8:11], s25 offen lds
    s_waitcnt lgkmcnt(7)
    v_mfma_f32_32x32x16_bf16 v[104:119], v[52:55], v[76:79], v[104:119]
    ds_read_b64_tr_b16 v[60:61], v23 offset:8192
    ds_read_b64_tr_b16 v[62:63], v23 offset:9216
    s_waitcnt lgkmcnt(7)
    s_add_u32 m0, s28, 99328
    v_mfma_f32_32x32x16_bf16 v[120:135], v[52:55], v[80:83], v[120:135]
    ds_read_b64_tr_b16 v[64:65], v24 offset:8192
    ds_read_b64_tr_b16 v[66:67], v24 offset:9216
    buffer_load_dwordx4 v9, s[8:11], s25 offen lds
    s_add_u32 s25, s25, 245760
    s_cmp_eq_u32 s55, 1
    s_cselect_b32 s56, 2457600, 0
    s_sub_u32 s25, s25, s56
    s_waitcnt lgkmcnt(7)
    v_mfma_f32_32x32x16_bf16 v[136:151], v[52:55], v[84:87], v[136:151]
    ds_read_b64_tr_b16 v[68:69], v25 offset:8192
    ds_read_b64_tr_b16 v[70:71], v25 offset:9216
    s_waitcnt lgkmcnt(6)
    v_mfma_f32_32x32x16_bf16 v[88:103], v[48:51], v[56:59], v[88:103]
    ds_read_b128 v[52:55], v13
    ds_read_b64_tr_b16 v[72:73], v22 offset:12288
    ds_read_b64_tr_b16 v[74:75], v22 offset:13312
    s_waitcnt lgkmcnt(7)
    v_mfma_f32_32x32x16_bf16 v[104:119], v[48:51], v[60:63], v[104:119]
    ds_read_b64_tr_b16 v[76:77], v23 offset:12288
    ds_read_b64_tr_b16 v[78:79], v23 offset:13312
    s_waitcnt lgkmcnt(7)
    v_mfma_f32_32x32x16_bf16 v[120:135], v[48:51], v[64:67], v[120:135]
    ds_read_b64_tr_b16 v[80:81], v24 offset:12288
    ds_read_b64_tr_b16 v[82:83], v24 offset:13312
    s_waitcnt lgkmcnt(7)
    v_mfma_f32_32x32x16_bf16 v[136:151], v[48:51], v[68:71], v[136:151]
    ds_read_b64_tr_b16 v[84:85], v25 offset:12288
    ds_read_b64_tr_b16 v[86:87], v25 offset:13312
    s_waitcnt lgkmcnt(6)
    v_mfma_f32_32x32x16_bf16 v[88:103], v[52:55], v[72:75], v[88:103]
    s_waitcnt vmcnt(6) lgkmcnt(0)
    s_cmp_lg_u32 s20, 0
    s_cbranch_scc1 p1_kernel_V_pd
    s_mov_b32 s54, 0
p1_kernel_V_pl:
    v_and_b32 v169, v169, v172
    v_cmp_eq_u32 vcc, v169, v172
    s_add_u32 s54, s54, 1
    s_nop 0
    s_cmp_eq_u64 vcc, -1
    s_cbranch_scc1 p1_kernel_V_pd
    s_cmp_gt_u32 s54, 0x40000
    s_cbranch_scc1 p1_kernel_V_pd
    buffer_load_dword v169, v170, s[76:79], 0 offen sc0 sc1
    s_waitcnt vmcnt(0)
    s_branch p1_kernel_V_pl
p1_kernel_V_pd:
    s_barrier
    s_lshl_b32 s48, s34, 3
    s_add_u32 s48, s48, 24117248
    v_lshlrev_b32 v168, 3, v2
    buffer_load_dwordx2 v[208:209], v168, s[12:15], s48 offen sc0 sc1
    s_cmp_lg_u32 s20, 1
    s_cbranch_scc1 p1_kernel_V_nf
    s_lshl_b32 s48, s22, 12
    s_add_u32 s48, s48, 24182784
    v_lshlrev_b32 v171, 3, v1
    buffer_load_dwordx2 v[210:211], v171, s[12:15], s48 offen offset:0 sc0 sc1
    buffer_load_dwordx2 v[212:213], v171, s[12:15], s48 offen offset:512 sc0 sc1
    buffer_load_dwordx2 v[214:215], v171, s[12:15], s48 offen offset:1024 sc0 sc1
    buffer_load_dwordx2 v[216:217], v171, s[12:15], s48 offen offset:1536 sc0 sc1
    buffer_load_dwordx2 v[218:219], v171, s[12:15], s48 offen offset:2048 sc0 sc1
    buffer_load_dwordx2 v[220:221], v171, s[12:15], s48 offen offset:2560 sc0 sc1
    buffer_load_dwordx2 v[222:223], v171, s[12:15], s48 offen offset:3072 sc0 sc1
    buffer_load_dwordx2 v[224:225], v171, s[12:15], s48 offen offset:3584 sc0 sc1
p1_kernel_V_nf:
    s_add_u32 m0, s27, 0
    v_mfma_f32_32x32x16_bf16 v[104:119], v[52:55], v[76:79], v[104:119]
    ds_read_b128 v[48:51], v14
    ds_read_b64_tr_b16 v[56:57], v26 offset:0
    ds_read_b64_tr_b16 v[58:59], v26 offset:1024
    buffer_load_dwordx4 v4, s[4:7], s24 offen lds
    v_mfma_f32_32x32x16_bf16 v[120:135], v[52:55], v[80:83], v[120:135]
    ds_read_b64_tr_b16 v[60:61], v27 offset:0
    ds_read_b64_tr_b16 v[62:63], v27 offset:1024
    s_add_u32 m0, s27, 1024
    v_mfma_f32_32x32x16_bf16 v[136:151], v[52:55], v[84:87], v[136:151]
    ds_read_b64_tr_b16 v[64:65], v28 offset:0
    ds_read_b64_tr_b16 v[66:67], v28 offset:1024
    ds_read_b64_tr_b16 v[68:69], v29 offset:0
    ds_read_b64_tr_b16 v[70:71], v29 offset:1024
    buffer_load_dwordx4 v5, s[4:7], s24 offen lds
    s_waitcnt lgkmcnt(6)
    s_add_u32 m0, s27, 2048
    v_mfma_f32_32x32x16_bf16 v[88:103], v[48:51], v[56:59], v[88:103]
    ds_read_b128 v[52:55], v15
    ds_read_b64_tr_b16 v[72:73], v26 offset:4096
    ds_read_b64_tr_b16 v[74:75], v26 offset:5120
    buffer_load_dwordx4 v6, s[4:7], s24 offen lds
    s_waitcnt lgkmcnt(7)
    v_mfma_f32_32x32x16_bf16 v[104:119], v[48:51], v[60:63], v[104:119]
    ds_read_b64_tr_b16 v[76:77], v27 offset:4096
    ds_read_b64_tr_b16 v[78:79], v27 offset:5120
    s_waitcnt lgkmcnt(7)
    s_add_u32 m0, s27, 3072
    v_mfma_f32_32x32x16_bf16 v[120:135], v[48:51], v[64:67], v[120:135]
    ds_read_b64_tr_b16 v[80:81], v28 offset:4096
    ds_read_b64_tr_b16 v[82:83], v28 offset:5120
    buffer_load_dwordx4 v7, s[4:7], s24 offen lds
    s_add_u32 s24, s24, 128
    s_cmp_eq_u32 s55, 0
    s_cselect_b32 s56, 1280, 0
    s_sub_u32 s24, s24, s56
    s_waitcnt lgkmcnt(7)
    v_mfma_f32_32x32x16_bf16 v[136:151], v[48:51], v[68:71], v[136:151]
    ds_read_b64_tr_b16 v[84:85], v29 offset:4096
    ds_read_b64_tr_b16 v[86:87], v29 offset:5120
    s_waitcnt lgkmcnt(6)
    s_add_u32 m0, s28, 0
    v_mfma_f32_32x32x16_bf16 v[88:103], v[52:55], v[72:75], v[88:103]
    ds_read_b128 v[48:51], v16
    ds_read_b64_tr_b16 v[56:57], v26 offset:8192
    ds_read_b64_tr_b16 v[58:59], v26 offset:9216
    buffer_load_dwordx4 v8, s[8:11], s25 offen lds
    s_waitcnt lgkmcnt(7)
    v_mfma_f32_32x32x16_bf16 v[104:119], v[52:55], v[76:79], v[104:119]
    ds_read_b64_tr_b16 v[60:61], v27 offset:8192
    ds_read_b64_tr_b16 v[62:63], v27 offset:9216
    s_waitcnt lgkmcnt(7)
    s_add_u32 m0, s28, 1024
    v_mfma_f32_32x32x16_bf16 v[120:135], v[52:55], v[80:83], v[120:135]
    ds_read_b64_tr_b16 v[64:65], v28 offset:8192
    ds_read_b64_tr_b16 v[66:67], v28 offset:9216
    buffer_load_dwordx4 v9, s[8:11], s25 offen lds
    s_add_u32 s25, s25, 245760
    s_cmp_eq_u32 s55, 0
    s_cselect_b32 s56, 2457600, 0
    s_sub_u32 s25, s25, s56
    s_waitcnt lgkmcnt(7)
    v_mfma_f32_32x32x16_bf16 v[136:151], v[52:55], v[84:87], v[136:151]
    ds_read_b64_tr_b16 v[68:69], v29 offset:8192
    ds_read_b64_tr_b16 v[70:71], v29 offset:9216
    s_waitcnt lgkmcnt(6)
    v_mfma_f32_32x32x16_bf16 v[88:103], v[48:51], v[56:59], v[88:103]
    ds_read_b128 v[52:55], v17
    ds_read_b64_tr_b16 v[72:73], v26 offset:12288
    ds_read_b64_tr_b16 v[74:75], v26 offset:13312
    s_waitcnt lgkmcnt(7)
    v_mfma_f32_32x32x16_bf16 v[104:119], v[48:51], v[60:63], v[104:119]
    ds_read_b64_tr_b16 v[76:77], v27 offset:12288
    ds_read_b64_tr_b16 v[78:79], v27 offset:13312
    s_waitcnt lgkmcnt(7)
    v_mfma_f32_32x32x16_bf16 v[120:135], v[48:51], v[64:67], v[120:135]
    ds_read_b64_tr_b16 v[80:81], v28 offset:12288
    ds_read_b64_tr_b16 v[82:83], v28 offset:13312
    s_waitcnt lgkmcnt(7)
    v_mfma_f32_32x32x16_bf16 v[136:151], v[48:51], v[68:71], v[136:151]
    ds_read_b64_tr_b16 v[84:85], v29 offset:12288
    ds_read_b64_tr_b16 v[86:87], v29 offset:13312
    s_waitcnt lgkmcnt(6)
    v_mfma_f32_32x32x16_bf16 v[88:103], v[52:55], v[72:75], v[88:103]
    s_waitcnt vmcnt(6) lgkmcnt(0)
    s_barrier
    v_mfma_f32_32x32x16_bf16 v[104:119], v[52:55], v[76:79], v[104:119]
    ds_read_b128 v[48:51], v18
    ds_read_b64_tr_b16 v[56:57], v30 offset:0
    ds_read_b64_tr_b16 v[58:59], v30 offset:1024
    v_mfma_f32_32x32x16_bf16 v[120:135], v[52:55], v[80:83], v[120:135]
    ds_read_b64_tr_b16 v[60:61], v31 offset:0
    ds_read_b64_tr_b16 v[62:63], v31 offset:1024
    v_mfma_f32_32x32x16_bf16 v[136:151], v[52:55], v[84:87], v[136:151]
    ds_read_b64_tr_b16 v[64:65], v32 offset:0
    ds_read_b64_tr_b16 v[66:67], v32 offset:1024
    ds_read_b64_tr_b16 v[68:69], v33 offset:0
    ds_read_b64_tr_b16 v[70:71], v33 offset:1024
    s_waitcnt lgkmcnt(6)
    v_mfma_f32_32x32x16_bf16 v[88:103], v[48:51], v[56:59], v[88:103]
    ds_read_b128 v[52:55], v19
    ds_read_b64_tr_b16 v[72:73], v30 offset:4096
    ds_read_b64_tr_b16 v[74:75], v30 offset:5120
    s_waitcnt lgkmcnt(7)
    v_mfma_f32_32x32x16_bf16 v[104:119], v[48:51], v[60:63], v[104:119]
    ds_read_b64_tr_b16 v[76:77], v31 offset:4096
    ds_read_b64_tr_b16 v[78:79], v31 offset:5120
    s_waitcnt lgkmcnt(7)
    v_mfma_f32_32x32x16_bf16 v[120:135], v[48:51], v[64:67], v[120:135]
    ds_read_b64_tr_b16 v[80:81], v32 offset:4096
    ds_read_b64_tr_b16 v[82:83], v32 offset:5120
    s_waitcnt lgkmcnt(7)
    v_mfma_f32_32x32x16_bf16 v[136:151], v[48:51], v[68:71], v[136:151]
    ds_read_b64_tr_b16 v[84:85], v33 offset:4096
    ds_read_b64_tr_b16 v[86:87], v33 offset:5120
    s_waitcnt lgkmcnt(6)
    v_mfma_f32_32x32x16_bf16 v[88:103], v[52:55], v[72:75], v[88:103]
    ds_read_b128 v[48:51], v20
    ds_read_b64_tr_b16 v[56:57], v30 offset:8192
    ds_read_b64_tr_b16 v[58:59], v30 offset:9216
    s_waitcnt lgkmcnt(7)
    v_mfma_f32_32x32x16_bf16 v[104:119], v[52:55], v[76:79], v[104:119]
    ds_read_b64_tr_b16 v[60:61], v31 offset:8192
    ds_read_b64_tr_b16 v[62:63], v31 offset:9216
    s_waitcnt lgkmcnt(7)
    v_mfma_f32_32x32x16_bf16 v[120:135], v[52:55], v[80:83], v[120:135]
    ds_read_b64_tr_b16 v[64:65], v32 offset:8192
    ds_read_b64_tr_b16 v[66:67], v32 offset:9216
    s_waitcnt lgkmcnt(7)
    v_mfma_f32_32x32x16_bf16 v[136:151], v[52:55], v[84:87], v[136:151]
    ds_read_b64_tr_b16 v[68:69], v33 offset:8192
    ds_read_b64_tr_b16 v[70:71], v33 offset:9216
    s_waitcnt lgkmcnt(6)
    v_mfma_f32_32x32x16_bf16 v[88:103], v[48:51], v[56:59], v[88:103]
    ds_read_b128 v[52:55], v21
    ds_read_b64_tr_b16 v[72:73], v30 offset:12288
    ds_read_b64_tr_b16 v[74:75], v30 offset:13312
    s_waitcnt lgkmcnt(7)
    v_mfma_f32_32x32x16_bf16 v[104:119], v[48:51], v[60:63], v[104:119]
    ds_read_b64_tr_b16 v[76:77], v31 offset:12288
    ds_read_b64_tr_b16 v[78:79], v31 offset:13312
    s_waitcnt lgkmcnt(7)
    v_mfma_f32_32x32x16_bf16 v[120:135], v[48:51], v[64:67], v[120:135]
    ds_read_b64_tr_b16 v[80:81], v32 offset:12288
    ds_read_b64_tr_b16 v[82:83], v32 offset:13312
    s_waitcnt lgkmcnt(7)
    v_mfma_f32_32x32x16_bf16 v[136:151], v[48:51], v[68:71], v[136:151]
    ds_read_b64_tr_b16 v[84:85], v33 offset:12288
    ds_read_b64_tr_b16 v[86:87], v33 offset:13312
    s_waitcnt lgkmcnt(6)
    v_mfma_f32_32x32x16_bf16 v[88:103], v[52:55], v[72:75], v[88:103]
    s_waitcnt vmcnt(0) lgkmcnt(0)
    s_barrier
    v_mfma_f32_32x32x16_bf16 v[104:119], v[52:55], v[76:79], v[104:119]
    ds_read_b128 v[48:51], v10
    ds_read_b64_tr_b16 v[56:57], v22 offset:0
    ds_read_b64_tr_b16 v[58:59], v22 offset:1024
    v_mfma_f32_32x32x16_bf16 v[120:135], v[52:55], v[80:83], v[120:135]
    ds_read_b64_tr_b16 v[60:61], v23 offset:0
    ds_read_b64_tr_b16 v[62:63], v23 offset:1024
    v_mfma_f32_32x32x16_bf16 v[136:151], v[52:55], v[84:87], v[136:151]
    ds_read_b64_tr_b16 v[64:65], v24 offset:0
    ds_read_b64_tr_b16 v[66:67], v24 offset:1024
    ds_read_b64_tr_b16 v[68:69], v25 offset:0
    ds_read_b64_tr_b16 v[70:71], v25 offset:1024
    s_waitcnt lgkmcnt(6)
    v_mfma_f32_32x32x16_bf16 v[88:103], v[48:51], v[56:59], v[88:103]
    ds_read_b128 v[52:55], v11
    ds_read_b64_tr_b16 v[72:73], v22 offset:4096
    ds_read_b64_tr_b16 v[74:75], v22 offset:5120
    s_waitcnt lgkmcnt(7)
    v_mfma_f32_32x32x16_bf16 v[104:119], v[48:51], v[60:63], v[104:119]
    ds_read_b64_tr_b16 v[76:77], v23 offset:4096
    ds_read_b64_tr_b16 v[78:79], v23 offset:5120
    s_waitcnt lgkmcnt(7)
    v_mfma_f32_32x32x16_bf16 v[120:135], v[48:51], v[64:67], v[120:135]
    ds_read_b64_tr_b16 v[80:81], v24 offset:4096
    ds_read_b64_tr_b16 v[82:83], v24 offset:5120
    s_waitcnt lgkmcnt(7)
    v_mfma_f32_32x32x16_bf16 v[136:151], v[48:51], v[68:71], v[136:151]
    ds_read_b64_tr_b16 v[84:85], v25 offset:4096
    ds_read_b64_tr_b16 v[86:87], v25 offset:5120
    s_waitcnt lgkmcnt(6)
    v_mfma_f32_32x32x16_bf16 v[88:103], v[52:55], v[72:75], v[88:103]
    ds_read_b128 v[48:51], v12
    ds_read_b64_tr_b16 v[56:57], v22 offset:8192
    ds_read_b64_tr_b16 v[58:59], v22 offset:9216
    s_waitcnt lgkmcnt(7)
    v_mfma_f32_32x32x16_bf16 v[104:119], v[52:55], v[76:79], v[104:119]
    ds_read_b64_tr_b16 v[60:61], v23 offset:8192
    ds_read_b64_tr_b16 v[62:63], v23 offset:9216
    s_waitcnt lgkmcnt(7)
    v_mfma_f32_32x32x16_bf16 v[120:135], v[52:55], v[80:83], v[120:135]
    ds_read_b64_tr_b16 v[64:65], v24 offset:8192
    ds_read_b64_tr_b16 v[66:67], v24 offset:9216
    s_waitcnt lgkmcnt(7)
    v_mfma_f32_32x32x16_bf16 v[136:151], v[52:55], v[84:87], v[136:151]
    ds_read_b64_tr_b16 v[68:69], v25 offset:8192
    ds_read_b64_tr_b16 v[70:71], v25 offset:9216
    s_waitcnt lgkmcnt(6)
    v_mfma_f32_32x32x16_bf16 v[88:103], v[48:51], v[56:59], v[88:103]
    ds_read_b128 v[52:55], v13
    ds_read_b64_tr_b16 v[72:73], v22 offset:12288
    ds_read_b64_tr_b16 v[74:75], v22 offset:13312
    s_waitcnt lgkmcnt(7)
    v_mfma_f32_32x32x16_bf16 v[104:119], v[48:51], v[60:63], v[104:119]
    ds_read_b64_tr_b16 v[76:77], v23 offset:12288
    ds_read_b64_tr_b16 v[78:79], v23 offset:13312
    s_waitcnt lgkmcnt(7)
    v_mfma_f32_32x32x16_bf16 v[120:135], v[48:51], v[64:67], v[120:135]
    ds_read_b64_tr_b16 v[80:81], v24 offset:12288
    ds_read_b64_tr_b16 v[82:83], v24 offset:13312
    s_waitcnt lgkmcnt(7)
    v_mfma_f32_32x32x16_bf16 v[136:151], v[48:51], v[68:71], v[136:151]
    ds_read_b64_tr_b16 v[84:85], v25 offset:12288
    ds_read_b64_tr_b16 v[86:87], v25 offset:13312
    s_waitcnt lgkmcnt(6)
    v_mfma_f32_32x32x16_bf16 v[88:103], v[52:55], v[72:75], v[88:103]
    s_waitcnt lgkmcnt(4)
    v_mfma_f32_32x32x16_bf16 v[104:119], v[52:55], v[76:79], v[104:119]
    s_waitcnt lgkmcnt(2)
    v_mfma_f32_32x32x16_bf16 v[120:135], v[52:55], v[80:83], v[120:135]
    s_waitcnt lgkmcnt(0)
    v_mfma_f32_32x32x16_bf16 v[136:151], v[52:55], v[84:87], v[136:151]
    s_waitcnt vmcnt(0)
    s_cmp_lg_u32 s20, 1
    s_cbranch_scc1 p1_kernel_V_nt
    v_pk_add_f32 v[210:211], v[210:211], v[212:213]
    v_pk_add_f32 v[210:211], v[210:211], v[214:215]
    v_pk_add_f32 v[210:211], v[210:211], v[216:217]
    v_pk_add_f32 v[210:211], v[210:211], v[218:219]
    v_pk_add_f32 v[210:211], v[210:211], v[220:221]
    v_pk_add_f32 v[210:211], v[210:211], v[222:223]
    v_pk_add_f32 v[210:211], v[210:211], v[224:225]
    v_add_u32 v171, 152064, v171
    ds_write_b64 v171, v[210:211]
p1_kernel_V_nt:
    v_mul_f32 v208, 0x3acccccd, v208
    v_mul_f32 v209, 0x3acccccd, v209
    v_fma_f32 v209, -v208, v208, v209
    v_max_f32 v209, 0, v209
    v_add_f32 v35, 0x3727c5ac, v209
    v_rsq_f32 v42, v35
    s_nop 0
    v_mul_f32 v44, v208, v42
    v_sub_f32 v44, 0, v44
    v_mov_b32 v43, v42
    v_mov_b32 v45, v44
    s_lshl_b32 s48, s20, 8
    s_add_u32 s48, s48, 153088
    v_lshl_add_u32 v35, v2, 2, s48
    ds_write_b32 v35, v42
    ds_write_b32 v35, v44 offset:128
    v_lshl_add_u32 v35, v3, 4, s48
    s_waitcnt lgkmcnt(0)
    s_barrier
    ds_read_b128 v[152:155], v35 offset:0
    ds_read_b128 v[168:171], v35 offset:128
    ds_read_b128 v[156:159], v35 offset:32
    ds_read_b128 v[172:175], v35 offset:160
    ds_read_b128 v[160:163], v35 offset:64
    ds_read_b128 v[176:179], v35 offset:192
    ds_read_b128 v[164:167], v35 offset:96
    ds_read_b128 v[180:183], v35 offset:224
    v_lshlrev_b32 v36, 2, v2
    v_add_u32 v36, 152064, v36
    s_lshl_b32 s50, s29, 7
    v_add_u32 v37, s50, v36
    ds_read_b32 v184, v37
    s_lshl_b32 s50, s30, 7
    v_add_u32 v37, s50, v36
    ds_read_b32 v186, v37
    s_lshl_b32 s50, s31, 7
    v_add_u32 v37, s50, v36
    ds_read_b32 v188, v37
    s_lshl_b32 s50, s32, 7
    v_add_u32 v37, s50, v36
    ds_read_b32 v190, v37
    s_mul_i32 s49, s34, 40
    s_add_u32 s49, s49, 6291456
    s_mov_b32 s52, 80640
    s_sub_u32 s48, s33, 1280
    v_and_b32 v37, 15, v2
    v_add_u32 v37, s48, v37
    v_lshrrev_b32 v38, 4, v2
    v_lshlrev_b32 v38, 5, v38
    v_lshl_add_u32 v38, v3, 4, v38
    v_add_u32 v34, 0, v37
    v_mul_u32_u24 v35, 3277, v34
    v_lshrrev_b32 v35, 16, v35
    v_lshl_add_u32 v34, v34, 6, v38
    v_mad_u32_u24 v10, v35, s52, v34
    v_add_u32 v34, 16, v37
    v_mul_u32_u24 v35, 3277, v34
    v_lshrrev_b32 v35, 16, v35
    v_lshl_add_u32 v34, v34, 6, v38
    v_mad_u32_u24 v11, v35, s52, v34
    v_add_u32 v34, 32, v37
    v_mul_u32_u24 v35, 3277, v34
    v_lshrrev_b32 v35, 16, v35
    v_lshl_add_u32 v34, v34, 6, v38
    v_mad_u32_u24 v12, v35, s52, v34
    v_add_u32 v34, 48, v37
    v_mul_u32_u24 v35, 3277, v34
    v_lshrrev_b32 v35, 16, v35
    v_lshl_add_u32 v34, v34, 6, v38
    v_mad_u32_u24 v13, v35, s52, v34
    v_add_u32 v34, 64, v37
    v_mul_u32_u24 v35, 3277, v34
    v_lshrrev_b32 v35, 16, v35
    v_lshl_add_u32 v34, v34, 6, v38
    v_mad_u32_u24 v14, v35, s52, v34
    v_add_u32 v34, 80, v37
    v_mul_u32_u24 v35, 3277, v34
    v_lshrrev_b32 v35, 16, v35
    v_lshl_add_u32 v34, v34, 6, v38
    v_mad_u32_u24 v15, v35, s52, v34
    v_add_u32 v34, 96, v37
    v_mul_u32_u24 v35, 3277, v34
    v_lshrrev_b32 v35, 16, v35
    v_lshl_add_u32 v34, v34, 6, v38
    v_mad_u32_u24 v16, v35, s52, v34
    v_add_u32 v34, 112, v37
    v_mul_u32_u24 v35, 3277, v34
    v_lshrrev_b32 v35, 16, v35
    v_lshl_add_u32 v34, v34, 6, v38
    v_mad_u32_u24 v17, v35, s52, v34
    s_waitcnt lgkmcnt(0)
    v_mov_b32 v185, v184
    v_pk_mul_f32 v[88:89], v[88:89], v[152:153]
    v_pk_fma_f32 v[88:89], v[168:169], v[184:185], v[88:89]
    v_pk_mul_f32 v[90:91], v[90:91], v[154:155]
    v_pk_fma_f32 v[90:91], v[170:171], v[184:185], v[90:91]
    v_pk_mul_f32 v[92:93], v[92:93], v[156:157]
    v_pk_fma_f32 v[92:93], v[172:173], v[184:185], v[92:93]
    v_pk_mul_f32 v[94:95], v[94:95], v[158:159]
    v_pk_fma_f32 v[94:95], v[174:175], v[184:185], v[94:95]
    v_pk_mul_f32 v[96:97], v[96:97], v[160:161]
    v_pk_fma_f32 v[96:97], v[176:177], v[184:185], v[96:97]
    v_pk_mul_f32 v[98:99], v[98:99], v[162:163]
    v_pk_fma_f32 v[98:99], v[178:179], v[184:185], v[98:99]
    v_pk_mul_f32 v[100:101], v[100:101], v[164:165]
    v_pk_fma_f32 v[100:101], v[180:181], v[184:185], v[100:101]
    v_pk_mul_f32 v[102:103], v[102:103], v[166:167]
    v_pk_fma_f32 v[102:103], v[182:183], v[184:185], v[102:103]
    v_cvt_pk_bf16_f32 v192, v88, v89
    v_cvt_pk_bf16_f32 v193, v90, v91
    v_cvt_pk_bf16_f32 v194, v92, v93
    v_cvt_pk_bf16_f32 v195, v94, v95
    v_cvt_pk_bf16_f32 v196, v96, v97
    v_cvt_pk_bf16_f32 v197, v98, v99
    v_cvt_pk_bf16_f32 v198, v100, v101
    v_cvt_pk_bf16_f32 v199, v102, v103
    s_nop 1
    v_permlane16_swap_b32 v192, v196
    v_permlane16_swap_b32 v193, v197
    v_permlane16_swap_b32 v194, v198
    v_permlane16_swap_b32 v195, v199
    buffer_store_dwordx4 v[192:195], v10, s[12:15], s49 offen sc1
    buffer_store_dwordx4 v[196:199], v11, s[12:15], s49 offen sc1
    v_mov_b32 v187, v186
    v_pk_mul_f32 v[104:105], v[104:105], v[152:153]
    v_pk_fma_f32 v[104:105], v[168:169], v[186:187], v[104:105]
    v_pk_mul_f32 v[106:107], v[106:107], v[154:155]
    v_pk_fma_f32 v[106:107], v[170:171], v[186:187], v[106:107]
    v_pk_mul_f32 v[108:109], v[108:109], v[156:157]
    v_pk_fma_f32 v[108:109], v[172:173], v[186:187], v[108:109]
    v_pk_mul_f32 v[110:111], v[110:111], v[158:159]
    v_pk_fma_f32 v[110:111], v[174:175], v[186:187], v[110:111]
    v_pk_mul_f32 v[112:113], v[112:113], v[160:161]
    v_pk_fma_f32 v[112:113], v[176:177], v[186:187], v[112:113]
    v_pk_mul_f32 v[114:115], v[114:115], v[162:163]
    v_pk_fma_f32 v[114:115], v[178:179], v[186:187], v[114:115]
    v_pk_mul_f32 v[116:117], v[116:117], v[164:165]
    v_pk_fma_f32 v[116:117], v[180:181], v[186:187], v[116:117]
    v_pk_mul_f32 v[118:119], v[118:119], v[166:167]
    v_pk_fma_f32 v[118:119], v[182:183], v[186:187], v[118:119]
    v_cvt_pk_bf16_f32 v200, v104, v105
    v_cvt_pk_bf16_f32 v201, v106, v107
    v_cvt_pk_bf16_f32 v202, v108, v109
    v_cvt_pk_bf16_f32 v203, v110, v111
    v_cvt_pk_bf16_f32 v204, v112, v113
    v_cvt_pk_bf16_f32 v205, v114, v115
    v_cvt_pk_bf16_f32 v206, v116, v117
    v_cvt_pk_bf16_f32 v207, v118, v119
    s_nop 1
    v_permlane16_swap_b32 v200, v204
    v_permlane16_swap_b32 v201, v205
    v_permlane16_swap_b32 v202, v206
    v_permlane16_swap_b32 v203, v207
    buffer_store_dwordx4 v[200:203], v12, s[12:15], s49 offen sc1
    buffer_store_dwordx4 v[204:207], v13, s[12:15], s49 offen sc1
    v_mov_b32 v189, v188
    v_pk_mul_f32 v[120:121], v[120:121], v[152:153]
    v_pk_fma_f32 v[120:121], v[168:169], v[188:189], v[120:121]
    v_pk_mul_f32 v[122:123], v[122:123], v[154:155]
    v_pk_fma_f32 v[122:123], v[170:171], v[188:189], v[122:123]
    v_pk_mul_f32 v[124:125], v[124:125], v[156:157]
    v_pk_fma_f32 v[124:125], v[172:173], v[188:189], v[124:125]
    v_pk_mul_f32 v[126:127], v[126:127], v[158:159]
    v_pk_fma_f32 v[126:127], v[174:175], v[188:189], v[126:127]
    v_pk_mul_f32 v[128:129], v[128:129], v[160:161]
    v_pk_fma_f32 v[128:129], v[176:177], v[188:189], v[128:129]
    v_pk_mul_f32 v[130:131], v[130:131], v[162:163]
    v_pk_fma_f32 v[130:131], v[178:179], v[188:189], v[130:131]
    v_pk_mul_f32 v[132:133], v[132:133], v[164:165]
    v_pk_fma_f32 v[132:133], v[180:181], v[188:189], v[132:133]
    v_pk_mul_f32 v[134:135], v[134:135], v[166:167]
    v_pk_fma_f32 v[134:135], v[182:183], v[188:189], v[134:135]
    v_cvt_pk_bf16_f32 v192, v120, v121
    v_cvt_pk_bf16_f32 v193, v122, v123
    v_cvt_pk_bf16_f32 v194, v124, v125
    v_cvt_pk_bf16_f32 v195, v126, v127
    v_cvt_pk_bf16_f32 v196, v128, v129
    v_cvt_pk_bf16_f32 v197, v130, v131
    v_cvt_pk_bf16_f32 v198, v132, v133
    v_cvt_pk_bf16_f32 v199, v134, v135
    s_nop 1
    v_permlane16_swap_b32 v192, v196
    v_permlane16_swap_b32 v193, v197
    v_permlane16_swap_b32 v194, v198
    v_permlane16_swap_b32 v195, v199
    buffer_store_dwordx4 v[192:195], v14, s[12:15], s49 offen sc1
    buffer_store_dwordx4 v[196:199], v15, s[12:15], s49 offen sc1
    v_mov_b32 v191, v190
    v_pk_mul_f32 v[136:137], v[136:137], v[152:153]
    v_pk_fma_f32 v[136:137], v[168:169], v[190:191], v[136:137]
    v_pk_mul_f32 v[138:139], v[138:139], v[154:155]
    v_pk_fma_f32 v[138:139], v[170:171], v[190:191], v[138:139]
    v_pk_mul_f32 v[140:141], v[140:141], v[156:157]
    v_pk_fma_f32 v[140:141], v[172:173], v[190:191], v[140:141]
    v_pk_mul_f32 v[142:143], v[142:143], v[158:159]
    v_pk_fma_f32 v[142:143], v[174:175], v[190:191], v[142:143]
    v_pk_mul_f32 v[144:145], v[144:145], v[160:161]
    v_pk_fma_f32 v[144:145], v[176:177], v[190:191], v[144:145]
    v_pk_mul_f32 v[146:147], v[146:147], v[162:163]
    v_pk_fma_f32 v[146:147], v[178:179], v[190:191], v[146:147]
    v_pk_mul_f32 v[148:149], v[148:149], v[164:165]
    v_pk_fma_f32 v[148:149], v[180:181], v[190:191], v[148:149]
    v_pk_mul_f32 v[150:151], v[150:151], v[166:167]
    v_pk_fma_f32 v[150:151], v[182:183], v[190:191], v[150:151]
    v_cvt_pk_bf16_f32 v200, v136, v137
    v_cvt_pk_bf16_f32 v201, v138, v139
    v_cvt_pk_bf16_f32 v202, v140, v141
    v_cvt_pk_bf16_f32 v203, v142, v143
    v_cvt_pk_bf16_f32 v204, v144, v145
    v_cvt_pk_bf16_f32 v205, v146, v147
    v_cvt_pk_bf16_f32 v206, v148, v149
    v_cvt_pk_bf16_f32 v207, v150, v151
    s_nop 1
    v_permlane16_swap_b32 v200, v204
    v_permlane16_swap_b32 v201, v205
    v_permlane16_swap_b32 v202, v206
    v_permlane16_swap_b32 v203, v207
    buffer_store_dwordx4 v[200:203], v16, s[12:15], s49 offen sc1
    buffer_store_dwordx4 v[204:207], v17, s[12:15], s49 offen sc1
    s_endpgm
p1_kernel_F:
    s_mov_b32 s8, s40
    s_and_b32 s9, s41, 0xffff
    s_mov_b32 s10, 0x1e0000
    s_mov_b32 s11, 0x00020000
    s_sub_u32 s48, s22, 15
    s_mul_i32 s33, s48, 96
    s_mov_b32 s29, 0
    s_mov_b32 s30, 1
    s_mov_b32 s31, 2
    v_add_u32 v34, 0, v1
    v_mul_u32_u24 v35, 171, v34
    v_lshrrev_b32 v35, 11, v35
    v_mul_u32_u24 v36, 12, v35
    v_sub_u32 v36, v34, v36
    v_mul_u32_u24 v35, 3072, v35
    v_lshl_add_u32 v8, v36, 4, v35
    v_add_u32 v34, 64, v1
    v_mul_u32_u24 v35, 171, v34
    v_lshrrev_b32 v35, 11, v35
    v_mul_u32_u24 v36, 12, v35
    v_sub_u32 v36, v34, v36
    v_mul_u32_u24 v35, 3072, v35
    v_lshl_add_u32 v9, v36, 4, v35
    s_mul_i32 s28, s20, 1536
    s_add_u32 s28, s28, 32768
    s_mul_i32 s25, s20, 24576
    s_lshl_b32 s48, s33, 1
    s_add_u32 s25, s25, s48
    s_and_b32 s55, s22, 7
    s_and_b32 s56, s21, 3
    s_mul_i32 s56, s56, 3
    s_add_u32 s55, s55, s56
    s_cmp_ge_u32 s55, 10
    s_cselect_b32 s56, 10, 0
    s_sub_u32 s55, s55, s56
    s_lshl_b32 s56, s55, 7
    s_add_u32 s24, s24, s56
    s_mul_i32 s56, s55, 196608
    s_add_u32 s25, s25, s56
    buffer_load_dwordx4 v[152:155], v182, s[4:7], s53 offen
    buffer_load_dword v156, v183, s[4:7], s53 offen offset:1024
    s_mul_i32 s48, s21, 80
    s_mul_i32 s49, s20, 10
    s_add_u32 s48, s48, s49
    s_mul_i32 s48, s48, 3072
    s_lshl_b32 s49, s33, 1
    s_add_u32 s48, s48, s49
    buffer_load_dword v158, v183, s[8:11], s48 offen
    s_add_u32 s48, s48, 3072
    buffer_load_dword v159, v183, s[8:11], s48 offen
    s_add_u32 s48, s48, 3072
    buffer_load_dword v160, v183, s[8:11], s48 offen
    s_add_u32 s48, s48, 3072
    buffer_load_dword v161, v183, s[8:11], s48 offen
    s_add_u32 s48, s48, 3072
    buffer_load_dword v162, v183, s[8:11], s48 offen
    s_add_u32 s48, s48, 3072
    buffer_load_dword v163, v183, s[8:11], s48 offen
    s_add_u32 s48, s48, 3072
    buffer_load_dword v164, v183, s[8:11], s48 offen
    s_add_u32 s48, s48, 3072
    buffer_load_dword v165, v183, s[8:11], s48 offen
    s_add_u32 s48, s48, 3072
    buffer_load_dword v166, v183, s[8:11], s48 offen
    s_add_u32 s48, s48, 3072
    buffer_load_dword v167, v183, s[8:11], s48 offen
    s_add_u32 s48, s48, 3072
    buffer_load_dword v157, v183, s[16:19], s49 offen
    s_add_u32 m0, s27, 0
    s_nop 0
    buffer_load_dwordx4 v4, s[4:7], s24 offen lds
    s_add_u32 m0, s27, 1024
    s_nop 0
    buffer_load_dwordx4 v5, s[4:7], s24 offen lds
    s_add_u32 m0, s27, 2048
    s_nop 0
    buffer_load_dwordx4 v6, s[4:7], s24 offen lds
    s_add_u32 m0, s27, 3072
    s_nop 0
    buffer_load_dwordx4 v7, s[4:7], s24 offen lds
    s_add_u32 s24, s24, 128
    s_cmp_eq_u32 s55, 9
    s_cselect_b32 s56, 1280, 0
    s_sub_u32 s24, s24, s56
    s_add_u32 m0, s28, 0
    s_nop 0
    buffer_load_dwordx4 v8, s[8:11], s25 offen lds
    s_add_u32 m0, s28, 1024
    s_nop 0
    s_mov_b64 exec, s[44:45]
    buffer_load_dwordx4 v9, s[8:11], s25 offen lds
    s_mov_b64 exec, -1
    s_add_u32 s25, s25, 196608
    s_cmp_eq_u32 s55, 9
    s_cselect_b32 s56, 1966080, 0
    s_sub_u32 s25, s25, s56
    s_add_u32 m0, s27, 49152
    s_nop 0
    buffer_load_dwordx4 v4, s[4:7], s24 offen lds
    s_add_u32 m0, s27, 50176
    s_nop 0
    buffer_load_dwordx4 v5, s[4:7], s24 offen lds
    s_add_u32 m0, s27, 51200
    s_nop 0
    buffer_load_dwordx4 v6, s[4:7], s24 offen lds
    s_add_u32 m0, s27, 52224
    s_nop 0
    buffer_load_dwordx4 v7, s[4:7], s24 offen lds
    s_add_u32 s24, s24, 128
    s_cmp_eq_u32 s55, 8
    s_cselect_b32 s56, 1280, 0
    s_sub_u32 s24, s24, s56
    s_add_u32 m0, s28, 49152
    s_nop 0
    buffer_load_dwordx4 v8, s[8:11], s25 offen lds
    s_add_u32 m0, s28, 50176
    s_nop 0
    s_mov_b64 exec, s[44:45]
    buffer_load_dwordx4 v9, s[8:11], s25 offen lds
    s_mov_b64 exec, -1
    s_add_u32 s25, s25, 196608
    s_cmp_eq_u32 s55, 8
    s_cselect_b32 s56, 1966080, 0
    s_sub_u32 s25, s25, s56
    v_lshrrev_b32 v34, 1, v2
    v_and_b32 v34, 7, v34
    s_lshl_b32 s48, s20, 12
    v_lshlrev_b32 v35, 7, v2
    v_add_u32 v35, s48, v35
    v_add_u32 v36, 0, v3
    v_xor_b32 v36, v36, v34
    v_lshl_add_u32 v10, v36, 4, v35
    v_add_u32 v14, 49152, v10
    v_add_u32 v18, 98304, v10
    v_add_u32 v36, 2, v3
    v_xor_b32 v36, v36, v34
    v_lshl_add_u32 v11, v36, 4, v35
    v_add_u32 v15, 49152, v11
    v_add_u32 v19, 98304, v11
    v_add_u32 v36, 4, v3
    v_xor_b32 v36, v36, v34
    v_lshl_add_u32 v12, v36, 4, v35
    v_add_u32 v16, 49152, v12
    v_add_u32 v20, 98304, v12
    v_add_u32 v36, 6, v3
    v_xor_b32 v36, v36, v34
    v_lshl_add_u32 v13, v36, 4, v35
    v_add_u32 v17, 49152, v13
    v_add_u32 v21, 98304, v13
    v_bfe_u32 v34, v1, 2, 2
    v_and_b32 v35, 3, v1
    v_bfe_u32 v36, v1, 4, 1
    v_lshl_add_u32 v37, v3, 3, v34
    v_mul_u32_u24 v37, 192, v37
    v_lshl_add_u32 v37, v36, 5, v37
    v_lshl_add_u32 v37, v35, 3, v37
    v_add_u32 v37, 32768, v37
    s_lshl_b32 s48, s29, 6
    v_add_u32 v22, s48, v37
    v_add_u32 v26, 49152, v22
    v_add_u32 v30, 98304, v22
    s_lshl_b32 s48, s30, 6
    v_add_u32 v23, s48, v37
    v_add_u32 v27, 49152, v23
    v_add_u32 v31, 98304, v23
    s_lshl_b32 s48, s31, 6
    v_add_u32 v24, s48, v37
    v_add_u32 v28, 49152, v24
    v_add_u32 v32, 98304, v24
    v_mov_b32 v88, 0
    v_mov_b32 v89, 0
    v_mov_b32 v90, 0
    v_mov_b32 v91, 0
    v_mov_b32 v92, 0
    v_mov_b32 v93, 0
    v_mov_b32 v94, 0
    v_mov_b32 v95, 0
    v_mov_b32 v96, 0
    v_mov_b32 v97, 0
    v_mov_b32 v98, 0
    v_mov_b32 v99, 0
    v_mov_b32 v100, 0
    v_mov_b32 v101, 0
    v_mov_b32 v102, 0
    v_mov_b32 v103, 0
    v_mov_b32 v104, 0
    v_mov_b32 v105, 0
    v_mov_b32 v106, 0
    v_mov_b32 v107, 0
    v_mov_b32 v108, 0
    v_mov_b32 v109, 0
    v_mov_b32 v110, 0
    v_mov_b32 v111, 0
    v_mov_b32 v112, 0
    v_mov_b32 v113, 0
    v_mov_b32 v114, 0
    v_mov_b32 v115, 0
    v_mov_b32 v116, 0
    v_mov_b32 v117, 0
    v_mov_b32 v118, 0
    v_mov_b32 v119, 0
    v_mov_b32 v120, 0
    v_mov_b32 v121, 0
    v_mov_b32 v122, 0
    v_mov_b32 v123, 0
    v_mov_b32 v124, 0
    v_mov_b32 v125, 0
    v_mov_b32 v126, 0
    v_mov_b32 v127, 0
    v_mov_b32 v128, 0
    v_mov_b32 v129, 0
    v_mov_b32 v130, 0
    v_mov_b32 v131, 0
    v_mov_b32 v132, 0
    v_mov_b32 v133, 0
    v_mov_b32 v134, 0
    v_mov_b32 v135, 0
    s_waitcnt vmcnt(12)
    v_and_b32 v168, 0xffff0000, v152
    v_lshlrev_b32 v169, 16, v152
    v_and_b32 v170, 0xffff0000, v153
    v_lshlrev_b32 v171, 16, v153
    v_and_b32 v172, 0xffff0000, v154
    v_lshlrev_b32 v173, 16, v154
    v_and_b32 v174, 0xffff0000, v155
    v_lshlrev_b32 v175, 16, v155
    v_and_b32 v176, 0xffff0000, v156
    v_lshlrev_b32 v177, 16, v156
    v_add_f32 v178, v168, v169
    v_mul_f32 v179, v168, v168
    v_fmac_f32 v179, v169, v169
    v_add_f32 v178, v178, v170
    v_fmac_f32 v179, v170, v170
    v_add_f32 v178, v178, v171
    v_fmac_f32 v179, v171, v171
    v_add_f32 v178, v178, v172
    v_fmac_f32 v179, v172, v172
    v_add_f32 v178, v178, v173
    v_fmac_f32 v179, v173, v173
    v_add_f32 v178, v178, v174
    v_fmac_f32 v179, v174, v174
    v_add_f32 v178, v178, v175
    v_fmac_f32 v179, v175, v175
    v_add_f32 v178, v178, v176
    v_fmac_f32 v179, v176, v176
    v_add_f32 v178, v178, v177
    v_fmac_f32 v179, v177, v177
    s_nop 1
    v_add_f32_dpp v178, v178, v178 row_shr:1 row_mask:0xf bank_mask:0xf bound_ctrl:0
    v_add_f32_dpp v179, v179, v179 row_shr:1 row_mask:0xf bank_mask:0xf bound_ctrl:0
    s_nop 1
    v_add_f32_dpp v178, v178, v178 row_shr:2 row_mask:0xf bank_mask:0xf bound_ctrl:0
    v_add_f32_dpp v179, v179, v179 row_shr:2 row_mask:0xf bank_mask:0xf bound_ctrl:0
    s_nop 1
    v_add_f32_dpp v178, v178, v178 row_shr:4 row_mask:0xf bank_mask:0xf bound_ctrl:0
    v_add_f32_dpp v179, v179, v179 row_shr:4 row_mask:0xf bank_mask:0xf bound_ctrl:0
    s_nop 1
    v_add_f32_dpp v178, v178, v178 row_shr:8 row_mask:0xf bank_mask:0xf bound_ctrl:0
    v_add_f32_dpp v179, v179, v179 row_shr:8 row_mask:0xf bank_mask:0xf bound_ctrl:0
    s_nop 1
    v_add_f32_dpp v178, v178, v178 row_bcast:15 row_mask:0xa bank_mask:0xf
    v_add_f32_dpp v179, v179, v179 row_bcast:15 row_mask:0xa bank_mask:0xf
    s_nop 1
    v_add_f32_dpp v178, v178, v178 row_bcast:31 row_mask:0xc bank_mask:0xf
    v_add_f32_dpp v179, v179, v179 row_bcast:31 row_mask:0xc bank_mask:0xf
    s_lshl_b32 s48, s20, 3
    v_mov_b32 v168, s48
    v_add_u32 v168, 151552, v168
    s_mov_b32 s48, 0
    s_mov_b32 s49, 0x80000000
    s_mov_b64 exec, s[48:49]
    ds_write_b64 v168, v[178:179]
    s_mov_b64 exec, -1
    v_lshlrev_b32 v168, 16, v158
    v_and_b32 v169, 0xffff0000, v158
    v_lshlrev_b32 v170, 16, v159
    v_and_b32 v171, 0xffff0000, v159
    v_pk_add_f32 v[168:169], v[168:169], v[170:171]
    v_lshlrev_b32 v170, 16, v160
    v_and_b32 v171, 0xffff0000, v160
    v_pk_add_f32 v[168:169], v[168:169], v[170:171]
    v_lshlrev_b32 v170, 16, v161
    v_and_b32 v171, 0xffff0000, v161
    v_pk_add_f32 v[168:169], v[168:169], v[170:171]
    v_lshlrev_b32 v170, 16, v162
    v_and_b32 v171, 0xffff0000, v162
    v_pk_add_f32 v[168:169], v[168:169], v[170:171]
    v_lshlrev_b32 v170, 16, v163
    v_and_b32 v171, 0xffff0000, v163
    v_pk_add_f32 v[168:169], v[168:169], v[170:171]
    v_lshlrev_b32 v170, 16, v164
    v_and_b32 v171, 0xffff0000, v164
    v_pk_add_f32 v[168:169], v[168:169], v[170:171]
    v_lshlrev_b32 v170, 16, v165
    v_and_b32 v171, 0xffff0000, v165
    v_pk_add_f32 v[168:169], v[168:169], v[170:171]
    v_lshlrev_b32 v170, 16, v166
    v_and_b32 v171, 0xffff0000, v166
    v_pk_add_f32 v[168:169], v[168:169], v[170:171]
    v_lshlrev_b32 v170, 16, v167
    v_and_b32 v171, 0xffff0000, v167
    v_pk_add_f32 v[168:169], v[168:169], v[170:171]
    s_lshl_b32 s48, s20, 9
    v_lshlrev_b32 v172, 3, v1
    v_add_u32 v172, 147456, v172
    v_add_u32 v173, s48, v172
    ds_write_b64 v173, v[168:169]
    v_and_b32 v171, 0xffff0000, v157
    v_lshlrev_b32 v170, 16, v157
    ds_write_b64 v172, v[170:171] offset:5120
    s_waitcnt vmcnt(6) lgkmcnt(0)
    s_barrier
    ds_read_b128 v[48:51], v10
    ds_read_b64_tr_b16 v[56:57], v22 offset:0
    ds_read_b64_tr_b16 v[58:59], v22 offset:768
    ds_read_b64_tr_b16 v[60:61], v23 offset:0
    ds_read_b64_tr_b16 v[62:63], v23 offset:768
    ds_read_b64_tr_b16 v[64:65], v24 offset:0
    ds_read_b64_tr_b16 v[66:67], v24 offset:768
    s_cmp_lg_u32 s20, 0
    s_cbranch_scc1 p1_kernel_F_np
    v_lshlrev_b32 v168, 3, v1
    v_add_u32 v169, 147456, v168
    ds_read_b64 v[210:211], v169 offset:0
    ds_read_b64 v[212:213], v169 offset:512
    ds_read_b64 v[214:215], v169 offset:1024
    ds_read_b64 v[216:217], v169 offset:1536
    ds_read_b64 v[218:219], v169 offset:2048
    ds_read_b64 v[220:221], v169 offset:2560
    ds_read_b64 v[222:223], v169 offset:3072
    ds_read_b64 v[224:225], v169 offset:3584
    s_waitcnt lgkmcnt(0)
    v_pk_add_f32 v[210:211], v[210:211], v[212:213]
    v_pk_add_f32 v[210:211], v[210:211], v[214:215]
    v_pk_add_f32 v[210:211], v[210:211], v[216:217]
    v_pk_add_f32 v[210:211], v[210:211], v[218:219]
    v_pk_add_f32 v[210:211], v[210:211], v[220:221]
    v_pk_add_f32 v[210:211], v[210:211], v[222:223]
    v_pk_add_f32 v[210:211], v[210:211], v[224:225]
    s_lshl_b32 s48, s22, 3
    s_add_u32 s48, s48, s21
    s_lshl_b32 s48, s48, 9
    s_add_u32 s48, s48, 24182784
    buffer_store_dwordx2 v[210:211], v168, s[12:15], s48 offen sc0 sc1
    v_lshlrev_b32 v168, 3, v1
    v_add_u32 v169, 151552, v168
    s_mov_b64 exec, 0xff
    ds_read_b64 v[170:171], v169
    s_lshl_b32 s48, s21, 11
    s_lshl_b32 s49, s22, 6
    s_add_u32 s48, s48, s49
    s_add_u32 s48, s48, 24117248
    s_waitcnt lgkmcnt(0)
    buffer_store_dwordx2 v[170:171], v168, s[12:15], s48 offen sc0 sc1
    s_mov_b64 exec, -1
p1_kernel_F_np:
    s_waitcnt lgkmcnt(4)
    s_add_u32 m0, s27, 98304
    v_mfma_f32_32x32x16_bf16 v[88:103], v[56:59], v[48:51], v[88:103]
    ds_read_b128 v[52:55], v11
    ds_read_b64_tr_b16 v[72:73], v22 offset:3072
    ds_read_b64_tr_b16 v[74:75], v22 offset:3840
    buffer_load_dwordx4 v4, s[4:7], s24 offen lds
    s_waitcnt lgkmcnt(5)
    v_mfma_f32_32x32x16_bf16 v[104:119], v[60:63], v[48:51], v[104:119]
    ds_read_b64_tr_b16 v[76:77], v23 offset:3072
    ds_read_b64_tr_b16 v[78:79], v23 offset:3840
    s_waitcnt lgkmcnt(5)
    s_add_u32 m0, s27, 99328
    v_mfma_f32_32x32x16_bf16 v[120:135], v[64:67], v[48:51], v[120:135]
    ds_read_b64_tr_b16 v[80:81], v24 offset:3072
    ds_read_b64_tr_b16 v[82:83], v24 offset:3840
    buffer_load_dwordx4 v5, s[4:7], s24 offen lds
    s_waitcnt lgkmcnt(4)
    s_add_u32 m0, s27, 100352
    v_mfma_f32_32x32x16_bf16 v[88:103], v[72:75], v[52:55], v[88:103]
    ds_read_b128 v[48:51], v12
    ds_read_b64_tr_b16 v[56:57], v22 offset:6144
    ds_read_b64_tr_b16 v[58:59], v22 offset:6912
    buffer_load_dwordx4 v6, s[4:7], s24 offen lds
    s_waitcnt lgkmcnt(5)
    v_mfma_f32_32x32x16_bf16 v[104:119], v[76:79], v[52:55], v[104:119]
    ds_read_b64_tr_b16 v[60:61], v23 offset:6144
    ds_read_b64_tr_b16 v[62:63], v23 offset:6912
    s_waitcnt lgkmcnt(5)
    s_add_u32 m0, s27, 101376
    v_mfma_f32_32x32x16_bf16 v[120:135], v[80:83], v[52:55], v[120:135]
    ds_read_b64_tr_b16 v[64:65], v24 offset:6144
    ds_read_b64_tr_b16 v[66:67], v24 offset:6912
    buffer_load_dwordx4 v7, s[4:7], s24 offen lds
    s_add_u32 s24, s24, 128
    s_cmp_eq_u32 s55, 7
    s_cselect_b32 s56, 1280, 0
    s_sub_u32 s24, s24, s56
    s_waitcnt lgkmcnt(4)
    s_add_u32 m0, s28, 98304
    v_mfma_f32_32x32x16_bf16 v[88:103], v[56:59], v[48:51], v[88:103]
    ds_read_b128 v[52:55], v13
    ds_read_b64_tr_b16 v[72:73], v22 offset:9216
    ds_read_b64_tr_b16 v[74:75], v22 offset:9984
    buffer_load_dwordx4 v8, s[8:11], s25 offen lds
    s_waitcnt lgkmcnt(5)
    v_mfma_f32_32x32x16_bf16 v[104:119], v[60:63], v[48:51], v[104:119]
    ds_read_b64_tr_b16 v[76:77], v23 offset:9216
    ds_read_b64_tr_b16 v[78:79], v23 offset:9984
    s_waitcnt lgkmcnt(5)
    s_add_u32 m0, s28, 99328
    v_mfma_f32_32x32x16_bf16 v[120:135], v[64:67], v[48:51], v[120:135]
    ds_read_b64_tr_b16 v[80:81], v24 offset:9216
    ds_read_b64_tr_b16 v[82:83], v24 offset:9984
    s_mov_b64 exec, s[44:45]
    buffer_load_dwordx4 v9, s[8:11], s25 offen lds
    s_mov_b64 exec, -1
    s_add_u32 s25, s25, 196608
    s_cmp_eq_u32 s55, 7
    s_cselect_b32 s56, 1966080, 0
    s_sub_u32 s25, s25, s56
    s_waitcnt lgkmcnt(4)
    v_mfma_f32_32x32x16_bf16 v[88:103], v[72:75], v[52:55], v[88:103]
    s_waitcnt vmcnt(6) lgkmcnt(0)
    s_cmp_lg_u32 s20, 0
    s_cbranch_scc1 p1_kernel_F_ns
    s_mov_b64 exec, 1
    v_mov_b32 v168, 1
    v_mov_b32 v169, 0
    s_lshl_b32 s48, s21, 5
    s_add_u32 s48, s48, s22
    buffer_store_byte v168, v169, s[76:79], s48 offen sc0 sc1
    s_mov_b64 exec, -1
p1_kernel_F_ns:
    s_barrier
    s_lshl_b32 s84, s2, 3
    s_add_u32 s84, s84, s20
    s_cmp_ge_u32 s84, 1920
    s_cselect_b32 s85, 1920, 0
    s_cselect_b32 s88, s82, s80
    s_cselect_b32 s89, s83, s81
    s_mov_b32 s90, 1966080
    s_mov_b32 s93, 27262976
    s_cselect_b32 s90, 819200, s90
    s_cselect_b32 s93, 30408704, s93
    s_cselect_b32 s94, 40, 96
    s_and_b32 s89, s89, 0xffff
    s_mov_b32 s91, 0x00020000
    s_sub_u32 s84, s84, s85
    s_mul_i32 s86, s84, 3277
    s_lshr_b32 s86, s86, 16
    s_mul_i32 s87, s86, 20
    s_sub_u32 s87, s84, s87
    s_mul_i32 s95, s87, 205
    s_lshr_b32 s95, s95, 10
    s_mul_i32 s96, s95, 5
    s_sub_u32 s96, s87, s96
    s_mul_i32 s95, s95, s94
    s_add_u32 s95, s95, s86
    s_mul_i32 s95, s95, 5
    s_add_u32 s95, s95, s96
    s_lshl_b32 s95, s95, 10
    s_add_u32 s92, s95, s93
    v_lshrrev_b32 v218, 2, v1
    s_mul_i32 s95, s86, 16
    s_cmp_eq_u32 s85, 0
    s_cbranch_scc1 p1_kernel_F_tr0_rows
    s_cmp_ge_u32 s86, 32
    s_cbranch_scc1 p1_kernel_F_tr0_tb
    s_mul_i32 s95, s86, 20
    v_lshrrev_b32 v219, 3, v218
    v_lshl_add_u32 v218, v219, 1, v218
    s_branch p1_kernel_F_tr0_rows
p1_kernel_F_tr0_tb:
    s_sub_u32 s95, s86, 32
    s_mul_i32 s95, s95, 80
    s_add_u32 s95, s95, 8
    v_lshrrev_b32 v219, 1, v218
    v_and_b32 v218, 1, v218
    v_mad_u32_u24 v218, v219, 10, v218
p1_kernel_F_tr0_rows:
    s_mul_i32 s95, s95, 1280
    s_lshl_b32 s96, s87, 6
    s_add_u32 s95, s95, s96
    v_mul_u32_u24 v218, 1280, v218
    v_and_b32 v219, 3, v1
    v_lshl_add_u32 v218, v219, 4, v218
    s_lshl_b32 s96, s20, 10
    s_add_u32 m0, s96, 155136
    s_nop 0
    buffer_load_dwordx4 v218, s[88:91], s95 offen lds
p1_kernel_F_tr0_end:
    s_add_u32 m0, s27, 0
    v_mfma_f32_32x32x16_bf16 v[104:119], v[76:79], v[52:55], v[104:119]
    ds_read_b128 v[48:51], v14
    ds_read_b64_tr_b16 v[56:57], v26 offset:0
    ds_read_b64_tr_b16 v[58:59], v26 offset:768
    buffer_load_dwordx4 v4, s[4:7], s24 offen lds
    s_add_u32 m0, s27, 1024
    v_mfma_f32_32x32x16_bf16 v[120:135], v[80:83], v[52:55], v[120:135]
    ds_read_b64_tr_b16 v[60:61], v27 offset:0
    ds_read_b64_tr_b16 v[62:63], v27 offset:768
    ds_read_b64_tr_b16 v[64:65], v28 offset:0
    ds_read_b64_tr_b16 v[66:67], v28 offset:768
    buffer_load_dwordx4 v5, s[4:7], s24 offen lds
    s_waitcnt lgkmcnt(4)
    s_add_u32 m0, s27, 2048
    v_mfma_f32_32x32x16_bf16 v[88:103], v[56:59], v[48:51], v[88:103]
    ds_read_b128 v[52:55], v15
    ds_read_b64_tr_b16 v[72:73], v26 offset:3072
    ds_read_b64_tr_b16 v[74:75], v26 offset:3840
    buffer_load_dwordx4 v6, s[4:7], s24 offen lds
    s_waitcnt lgkmcnt(5)
    v_mfma_f32_32x32x16_bf16 v[104:119], v[60:63], v[48:51], v[104:119]
    ds_read_b64_tr_b16 v[76:77], v27 offset:3072
    ds_read_b64_tr_b16 v[78:79], v27 offset:3840
    s_waitcnt lgkmcnt(5)
    s_add_u32 m0, s27, 3072
    v_mfma_f32_32x32x16_bf16 v[120:135], v[64:67], v[48:51], v[120:135]
    ds_read_b64_tr_b16 v[80:81], v28 offset:3072
    ds_read_b64_tr_b16 v[82:83], v28 offset:3840
    buffer_load_dwordx4 v7, s[4:7], s24 offen lds
    s_add_u32 s24, s24, 128
    s_cmp_eq_u32 s55, 6
    s_cselect_b32 s56, 1280, 0
    s_sub_u32 s24, s24, s56
    s_waitcnt lgkmcnt(4)
    s_add_u32 m0, s28, 0
    v_mfma_f32_32x32x16_bf16 v[88:103], v[72:75], v[52:55], v[88:103]
    ds_read_b128 v[48:51], v16
    ds_read_b64_tr_b16 v[56:57], v26 offset:6144
    ds_read_b64_tr_b16 v[58:59], v26 offset:6912
    buffer_load_dwordx4 v8, s[8:11], s25 offen lds
    s_waitcnt lgkmcnt(5)
    v_mfma_f32_32x32x16_bf16 v[104:119], v[76:79], v[52:55], v[104:119]
    ds_read_b64_tr_b16 v[60:61], v27 offset:6144
    ds_read_b64_tr_b16 v[62:63], v27 offset:6912
    s_waitcnt lgkmcnt(5)
    s_add_u32 m0, s28, 1024
    v_mfma_f32_32x32x16_bf16 v[120:135], v[80:83], v[52:55], v[120:135]
    ds_read_b64_tr_b16 v[64:65], v28 offset:6144
    ds_read_b64_tr_b16 v[66:67], v28 offset:6912
    s_mov_b64 exec, s[44:45]
    buffer_load_dwordx4 v9, s[8:11], s25 offen lds
    s_mov_b64 exec, -1
    s_add_u32 s25, s25, 196608
    s_cmp_eq_u32 s55, 6
    s_cselect_b32 s56, 1966080, 0
    s_sub_u32 s25, s25, s56
    s_waitcnt lgkmcnt(4)
    v_mfma_f32_32x32x16_bf16 v[88:103], v[56:59], v[48:51], v[88:103]
    ds_read_b128 v[52:55], v17
    ds_read_b64_tr_b16 v[72:73], v26 offset:9216
    ds_read_b64_tr_b16 v[74:75], v26 offset:9984
    s_waitcnt lgkmcnt(5)
    v_mfma_f32_32x32x16_bf16 v[104:119], v[60:63], v[48:51], v[104:119]
    ds_read_b64_tr_b16 v[76:77], v27 offset:9216
    ds_read_b64_tr_b16 v[78:79], v27 offset:9984
    s_waitcnt lgkmcnt(5)
    v_mfma_f32_32x32x16_bf16 v[120:135], v[64:67], v[48:51], v[120:135]
    ds_read_b64_tr_b16 v[80:81], v28 offset:9216
    ds_read_b64_tr_b16 v[82:83], v28 offset:9984
    s_waitcnt lgkmcnt(4)
    v_mfma_f32_32x32x16_bf16 v[88:103], v[72:75], v[52:55], v[88:103]
    s_waitcnt vmcnt(6) lgkmcnt(0)
    s_cmp_eq_u32 s92, -1
    s_cbranch_scc1 p1_kernel_F_tr0_fin
    v_bfe_u32 v218, v1, 2, 2
    v_lshl_add_u32 v218, v3, 3, v218
    v_lshlrev_b32 v218, 6, v218
    v_bfe_u32 v219, v1, 4, 1
    v_lshl_add_u32 v218, v219, 5, v218
    v_and_b32 v219, 3, v1
    v_lshl_add_u32 v218, v219, 3, v218
    s_lshl_b32 s96, s20, 10
    s_add_u32 s96, s96, 155136
    v_add_u32 v218, s96, v218
    ds_read_b64_tr_b16 v[220:221], v218
    ds_read_b64_tr_b16 v[222:223], v218 offset:256
    v_lshlrev_b32 v219, 4, v1
    s_waitcnt lgkmcnt(0)
    buffer_store_dwordx4 v[220:223], v219, s[12:15], s92 offen sc1
p1_kernel_F_tr0_fin:
    s_barrier
    s_add_u32 m0, s27, 49152
    v_mfma_f32_32x32x16_bf16 v[104:119], v[76:79], v[52:55], v[104:119]
    ds_read_b128 v[48:51], v18
    ds_read_b64_tr_b16 v[56:57], v30 offset:0
    ds_read_b64_tr_b16 v[58:59], v30 offset:768
    buffer_load_dwordx4 v4, s[4:7], s24 offen lds
    s_add_u32 m0, s27, 50176
    v_mfma_f32_32x32x16_bf16 v[120:135], v[80:83], v[52:55], v[120:135]
    ds_read_b64_tr_b16 v[60:61], v31 offset:0
    ds_read_b64_tr_b16 v[62:63], v31 offset:768
    ds_read_b64_tr_b16 v[64:65], v32 offset:0
    ds_read_b64_tr_b16 v[66:67], v32 offset:768
    buffer_load_dwordx4 v5, s[4:7], s24 offen lds
    s_waitcnt lgkmcnt(4)
    s_add_u32 m0, s27, 51200
    v_mfma_f32_32x32x16_bf16 v[88:103], v[56:59], v[48:51], v[88:103]
    ds_read_b128 v[52:55], v19
    ds_read_b64_tr_b16 v[72:73], v30 offset:3072
    ds_read_b64_tr_b16 v[74:75], v30 offset:3840
    buffer_load_dwordx4 v6, s[4:7], s24 offen lds
    s_waitcnt lgkmcnt(5)
    v_mfma_f32_32x32x16_bf16 v[104:119], v[60:63], v[48:51], v[104:119]
    ds_read_b64_tr_b16 v[76:77], v31 offset:3072
    ds_read_b64_tr_b16 v[78:79], v31 offset:3840
    s_waitcnt lgkmcnt(5)
    s_add_u32 m0, s27, 52224
    v_mfma_f32_32x32x16_bf16 v[120:135], v[64:67], v[48:51], v[120:135]
    ds_read_b64_tr_b16 v[80:81], v32 offset:3072
    ds_read_b64_tr_b16 v[82:83], v32 offset:3840
    buffer_load_dwordx4 v7, s[4:7], s24 offen lds
    s_add_u32 s24, s24, 128
    s_cmp_eq_u32 s55, 5
    s_cselect_b32 s56, 1280, 0
    s_sub_u32 s24, s24, s56
    s_waitcnt lgkmcnt(4)
    s_add_u32 m0, s28, 49152
    v_mfma_f32_32x32x16_bf16 v[88:103], v[72:75], v[52:55], v[88:103]
    ds_read_b128 v[48:51], v20
    ds_read_b64_tr_b16 v[56:57], v30 offset:6144
    ds_read_b64_tr_b16 v[58:59], v30 offset:6912
    buffer_load_dwordx4 v8, s[8:11], s25 offen lds
    s_waitcnt lgkmcnt(5)
    v_mfma_f32_32x32x16_bf16 v[104:119], v[76:79], v[52:55], v[104:119]
    ds_read_b64_tr_b16 v[60:61], v31 offset:6144
    ds_read_b64_tr_b16 v[62:63], v31 offset:6912
    s_waitcnt lgkmcnt(5)
    s_add_u32 m0, s28, 50176
    v_mfma_f32_32x32x16_bf16 v[120:135], v[80:83], v[52:55], v[120:135]
    ds_read_b64_tr_b16 v[64:65], v32 offset:6144
    ds_read_b64_tr_b16 v[66:67], v32 offset:6912
    s_mov_b64 exec, s[44:45]
    buffer_load_dwordx4 v9, s[8:11], s25 offen lds
    s_mov_b64 exec, -1
    s_add_u32 s25, s25, 196608
    s_cmp_eq_u32 s55, 5
    s_cselect_b32 s56, 1966080, 0
    s_sub_u32 s25, s25, s56
    s_waitcnt lgkmcnt(4)
    v_mfma_f32_32x32x16_bf16 v[88:103], v[56:59], v[48:51], v[88:103]
    ds_read_b128 v[52:55], v21
    ds_read_b64_tr_b16 v[72:73], v30 offset:9216
    ds_read_b64_tr_b16 v[74:75], v30 offset:9984
    s_waitcnt lgkmcnt(5)
    v_mfma_f32_32x32x16_bf16 v[104:119], v[60:63], v[48:51], v[104:119]
    ds_read_b64_tr_b16 v[76:77], v31 offset:9216
    ds_read_b64_tr_b16 v[78:79], v31 offset:9984
    s_waitcnt lgkmcnt(5)
    v_mfma_f32_32x32x16_bf16 v[120:135], v[64:67], v[48:51], v[120:135]
    ds_read_b64_tr_b16 v[80:81], v32 offset:9216
    ds_read_b64_tr_b16 v[82:83], v32 offset:9984
    s_waitcnt lgkmcnt(4)
    v_mfma_f32_32x32x16_bf16 v[88:103], v[72:75], v[52:55], v[88:103]
    s_waitcnt vmcnt(6) lgkmcnt(0)
    s_barrier
    s_lshl_b32 s84, s2, 3
    s_add_u32 s84, s84, s20
    s_mov_b32 s92, -1
    s_cmp_ge_u32 s84, 672
    s_cbranch_scc1 p1_kernel_F_tr1_end
    s_add_u32 s84, s84, 2048
    s_cmp_ge_u32 s84, 1920
    s_cselect_b32 s85, 1920, 0
    s_cselect_b32 s88, s82, s80
    s_cselect_b32 s89, s83, s81
    s_mov_b32 s90, 1966080
    s_mov_b32 s93, 27262976
    s_cselect_b32 s90, 819200, s90
    s_cselect_b32 s93, 30408704, s93
    s_cselect_b32 s94, 40, 96
    s_and_b32 s89, s89, 0xffff
    s_mov_b32 s91, 0x00020000
    s_sub_u32 s84, s84, s85
    s_mul_i32 s86, s84, 3277
    s_lshr_b32 s86, s86, 16
    s_mul_i32 s87, s86, 20
    s_sub_u32 s87, s84, s87
    s_mul_i32 s95, s87, 205
    s_lshr_b32 s95, s95, 10
    s_mul_i32 s96, s95, 5
    s_sub_u32 s96, s87, s96
    s_mul_i32 s95, s95, s94
    s_add_u32 s95, s95, s86
    s_mul_i32 s95, s95, 5
    s_add_u32 s95, s95, s96
    s_lshl_b32 s95, s95, 10
    s_add_u32 s92, s95, s93
    v_lshrrev_b32 v218, 2, v1
    s_mul_i32 s95, s86, 16
    s_cmp_eq_u32 s85, 0
    s_cbranch_scc1 p1_kernel_F_tr1_rows
    s_cmp_ge_u32 s86, 32
    s_cbranch_scc1 p1_kernel_F_tr1_tb
    s_mul_i32 s95, s86, 20
    v_lshrrev_b32 v219, 3, v218
    v_lshl_add_u32 v218, v219, 1, v218
    s_branch p1_kernel_F_tr1_rows
p1_kernel_F_tr1_tb:
    s_sub_u32 s95, s86, 32
    s_mul_i32 s95, s95, 80
    s_add_u32 s95, s95, 8
    v_lshrrev_b32 v219, 1, v218
    v_and_b32 v218, 1, v218
    v_mad_u32_u24 v218, v219, 10, v218
p1_kernel_F_tr1_rows:
    s_mul_i32 s95, s95, 1280
    s_lshl_b32 s96, s87, 6
    s_add_u32 s95, s95, s96
    v_mul_u32_u24 v218, 1280, v218
    v_and_b32 v219, 3, v1
    v_lshl_add_u32 v218, v219, 4, v218
    s_lshl_b32 s96, s20, 10
    s_add_u32 m0, s96, 155136
    s_nop 0
    buffer_load_dwordx4 v218, s[88:91], s95 offen lds
p1_kernel_F_tr1_end:
    s_add_u32 m0, s27, 98304
    v_mfma_f32_32x32x16_bf16 v[104:119], v[76:79], v[52:55], v[104:119]
    ds_read_b128 v[48:51], v10
    ds_read_b64_tr_b16 v[56:57], v22 offset:0
    ds_read_b64_tr_b16 v[58:59], v22 offset:768
    buffer_load_dwordx4 v4, s[4:7], s24 offen lds
    s_add_u32 m0, s27, 99328
    v_mfma_f32_32x32x16_bf16 v[120:135], v[80:83], v[52:55], v[120:135]
    ds_read_b64_tr_b16 v[60:61], v23 offset:0
    ds_read_b64_tr_b16 v[62:63], v23 offset:768
    ds_read_b64_tr_b16 v[64:65], v24 offset:0
    ds_read_b64_tr_b16 v[66:67], v24 offset:768
    buffer_load_dwordx4 v5, s[4:7], s24 offen lds
    s_waitcnt lgkmcnt(4)
    s_add_u32 m0, s27, 100352
    v_mfma_f32_32x32x16_bf16 v[88:103], v[56:59], v[48:51], v[88:103]
    ds_read_b128 v[52:55], v11
    ds_read_b64_tr_b16 v[72:73], v22 offset:3072
    ds_read_b64_tr_b16 v[74:75], v22 offset:3840
    buffer_load_dwordx4 v6, s[4:7], s24 offen lds
    s_waitcnt lgkmcnt(5)
    v_mfma_f32_32x32x16_bf16 v[104:119], v[60:63], v[48:51], v[104:119]
    ds_read_b64_tr_b16 v[76:77], v23 offset:3072
    ds_read_b64_tr_b16 v[78:79], v23 offset:3840
    s_waitcnt lgkmcnt(5)
    s_add_u32 m0, s27, 101376
    v_mfma_f32_32x32x16_bf16 v[120:135], v[64:67], v[48:51], v[120:135]
    ds_read_b64_tr_b16 v[80:81], v24 offset:3072
    ds_read_b64_tr_b16 v[82:83], v24 offset:3840
    buffer_load_dwordx4 v7, s[4:7], s24 offen lds
    s_add_u32 s24, s24, 128
    s_cmp_eq_u32 s55, 4
    s_cselect_b32 s56, 1280, 0
    s_sub_u32 s24, s24, s56
    s_waitcnt lgkmcnt(4)
    s_add_u32 m0, s28, 98304
    v_mfma_f32_32x32x16_bf16 v[88:103], v[72:75], v[52:55], v[88:103]
    ds_read_b128 v[48:51], v12
    ds_read_b64_tr_b16 v[56:57], v22 offset:6144
    ds_read_b64_tr_b16 v[58:59], v22 offset:6912
    buffer_load_dwordx4 v8, s[8:11], s25 offen lds
    s_waitcnt lgkmcnt(5)
    v_mfma_f32_32x32x16_bf16 v[104:119], v[76:79], v[52:55], v[104:119]
    ds_read_b64_tr_b16 v[60:61], v23 offset:6144
    ds_read_b64_tr_b16 v[62:63], v23 offset:6912
    s_waitcnt lgkmcnt(5)
    s_add_u32 m0, s28, 99328
    v_mfma_f32_32x32x16_bf16 v[120:135], v[80:83], v[52:55], v[120:135]
    ds_read_b64_tr_b16 v[64:65], v24 offset:6144
    ds_read_b64_tr_b16 v[66:67], v24 offset:6912
    s_mov_b64 exec, s[44:45]
    buffer_load_dwordx4 v9, s[8:11], s25 offen lds
    s_mov_b64 exec, -1
    s_add_u32 s25, s25, 196608
    s_cmp_eq_u32 s55, 4
    s_cselect_b32 s56, 1966080, 0
    s_sub_u32 s25, s25, s56
    s_waitcnt lgkmcnt(4)
    v_mfma_f32_32x32x16_bf16 v[88:103], v[56:59], v[48:51], v[88:103]
    ds_read_b128 v[52:55], v13
    ds_read_b64_tr_b16 v[72:73], v22 offset:9216
    ds_read_b64_tr_b16 v[74:75], v22 offset:9984
    s_waitcnt lgkmcnt(5)
    v_mfma_f32_32x32x16_bf16 v[104:119], v[60:63], v[48:51], v[104:119]
    ds_read_b64_tr_b16 v[76:77], v23 offset:9216
    ds_read_b64_tr_b16 v[78:79], v23 offset:9984
    s_waitcnt lgkmcnt(5)
    v_mfma_f32_32x32x16_bf16 v[120:135], v[64:67], v[48:51], v[120:135]
    ds_read_b64_tr_b16 v[80:81], v24 offset:9216
    ds_read_b64_tr_b16 v[82:83], v24 offset:9984
    s_waitcnt lgkmcnt(4)
    v_mfma_f32_32x32x16_bf16 v[88:103], v[72:75], v[52:55], v[88:103]
    s_waitcnt vmcnt(6) lgkmcnt(0)
    s_cmp_eq_u32 s92, -1
    s_cbranch_scc1 p1_kernel_F_tr1_fin
    v_bfe_u32 v218, v1, 2, 2
    v_lshl_add_u32 v218, v3, 3, v218
    v_lshlrev_b32 v218, 6, v218
    v_bfe_u32 v219, v1, 4, 1
    v_lshl_add_u32 v218, v219, 5, v218
    v_and_b32 v219, 3, v1
    v_lshl_add_u32 v218, v219, 3, v218
    s_lshl_b32 s96, s20, 10
    s_add_u32 s96, s96, 155136
    v_add_u32 v218, s96, v218
    ds_read_b64_tr_b16 v[220:221], v218
    ds_read_b64_tr_b16 v[222:223], v218 offset:256
    v_lshlrev_b32 v219, 4, v1
    s_waitcnt lgkmcnt(0)
    buffer_store_dwordx4 v[220:223], v219, s[12:15], s92 offen sc1
p1_kernel_F_tr1_fin:
    s_barrier
    s_add_u32 m0, s27, 0
    v_mfma_f32_32x32x16_bf16 v[104:119], v[76:79], v[52:55], v[104:119]
    ds_read_b128 v[48:51], v14
    ds_read_b64_tr_b16 v[56:57], v26 offset:0
    ds_read_b64_tr_b16 v[58:59], v26 offset:768
    buffer_load_dwordx4 v4, s[4:7], s24 offen lds
    s_add_u32 m0, s27, 1024
    v_mfma_f32_32x32x16_bf16 v[120:135], v[80:83], v[52:55], v[120:135]
    ds_read_b64_tr_b16 v[60:61], v27 offset:0
    ds_read_b64_tr_b16 v[62:63], v27 offset:768
    ds_read_b64_tr_b16 v[64:65], v28 offset:0
    ds_read_b64_tr_b16 v[66:67], v28 offset:768
    buffer_load_dwordx4 v5, s[4:7], s24 offen lds
    s_waitcnt lgkmcnt(4)
    s_add_u32 m0, s27, 2048
    v_mfma_f32_32x32x16_bf16 v[88:103], v[56:59], v[48:51], v[88:103]
    ds_read_b128 v[52:55], v15
    ds_read_b64_tr_b16 v[72:73], v26 offset:3072
    ds_read_b64_tr_b16 v[74:75], v26 offset:3840
    buffer_load_dwordx4 v6, s[4:7], s24 offen lds
    s_waitcnt lgkmcnt(5)
    v_mfma_f32_32x32x16_bf16 v[104:119], v[60:63], v[48:51], v[104:119]
    ds_read_b64_tr_b16 v[76:77], v27 offset:3072
    ds_read_b64_tr_b16 v[78:79], v27 offset:3840
    s_waitcnt lgkmcnt(5)
    s_add_u32 m0, s27, 3072
    v_mfma_f32_32x32x16_bf16 v[120:135], v[64:67], v[48:51], v[120:135]
    ds_read_b64_tr_b16 v[80:81], v28 offset:3072
    ds_read_b64_tr_b16 v[82:83], v28 offset:3840
    buffer_load_dwordx4 v7, s[4:7], s24 offen lds
    s_add_u32 s24, s24, 128
    s_cmp_eq_u32 s55, 3
    s_cselect_b32 s56, 1280, 0
    s_sub_u32 s24, s24, s56
    s_waitcnt lgkmcnt(4)
    s_add_u32 m0, s28, 0
    v_mfma_f32_32x32x16_bf16 v[88:103], v[72:75], v[52:55], v[88:103]
    ds_read_b128 v[48:51], v16
    ds_read_b64_tr_b16 v[56:57], v26 offset:6144
    ds_read_b64_tr_b16 v[58:59], v26 offset:6912
    buffer_load_dwordx4 v8, s[8:11], s25 offen lds
    s_waitcnt lgkmcnt(5)
    v_mfma_f32_32x32x16_bf16 v[104:119], v[76:79], v[52:55], v[104:119]
    ds_read_b64_tr_b16 v[60:61], v27 offset:6144
    ds_read_b64_tr_b16 v[62:63], v27 offset:6912
    s_waitcnt lgkmcnt(5)
    s_add_u32 m0, s28, 1024
    v_mfma_f32_32x32x16_bf16 v[120:135], v[80:83], v[52:55], v[120:135]
    ds_read_b64_tr_b16 v[64:65], v28 offset:6144
    ds_read_b64_tr_b16 v[66:67], v28 offset:6912
    s_mov_b64 exec, s[44:45]
    buffer_load_dwordx4 v9, s[8:11], s25 offen lds
    s_mov_b64 exec, -1
    s_add_u32 s25, s25, 196608
    s_cmp_eq_u32 s55, 3
    s_cselect_b32 s56, 1966080, 0
    s_sub_u32 s25, s25, s56
    s_waitcnt lgkmcnt(4)
    v_mfma_f32_32x32x16_bf16 v[88:103], v[56:59], v[48:51], v[88:103]
    ds_read_b128 v[52:55], v17
    ds_read_b64_tr_b16 v[72:73], v26 offset:9216
    ds_read_b64_tr_b16 v[74:75], v26 offset:9984
    s_waitcnt lgkmcnt(5)
    v_mfma_f32_32x32x16_bf16 v[104:119], v[60:63], v[48:51], v[104:119]
    ds_read_b64_tr_b16 v[76:77], v27 offset:9216
    ds_read_b64_tr_b16 v[78:79], v27 offset:9984
    s_waitcnt lgkmcnt(5)
    v_mfma_f32_32x32x16_bf16 v[120:135], v[64:67], v[48:51], v[120:135]
    ds_read_b64_tr_b16 v[80:81], v28 offset:9216
    ds_read_b64_tr_b16 v[82:83], v28 offset:9984
    s_waitcnt lgkmcnt(4)
    v_mfma_f32_32x32x16_bf16 v[88:103], v[72:75], v[52:55], v[88:103]
    s_waitcnt vmcnt(6) lgkmcnt(0)
    s_barrier
    v_mov_b32 v218, -1
    v_mov_b32 v219, -1
    v_mov_b32 v220, -1
    v_mov_b32 v221, -1
    s_mul_i32 s48, s2, 10240
    s_add_u32 s48, s48, 16777216
    s_add_u32 s49, s48, 8192
    v_lshlrev_b32 v222, 4, v0
    v_lshlrev_b32 v223, 2, v0
    buffer_store_dwordx4 v[218:221], v222, s[12:15], s48 offen sc1
    buffer_store_dword v218, v223, s[12:15], s49 offen sc1
    s_add_u32 m0, s27, 49152
    v_mfma_f32_32x32x16_bf16 v[104:119], v[76:79], v[52:55], v[104:119]
    ds_read_b128 v[48:51], v18
    ds_read_b64_tr_b16 v[56:57], v30 offset:0
    ds_read_b64_tr_b16 v[58:59], v30 offset:768
    buffer_load_dwordx4 v4, s[4:7], s24 offen lds
    s_add_u32 m0, s27, 50176
    v_mfma_f32_32x32x16_bf16 v[120:135], v[80:83], v[52:55], v[120:135]
    ds_read_b64_tr_b16 v[60:61], v31 offset:0
    ds_read_b64_tr_b16 v[62:63], v31 offset:768
    ds_read_b64_tr_b16 v[64:65], v32 offset:0
    ds_read_b64_tr_b16 v[66:67], v32 offset:768
    buffer_load_dwordx4 v5, s[4:7], s24 offen lds
    s_waitcnt lgkmcnt(4)
    s_add_u32 m0, s27, 51200
    v_mfma_f32_32x32x16_bf16 v[88:103], v[56:59], v[48:51], v[88:103]
    ds_read_b128 v[52:55], v19
    ds_read_b64_tr_b16 v[72:73], v30 offset:3072
    ds_read_b64_tr_b16 v[74:75], v30 offset:3840
    buffer_load_dwordx4 v6, s[4:7], s24 offen lds
    s_waitcnt lgkmcnt(5)
    v_mfma_f32_32x32x16_bf16 v[104:119], v[60:63], v[48:51], v[104:119]
    ds_read_b64_tr_b16 v[76:77], v31 offset:3072
    ds_read_b64_tr_b16 v[78:79], v31 offset:3840
    s_waitcnt lgkmcnt(5)
    s_add_u32 m0, s27, 52224
    v_mfma_f32_32x32x16_bf16 v[120:135], v[64:67], v[48:51], v[120:135]
    ds_read_b64_tr_b16 v[80:81], v32 offset:3072
    ds_read_b64_tr_b16 v[82:83], v32 offset:3840
    buffer_load_dwordx4 v7, s[4:7], s24 offen lds
    s_add_u32 s24, s24, 128
    s_cmp_eq_u32 s55, 2
    s_cselect_b32 s56, 1280, 0
    s_sub_u32 s24, s24, s56
    s_waitcnt lgkmcnt(4)
    s_add_u32 m0, s28, 49152
    v_mfma_f32_32x32x16_bf16 v[88:103], v[72:75], v[52:55], v[88:103]
    ds_read_b128 v[48:51], v20
    ds_read_b64_tr_b16 v[56:57], v30 offset:6144
    ds_read_b64_tr_b16 v[58:59], v30 offset:6912
    buffer_load_dwordx4 v8, s[8:11], s25 offen lds
    s_waitcnt lgkmcnt(5)
    v_mfma_f32_32x32x16_bf16 v[104:119], v[76:79], v[52:55], v[104:119]
    ds_read_b64_tr_b16 v[60:61], v31 offset:6144
    ds_read_b64_tr_b16 v[62:63], v31 offset:6912
    s_waitcnt lgkmcnt(5)
    s_add_u32 m0, s28, 50176
    v_mfma_f32_32x32x16_bf16 v[120:135], v[80:83], v[52:55], v[120:135]
    ds_read_b64_tr_b16 v[64:65], v32 offset:6144
    ds_read_b64_tr_b16 v[66:67], v32 offset:6912
    s_mov_b64 exec, s[44:45]
    buffer_load_dwordx4 v9, s[8:11], s25 offen lds
    s_mov_b64 exec, -1
    s_add_u32 s25, s25, 196608
    s_cmp_eq_u32 s55, 2
    s_cselect_b32 s56, 1966080, 0
    s_sub_u32 s25, s25, s56
    s_waitcnt lgkmcnt(4)
    v_mfma_f32_32x32x16_bf16 v[88:103], v[56:59], v[48:51], v[88:103]
    ds_read_b128 v[52:55], v21
    ds_read_b64_tr_b16 v[72:73], v30 offset:9216
    ds_read_b64_tr_b16 v[74:75], v30 offset:9984
    s_waitcnt lgkmcnt(5)
    v_mfma_f32_32x32x16_bf16 v[104:119], v[60:63], v[48:51], v[104:119]
    ds_read_b64_tr_b16 v[76:77], v31 offset:9216
    ds_read_b64_tr_b16 v[78:79], v31 offset:9984
    s_waitcnt lgkmcnt(5)
    v_mfma_f32_32x32x16_bf16 v[120:135], v[64:67], v[48:51], v[120:135]
    ds_read_b64_tr_b16 v[80:81], v32 offset:9216
    ds_read_b64_tr_b16 v[82:83], v32 offset:9984
    s_waitcnt lgkmcnt(4)
    v_mfma_f32_32x32x16_bf16 v[88:103], v[72:75], v[52:55], v[88:103]
    s_waitcnt vmcnt(6) lgkmcnt(0)
    s_barrier
    s_cmp_lg_u32 s20, 0
    s_cbranch_scc1 p1_kernel_F_nq
    v_lshlrev_b32 v170, 2, v1
    v_lshrrev_b32 v171, 3, v1
    v_cmp_eq_u32 vcc, s21, v171
    v_mov_b32 v173, 0x01010101
    v_and_b32 v171, 7, v1
    v_cndmask_b32 v172, 0, v173, vcc
    s_lshr_b32 s48, s22, 2
    s_and_b32 s49, s22, 3
    s_lshl_b32 s49, s49, 3
    s_lshl_b32 s49, 1, s49
    v_cmp_eq_u32 vcc, s48, v171
    v_mov_b32 v173, s49
    s_nop 0
    v_cndmask_b32 v173, 0, v173, vcc
    v_or_b32 v172, v172, v173
    buffer_load_dword v169, v170, s[76:79], 0 offen sc0 sc1
p1_kernel_F_nq:
    s_add_u32 m0, s27, 98304
    v_mfma_f32_32x32x16_bf16 v[104:119], v[76:79], v[52:55], v[104:119]
    ds_read_b128 v[48:51], v10
    ds_read_b64_tr_b16 v[56:57], v22 offset:0
    ds_read_b64_tr_b16 v[58:59], v22 offset:768
    buffer_load_dwordx4 v4, s[4:7], s24 offen lds
    s_add_u32 m0, s27, 99328
    v_mfma_f32_32x32x16_bf16 v[120:135], v[80:83], v[52:55], v[120:135]
    ds_read_b64_tr_b16 v[60:61], v23 offset:0
    ds_read_b64_tr_b16 v[62:63], v23 offset:768
    ds_read_b64_tr_b16 v[64:65], v24 offset:0
    ds_read_b64_tr_b16 v[66:67], v24 offset:768
    buffer_load_dwordx4 v5, s[4:7], s24 offen lds
    s_waitcnt lgkmcnt(4)
    s_add_u32 m0, s27, 100352
    v_mfma_f32_32x32x16_bf16 v[88:103], v[56:59], v[48:51], v[88:103]
    ds_read_b128 v[52:55], v11
    ds_read_b64_tr_b16 v[72:73], v22 offset:3072
    ds_read_b64_tr_b16 v[74:75], v22 offset:3840
    buffer_load_dwordx4 v6, s[4:7], s24 offen lds
    s_waitcnt lgkmcnt(5)
    v_mfma_f32_32x32x16_bf16 v[104:119], v[60:63], v[48:51], v[104:119]
    ds_read_b64_tr_b16 v[76:77], v23 offset:3072
    ds_read_b64_tr_b16 v[78:79], v23 offset:3840
    s_waitcnt lgkmcnt(5)
    s_add_u32 m0, s27, 101376
    v_mfma_f32_32x32x16_bf16 v[120:135], v[64:67], v[48:51], v[120:135]
    ds_read_b64_tr_b16 v[80:81], v24 offset:3072
    ds_read_b64_tr_b16 v[82:83], v24 offset:3840
    buffer_load_dwordx4 v7, s[4:7], s24 offen lds
    s_add_u32 s24, s24, 128
    s_cmp_eq_u32 s55, 1
    s_cselect_b32 s56, 1280, 0
    s_sub_u32 s24, s24, s56
    s_waitcnt lgkmcnt(4)
    s_add_u32 m0, s28, 98304
    v_mfma_f32_32x32x16_bf16 v[88:103], v[72:75], v[52:55], v[88:103]
    ds_read_b128 v[48:51], v12
    ds_read_b64_tr_b16 v[56:57], v22 offset:6144
    ds_read_b64_tr_b16 v[58:59], v22 offset:6912
    buffer_load_dwordx4 v8, s[8:11], s25 offen lds
    s_waitcnt lgkmcnt(5)
    v_mfma_f32_32x32x16_bf16 v[104:119], v[76:79], v[52:55], v[104:119]
    ds_read_b64_tr_b16 v[60:61], v23 offset:6144
    ds_read_b64_tr_b16 v[62:63], v23 offset:6912
    s_waitcnt lgkmcnt(5)
    s_add_u32 m0, s28, 99328
    v_mfma_f32_32x32x16_bf16 v[120:135], v[80:83], v[52:55], v[120:135]
    ds_read_b64_tr_b16 v[64:65], v24 offset:6144
    ds_read_b64_tr_b16 v[66:67], v24 offset:6912
    s_mov_b64 exec, s[44:45]
    buffer_load_dwordx4 v9, s[8:11], s25 offen lds
    s_mov_b64 exec, -1
    s_add_u32 s25, s25, 196608
    s_cmp_eq_u32 s55, 1
    s_cselect_b32 s56, 1966080, 0
    s_sub_u32 s25, s25, s56
    s_waitcnt lgkmcnt(4)
    v_mfma_f32_32x32x16_bf16 v[88:103], v[56:59], v[48:51], v[88:103]
    ds_read_b128 v[52:55], v13
    ds_read_b64_tr_b16 v[72:73], v22 offset:9216
    ds_read_b64_tr_b16 v[74:75], v22 offset:9984
    s_waitcnt lgkmcnt(5)
    v_mfma_f32_32x32x16_bf16 v[104:119], v[60:63], v[48:51], v[104:119]
    ds_read_b64_tr_b16 v[76:77], v23 offset:9216
    ds_read_b64_tr_b16 v[78:79], v23 offset:9984
    s_waitcnt lgkmcnt(5)
    v_mfma_f32_32x32x16_bf16 v[120:135], v[64:67], v[48:51], v[120:135]
    ds_read_b64_tr_b16 v[80:81], v24 offset:9216
    ds_read_b64_tr_b16 v[82:83], v24 offset:9984
    s_waitcnt lgkmcnt(4)
    v_mfma_f32_32x32x16_bf16 v[88:103], v[72:75], v[52:55], v[88:103]
    s_waitcnt vmcnt(6) lgkmcnt(0)
    s_cmp_lg_u32 s20, 0
    s_cbranch_scc1 p1_kernel_F_pd
    s_mov_b32 s54, 0
p1_kernel_F_pl:
    v_and_b32 v169, v169, v172
    v_cmp_eq_u32 vcc, v169, v172
    s_add_u32 s54, s54, 1
    s_nop 0
    s_cmp_eq_u64 vcc, -1
    s_cbranch_scc1 p1_kernel_F_pd
    s_cmp_gt_u32 s54, 0x40000
    s_cbranch_scc1 p1_kernel_F_pd
    buffer_load_dword v169, v170, s[76:79], 0 offen sc0 sc1
    s_waitcnt vmcnt(0)
    s_branch p1_kernel_F_pl
p1_kernel_F_pd:
    s_barrier
    s_lshl_b32 s48, s34, 3
    s_add_u32 s48, s48, 24117248
    v_lshlrev_b32 v168, 3, v2
    buffer_load_dwordx2 v[208:209], v168, s[12:15], s48 offen sc0 sc1
    s_cmp_lg_u32 s20, 1
    s_cbranch_scc1 p1_kernel_F_nf
    s_lshl_b32 s48, s22, 12
    s_add_u32 s48, s48, 24182784
    v_lshlrev_b32 v171, 3, v1
    buffer_load_dwordx2 v[210:211], v171, s[12:15], s48 offen offset:0 sc0 sc1
    buffer_load_dwordx2 v[212:213], v171, s[12:15], s48 offen offset:512 sc0 sc1
    buffer_load_dwordx2 v[214:215], v171, s[12:15], s48 offen offset:1024 sc0 sc1
    buffer_load_dwordx2 v[216:217], v171, s[12:15], s48 offen offset:1536 sc0 sc1
    buffer_load_dwordx2 v[218:219], v171, s[12:15], s48 offen offset:2048 sc0 sc1
    buffer_load_dwordx2 v[220:221], v171, s[12:15], s48 offen offset:2560 sc0 sc1
    buffer_load_dwordx2 v[222:223], v171, s[12:15], s48 offen offset:3072 sc0 sc1
    buffer_load_dwordx2 v[224:225], v171, s[12:15], s48 offen offset:3584 sc0 sc1
p1_kernel_F_nf:
    s_add_u32 m0, s27, 0
    v_mfma_f32_32x32x16_bf16 v[104:119], v[76:79], v[52:55], v[104:119]
    ds_read_b128 v[48:51], v14
    ds_read_b64_tr_b16 v[56:57], v26 offset:0
    ds_read_b64_tr_b16 v[58:59], v26 offset:768
    buffer_load_dwordx4 v4, s[4:7], s24 offen lds
    s_add_u32 m0, s27, 1024
    v_mfma_f32_32x32x16_bf16 v[120:135], v[80:83], v[52:55], v[120:135]
    ds_read_b64_tr_b16 v[60:61], v27 offset:0
    ds_read_b64_tr_b16 v[62:63], v27 offset:768
    ds_read_b64_tr_b16 v[64:65], v28 offset:0
    ds_read_b64_tr_b16 v[66:67], v28 offset:768
    buffer_load_dwordx4 v5, s[4:7], s24 offen lds
    s_waitcnt lgkmcnt(4)
    s_add_u32 m0, s27, 2048
    v_mfma_f32_32x32x16_bf16 v[88:103], v[56:59], v[48:51], v[88:103]
    ds_read_b128 v[52:55], v15
    ds_read_b64_tr_b16 v[72:73], v26 offset:3072
    ds_read_b64_tr_b16 v[74:75], v26 offset:3840
    buffer_load_dwordx4 v6, s[4:7], s24 offen lds
    s_waitcnt lgkmcnt(5)
    v_mfma_f32_32x32x16_bf16 v[104:119], v[60:63], v[48:51], v[104:119]
    ds_read_b64_tr_b16 v[76:77], v27 offset:3072
    ds_read_b64_tr_b16 v[78:79], v27 offset:3840
    s_waitcnt lgkmcnt(5)
    s_add_u32 m0, s27, 3072
    v_mfma_f32_32x32x16_bf16 v[120:135], v[64:67], v[48:51], v[120:135]
    ds_read_b64_tr_b16 v[80:81], v28 offset:3072
    ds_read_b64_tr_b16 v[82:83], v28 offset:3840
    buffer_load_dwordx4 v7, s[4:7], s24 offen lds
    s_add_u32 s24, s24, 128
    s_cmp_eq_u32 s55, 0
    s_cselect_b32 s56, 1280, 0
    s_sub_u32 s24, s24, s56
    s_waitcnt lgkmcnt(4)
    s_add_u32 m0, s28, 0
    v_mfma_f32_32x32x16_bf16 v[88:103], v[72:75], v[52:55], v[88:103]
    ds_read_b128 v[48:51], v16
    ds_read_b64_tr_b16 v[56:57], v26 offset:6144
    ds_read_b64_tr_b16 v[58:59], v26 offset:6912
    buffer_load_dwordx4 v8, s[8:11], s25 offen lds
    s_waitcnt lgkmcnt(5)
    v_mfma_f32_32x32x16_bf16 v[104:119], v[76:79], v[52:55], v[104:119]
    ds_read_b64_tr_b16 v[60:61], v27 offset:6144
    ds_read_b64_tr_b16 v[62:63], v27 offset:6912
    s_waitcnt lgkmcnt(5)
    s_add_u32 m0, s28, 1024
    v_mfma_f32_32x32x16_bf16 v[120:135], v[80:83], v[52:55], v[120:135]
    ds_read_b64_tr_b16 v[64:65], v28 offset:6144
    ds_read_b64_tr_b16 v[66:67], v28 offset:6912
    s_mov_b64 exec, s[44:45]
    buffer_load_dwordx4 v9, s[8:11], s25 offen lds
    s_mov_b64 exec, -1
    s_add_u32 s25, s25, 196608
    s_cmp_eq_u32 s55, 0
    s_cselect_b32 s56, 1966080, 0
    s_sub_u32 s25, s25, s56
    s_waitcnt lgkmcnt(4)
    v_mfma_f32_32x32x16_bf16 v[88:103], v[56:59], v[48:51], v[88:103]
    ds_read_b128 v[52:55], v17
    ds_read_b64_tr_b16 v[72:73], v26 offset:9216
    ds_read_b64_tr_b16 v[74:75], v26 offset:9984
    s_waitcnt lgkmcnt(5)
    v_mfma_f32_32x32x16_bf16 v[104:119], v[60:63], v[48:51], v[104:119]
    ds_read_b64_tr_b16 v[76:77], v27 offset:9216
    ds_read_b64_tr_b16 v[78:79], v27 offset:9984
    s_waitcnt lgkmcnt(5)
    v_mfma_f32_32x32x16_bf16 v[120:135], v[64:67], v[48:51], v[120:135]
    ds_read_b64_tr_b16 v[80:81], v28 offset:9216
    ds_read_b64_tr_b16 v[82:83], v28 offset:9984
    s_waitcnt lgkmcnt(4)
    v_mfma_f32_32x32x16_bf16 v[88:103], v[72:75], v[52:55], v[88:103]
    s_waitcnt vmcnt(6) lgkmcnt(0)
    s_barrier
    v_mfma_f32_32x32x16_bf16 v[104:119], v[76:79], v[52:55], v[104:119]
    ds_read_b128 v[48:51], v18
    ds_read_b64_tr_b16 v[56:57], v30 offset:0
    ds_read_b64_tr_b16 v[58:59], v30 offset:768
    v_mfma_f32_32x32x16_bf16 v[120:135], v[80:83], v[52:55], v[120:135]
    ds_read_b64_tr_b16 v[60:61], v31 offset:0
    ds_read_b64_tr_b16 v[62:63], v31 offset:768
    ds_read_b64_tr_b16 v[64:65], v32 offset:0
    ds_read_b64_tr_b16 v[66:67], v32 offset:768
    s_waitcnt lgkmcnt(4)
    v_mfma_f32_32x32x16_bf16 v[88:103], v[56:59], v[48:51], v[88:103]
    ds_read_b128 v[52:55], v19
    ds_read_b64_tr_b16 v[72:73], v30 offset:3072
    ds_read_b64_tr_b16 v[74:75], v30 offset:3840
    s_waitcnt lgkmcnt(5)
    v_mfma_f32_32x32x16_bf16 v[104:119], v[60:63], v[48:51], v[104:119]
    ds_read_b64_tr_b16 v[76:77], v31 offset:3072
    ds_read_b64_tr_b16 v[78:79], v31 offset:3840
    s_waitcnt lgkmcnt(5)
    v_mfma_f32_32x32x16_bf16 v[120:135], v[64:67], v[48:51], v[120:135]
    ds_read_b64_tr_b16 v[80:81], v32 offset:3072
    ds_read_b64_tr_b16 v[82:83], v32 offset:3840
    s_waitcnt lgkmcnt(4)
    v_mfma_f32_32x32x16_bf16 v[88:103], v[72:75], v[52:55], v[88:103]
    ds_read_b128 v[48:51], v20
    ds_read_b64_tr_b16 v[56:57], v30 offset:6144
    ds_read_b64_tr_b16 v[58:59], v30 offset:6912
    s_waitcnt lgkmcnt(5)
    v_mfma_f32_32x32x16_bf16 v[104:119], v[76:79], v[52:55], v[104:119]
    ds_read_b64_tr_b16 v[60:61], v31 offset:6144
    ds_read_b64_tr_b16 v[62:63], v31 offset:6912
    s_waitcnt lgkmcnt(5)
    v_mfma_f32_32x32x16_bf16 v[120:135], v[80:83], v[52:55], v[120:135]
    ds_read_b64_tr_b16 v[64:65], v32 offset:6144
    ds_read_b64_tr_b16 v[66:67], v32 offset:6912
    s_waitcnt lgkmcnt(4)
    v_mfma_f32_32x32x16_bf16 v[88:103], v[56:59], v[48:51], v[88:103]
    ds_read_b128 v[52:55], v21
    ds_read_b64_tr_b16 v[72:73], v30 offset:9216
    ds_read_b64_tr_b16 v[74:75], v30 offset:9984
    s_waitcnt lgkmcnt(5)
    v_mfma_f32_32x32x16_bf16 v[104:119], v[60:63], v[48:51], v[104:119]
    ds_read_b64_tr_b16 v[76:77], v31 offset:9216
    ds_read_b64_tr_b16 v[78:79], v31 offset:9984
    s_waitcnt lgkmcnt(5)
    v_mfma_f32_32x32x16_bf16 v[120:135], v[64:67], v[48:51], v[120:135]
    ds_read_b64_tr_b16 v[80:81], v32 offset:9216
    ds_read_b64_tr_b16 v[82:83], v32 offset:9984
    s_waitcnt lgkmcnt(4)
    v_mfma_f32_32x32x16_bf16 v[88:103], v[72:75], v[52:55], v[88:103]
    s_waitcnt vmcnt(0) lgkmcnt(0)
    s_barrier
    v_mfma_f32_32x32x16_bf16 v[104:119], v[76:79], v[52:55], v[104:119]
    ds_read_b128 v[48:51], v10
    ds_read_b64_tr_b16 v[56:57], v22 offset:0
    ds_read_b64_tr_b16 v[58:59], v22 offset:768
    v_mfma_f32_32x32x16_bf16 v[120:135], v[80:83], v[52:55], v[120:135]
    ds_read_b64_tr_b16 v[60:61], v23 offset:0
    ds_read_b64_tr_b16 v[62:63], v23 offset:768
    ds_read_b64_tr_b16 v[64:65], v24 offset:0
    ds_read_b64_tr_b16 v[66:67], v24 offset:768
    s_waitcnt lgkmcnt(4)
    v_mfma_f32_32x32x16_bf16 v[88:103], v[56:59], v[48:51], v[88:103]
    ds_read_b128 v[52:55], v11
    ds_read_b64_tr_b16 v[72:73], v22 offset:3072
    ds_read_b64_tr_b16 v[74:75], v22 offset:3840
    s_waitcnt lgkmcnt(5)
    v_mfma_f32_32x32x16_bf16 v[104:119], v[60:63], v[48:51], v[104:119]
    ds_read_b64_tr_b16 v[76:77], v23 offset:3072
    ds_read_b64_tr_b16 v[78:79], v23 offset:3840
    s_waitcnt lgkmcnt(5)
    v_mfma_f32_32x32x16_bf16 v[120:135], v[64:67], v[48:51], v[120:135]
    ds_read_b64_tr_b16 v[80:81], v24 offset:3072
    ds_read_b64_tr_b16 v[82:83], v24 offset:3840
    s_waitcnt lgkmcnt(4)
    v_mfma_f32_32x32x16_bf16 v[88:103], v[72:75], v[52:55], v[88:103]
    ds_read_b128 v[48:51], v12
    ds_read_b64_tr_b16 v[56:57], v22 offset:6144
    ds_read_b64_tr_b16 v[58:59], v22 offset:6912
    s_waitcnt lgkmcnt(5)
    v_mfma_f32_32x32x16_bf16 v[104:119], v[76:79], v[52:55], v[104:119]
    ds_read_b64_tr_b16 v[60:61], v23 offset:6144
    ds_read_b64_tr_b16 v[62:63], v23 offset:6912
    s_waitcnt lgkmcnt(5)
    v_mfma_f32_32x32x16_bf16 v[120:135], v[80:83], v[52:55], v[120:135]
    ds_read_b64_tr_b16 v[64:65], v24 offset:6144
    ds_read_b64_tr_b16 v[66:67], v24 offset:6912
    s_waitcnt lgkmcnt(4)
    v_mfma_f32_32x32x16_bf16 v[88:103], v[56:59], v[48:51], v[88:103]
    ds_read_b128 v[52:55], v13
    ds_read_b64_tr_b16 v[72:73], v22 offset:9216
    ds_read_b64_tr_b16 v[74:75], v22 offset:9984
    s_waitcnt lgkmcnt(5)
    v_mfma_f32_32x32x16_bf16 v[104:119], v[60:63], v[48:51], v[104:119]
    ds_read_b64_tr_b16 v[76:77], v23 offset:9216
    ds_read_b64_tr_b16 v[78:79], v23 offset:9984
    s_waitcnt lgkmcnt(5)
    v_mfma_f32_32x32x16_bf16 v[120:135], v[64:67], v[48:51], v[120:135]
    ds_read_b64_tr_b16 v[80:81], v24 offset:9216
    ds_read_b64_tr_b16 v[82:83], v24 offset:9984
    s_waitcnt lgkmcnt(4)
    v_mfma_f32_32x32x16_bf16 v[88:103], v[72:75], v[52:55], v[88:103]
    s_waitcnt lgkmcnt(2)
    v_mfma_f32_32x32x16_bf16 v[104:119], v[76:79], v[52:55], v[104:119]
    s_waitcnt lgkmcnt(0)
    v_mfma_f32_32x32x16_bf16 v[120:135], v[80:83], v[52:55], v[120:135]
    s_waitcnt vmcnt(0)
    s_cmp_lg_u32 s20, 1
    s_cbranch_scc1 p1_kernel_F_nt
    v_pk_add_f32 v[210:211], v[210:211], v[212:213]
    v_pk_add_f32 v[210:211], v[210:211], v[214:215]
    v_pk_add_f32 v[210:211], v[210:211], v[216:217]
    v_pk_add_f32 v[210:211], v[210:211], v[218:219]
    v_pk_add_f32 v[210:211], v[210:211], v[220:221]
    v_pk_add_f32 v[210:211], v[210:211], v[222:223]
    v_pk_add_f32 v[210:211], v[210:211], v[224:225]
    v_add_u32 v171, 152064, v171
    ds_write_b64 v171, v[210:211]
p1_kernel_F_nt:
    v_mul_f32 v208, 0x3acccccd, v208
    v_mul_f32 v209, 0x3acccccd, v209
    v_fma_f32 v209, -v208, v208, v209
    v_max_f32 v209, 0, v209
    v_add_f32 v35, 0x3727c5ac, v209
    v_rsq_f32 v42, v35
    s_nop 0
    v_mul_f32 v35, v42, v42
    v_mul_f32 v35, v35, v209
    v_add_f32 v35, 0x3727c5ac, v35
    v_rsq_f32 v35, v35
    s_nop 0
    v_mul_f32 v42, v42, v35
    v_mul_f32 v44, v208, v42
    v_sub_f32 v44, 0, v44
    v_mov_b32 v43, v42
    v_mov_b32 v45, v44
    s_mul_i32 s49, s34, 3072
    s_add_u32 s49, s49, 10485760
    s_lshl_b32 s51, s33, 6
    s_add_u32 s49, s49, s51
    v_lshlrev_b32 v39, 4, v1
    v_mov_b32 v46, 0xc0135761
    v_mov_b32 v47, 0xc0135761
    v_mov_b32 v200, 0xbdd2d3e8
    v_mov_b32 v201, 0xbdd2d3e8
    v_mov_b32 v202, 0x3f800000
    v_mov_b32 v203, 0x3f800000
    s_waitcnt lgkmcnt(0)
    s_barrier
    s_lshl_b32 s48, s29, 7
    s_add_u32 s48, s48, 147456
    v_lshl_add_u32 v34, v3, 4, s48
    ds_read_b128 v[152:155], v34 offset:4608
    ds_read_b128 v[168:171], v34 offset:5120
    ds_read_b128 v[156:159], v34 offset:4640
    ds_read_b128 v[172:175], v34 offset:5152
    ds_read_b128 v[160:163], v34 offset:4672
    ds_read_b128 v[176:179], v34 offset:5184
    ds_read_b128 v[164:167], v34 offset:4704
    ds_read_b128 v[180:183], v34 offset:5216
    s_waitcnt lgkmcnt(0)
    v_pk_fma_f32 v[168:169], v[152:153], v[44:45], v[168:169]
    v_pk_fma_f32 v[170:171], v[154:155], v[44:45], v[170:171]
    v_pk_fma_f32 v[172:173], v[156:157], v[44:45], v[172:173]
    v_pk_fma_f32 v[174:175], v[158:159], v[44:45], v[174:175]
    v_pk_fma_f32 v[176:177], v[160:161], v[44:45], v[176:177]
    v_pk_fma_f32 v[178:179], v[162:163], v[44:45], v[178:179]
    v_pk_fma_f32 v[180:181], v[164:165], v[44:45], v[180:181]
    v_pk_fma_f32 v[182:183], v[166:167], v[44:45], v[182:183]
    v_pk_fma_f32 v[88:89], v[88:89], v[42:43], v[168:169]
    v_pk_fma_f32 v[90:91], v[90:91], v[42:43], v[170:171]
    v_pk_fma_f32 v[92:93], v[92:93], v[42:43], v[172:173]
    v_pk_fma_f32 v[94:95], v[94:95], v[42:43], v[174:175]
    v_pk_fma_f32 v[96:97], v[96:97], v[42:43], v[176:177]
    v_pk_fma_f32 v[98:99], v[98:99], v[42:43], v[178:179]
    v_pk_fma_f32 v[100:101], v[100:101], v[42:43], v[180:181]
    v_pk_fma_f32 v[102:103], v[102:103], v[42:43], v[182:183]
    v_pk_mul_f32 v[152:153], v[88:89], v[88:89]
    v_pk_mul_f32 v[154:155], v[90:91], v[90:91]
    v_pk_mul_f32 v[156:157], v[92:93], v[92:93]
    v_pk_mul_f32 v[158:159], v[94:95], v[94:95]
    v_pk_mul_f32 v[160:161], v[96:97], v[96:97]
    v_pk_mul_f32 v[162:163], v[98:99], v[98:99]
    v_pk_mul_f32 v[164:165], v[100:101], v[100:101]
    v_pk_mul_f32 v[166:167], v[102:103], v[102:103]
    v_pk_fma_f32 v[152:153], v[152:153], v[200:201], v[46:47]
    v_pk_fma_f32 v[154:155], v[154:155], v[200:201], v[46:47]
    v_pk_fma_f32 v[156:157], v[156:157], v[200:201], v[46:47]
    v_pk_fma_f32 v[158:159], v[158:159], v[200:201], v[46:47]
    v_pk_fma_f32 v[160:161], v[160:161], v[200:201], v[46:47]
    v_pk_fma_f32 v[162:163], v[162:163], v[200:201], v[46:47]
    v_pk_fma_f32 v[164:165], v[164:165], v[200:201], v[46:47]
    v_pk_fma_f32 v[166:167], v[166:167], v[200:201], v[46:47]
    v_pk_mul_f32 v[152:153], v[152:153], v[88:89]
    v_pk_mul_f32 v[154:155], v[154:155], v[90:91]
    v_pk_mul_f32 v[156:157], v[156:157], v[92:93]
    v_pk_mul_f32 v[158:159], v[158:159], v[94:95]
    v_pk_mul_f32 v[160:161], v[160:161], v[96:97]
    v_pk_mul_f32 v[162:163], v[162:163], v[98:99]
    v_pk_mul_f32 v[164:165], v[164:165], v[100:101]
    v_pk_mul_f32 v[166:167], v[166:167], v[102:103]
    v_exp_f32 v152, v152
    v_exp_f32 v153, v153
    v_exp_f32 v154, v154
    v_exp_f32 v155, v155
    v_exp_f32 v156, v156
    v_exp_f32 v157, v157
    v_exp_f32 v158, v158
    v_exp_f32 v159, v159
    v_exp_f32 v160, v160
    v_exp_f32 v161, v161
    v_exp_f32 v162, v162
    v_exp_f32 v163, v163
    v_exp_f32 v164, v164
    v_exp_f32 v165, v165
    v_exp_f32 v166, v166
    v_exp_f32 v167, v167
    v_pk_add_f32 v[152:153], v[152:153], v[202:203]
    v_pk_add_f32 v[154:155], v[154:155], v[202:203]
    v_pk_add_f32 v[156:157], v[156:157], v[202:203]
    v_pk_add_f32 v[158:159], v[158:159], v[202:203]
    v_pk_add_f32 v[160:161], v[160:161], v[202:203]
    v_pk_add_f32 v[162:163], v[162:163], v[202:203]
    v_pk_add_f32 v[164:165], v[164:165], v[202:203]
    v_pk_add_f32 v[166:167], v[166:167], v[202:203]
    v_rcp_f32 v152, v152
    v_rcp_f32 v153, v153
    v_rcp_f32 v154, v154
    v_rcp_f32 v155, v155
    v_rcp_f32 v156, v156
    v_rcp_f32 v157, v157
    v_rcp_f32 v158, v158
    v_rcp_f32 v159, v159
    v_rcp_f32 v160, v160
    v_rcp_f32 v161, v161
    v_rcp_f32 v162, v162
    v_rcp_f32 v163, v163
    v_rcp_f32 v164, v164
    v_rcp_f32 v165, v165
    v_rcp_f32 v166, v166
    v_rcp_f32 v167, v167
    v_pk_mul_f32 v[88:89], v[88:89], v[152:153]
    v_pk_mul_f32 v[90:91], v[90:91], v[154:155]
    v_pk_mul_f32 v[92:93], v[92:93], v[156:157]
    v_pk_mul_f32 v[94:95], v[94:95], v[158:159]
    v_pk_mul_f32 v[96:97], v[96:97], v[160:161]
    v_pk_mul_f32 v[98:99], v[98:99], v[162:163]
    v_pk_mul_f32 v[100:101], v[100:101], v[164:165]
    v_pk_mul_f32 v[102:103], v[102:103], v[166:167]
    v_cvt_pk_bf16_f32 v184, v88, v89
    v_cvt_pk_bf16_f32 v185, v90, v91
    v_cvt_pk_bf16_f32 v186, v92, v93
    v_cvt_pk_bf16_f32 v187, v94, v95
    v_cvt_pk_bf16_f32 v188, v96, v97
    v_cvt_pk_bf16_f32 v189, v98, v99
    v_cvt_pk_bf16_f32 v190, v100, v101
    v_cvt_pk_bf16_f32 v191, v102, v103
    s_nop 1
    v_permlane32_swap_b32 v184, v186
    v_permlane32_swap_b32 v185, v187
    v_permlane32_swap_b32 v188, v190
    v_permlane32_swap_b32 v189, v191
    s_lshl_b32 s48, s29, 11
    s_add_u32 s48, s48, s49
    buffer_store_dwordx4 v[184:187], v39, s[12:15], s48 offen offset:0 sc1
    buffer_store_dwordx4 v[188:191], v39, s[12:15], s48 offen offset:1024 sc1
    s_lshl_b32 s48, s30, 7
    s_add_u32 s48, s48, 147456
    v_lshl_add_u32 v34, v3, 4, s48
    ds_read_b128 v[152:155], v34 offset:4608
    ds_read_b128 v[168:171], v34 offset:5120
    ds_read_b128 v[156:159], v34 offset:4640
    ds_read_b128 v[172:175], v34 offset:5152
    ds_read_b128 v[160:163], v34 offset:4672
    ds_read_b128 v[176:179], v34 offset:5184
    ds_read_b128 v[164:167], v34 offset:4704
    ds_read_b128 v[180:183], v34 offset:5216
    s_waitcnt lgkmcnt(0)
    v_pk_fma_f32 v[168:169], v[152:153], v[44:45], v[168:169]
    v_pk_fma_f32 v[170:171], v[154:155], v[44:45], v[170:171]
    v_pk_fma_f32 v[172:173], v[156:157], v[44:45], v[172:173]
    v_pk_fma_f32 v[174:175], v[158:159], v[44:45], v[174:175]
    v_pk_fma_f32 v[176:177], v[160:161], v[44:45], v[176:177]
    v_pk_fma_f32 v[178:179], v[162:163], v[44:45], v[178:179]
    v_pk_fma_f32 v[180:181], v[164:165], v[44:45], v[180:181]
    v_pk_fma_f32 v[182:183], v[166:167], v[44:45], v[182:183]
    v_pk_fma_f32 v[104:105], v[104:105], v[42:43], v[168:169]
    v_pk_fma_f32 v[106:107], v[106:107], v[42:43], v[170:171]
    v_pk_fma_f32 v[108:109], v[108:109], v[42:43], v[172:173]
    v_pk_fma_f32 v[110:111], v[110:111], v[42:43], v[174:175]
    v_pk_fma_f32 v[112:113], v[112:113], v[42:43], v[176:177]
    v_pk_fma_f32 v[114:115], v[114:115], v[42:43], v[178:179]
    v_pk_fma_f32 v[116:117], v[116:117], v[42:43], v[180:181]
    v_pk_fma_f32 v[118:119], v[118:119], v[42:43], v[182:183]
    v_pk_mul_f32 v[152:153], v[104:105], v[104:105]
    v_pk_mul_f32 v[154:155], v[106:107], v[106:107]
    v_pk_mul_f32 v[156:157], v[108:109], v[108:109]
    v_pk_mul_f32 v[158:159], v[110:111], v[110:111]
    v_pk_mul_f32 v[160:161], v[112:113], v[112:113]
    v_pk_mul_f32 v[162:163], v[114:115], v[114:115]
    v_pk_mul_f32 v[164:165], v[116:117], v[116:117]
    v_pk_mul_f32 v[166:167], v[118:119], v[118:119]
    v_pk_fma_f32 v[152:153], v[152:153], v[200:201], v[46:47]
    v_pk_fma_f32 v[154:155], v[154:155], v[200:201], v[46:47]
    v_pk_fma_f32 v[156:157], v[156:157], v[200:201], v[46:47]
    v_pk_fma_f32 v[158:159], v[158:159], v[200:201], v[46:47]
    v_pk_fma_f32 v[160:161], v[160:161], v[200:201], v[46:47]
    v_pk_fma_f32 v[162:163], v[162:163], v[200:201], v[46:47]
    v_pk_fma_f32 v[164:165], v[164:165], v[200:201], v[46:47]
    v_pk_fma_f32 v[166:167], v[166:167], v[200:201], v[46:47]
    v_pk_mul_f32 v[152:153], v[152:153], v[104:105]
    v_pk_mul_f32 v[154:155], v[154:155], v[106:107]
    v_pk_mul_f32 v[156:157], v[156:157], v[108:109]
    v_pk_mul_f32 v[158:159], v[158:159], v[110:111]
    v_pk_mul_f32 v[160:161], v[160:161], v[112:113]
    v_pk_mul_f32 v[162:163], v[162:163], v[114:115]
    v_pk_mul_f32 v[164:165], v[164:165], v[116:117]
    v_pk_mul_f32 v[166:167], v[166:167], v[118:119]
    v_exp_f32 v152, v152
    v_exp_f32 v153, v153
    v_exp_f32 v154, v154
    v_exp_f32 v155, v155
    v_exp_f32 v156, v156
    v_exp_f32 v157, v157
    v_exp_f32 v158, v158
    v_exp_f32 v159, v159
    v_exp_f32 v160, v160
    v_exp_f32 v161, v161
    v_exp_f32 v162, v162
    v_exp_f32 v163, v163
    v_exp_f32 v164, v164
    v_exp_f32 v165, v165
    v_exp_f32 v166, v166
    v_exp_f32 v167, v167
    v_pk_add_f32 v[152:153], v[152:153], v[202:203]
    v_pk_add_f32 v[154:155], v[154:155], v[202:203]
    v_pk_add_f32 v[156:157], v[156:157], v[202:203]
    v_pk_add_f32 v[158:159], v[158:159], v[202:203]
    v_pk_add_f32 v[160:161], v[160:161], v[202:203]
    v_pk_add_f32 v[162:163], v[162:163], v[202:203]
    v_pk_add_f32 v[164:165], v[164:165], v[202:203]
    v_pk_add_f32 v[166:167], v[166:167], v[202:203]
    v_rcp_f32 v152, v152
    v_rcp_f32 v153, v153
    v_rcp_f32 v154, v154
    v_rcp_f32 v155, v155
    v_rcp_f32 v156, v156
    v_rcp_f32 v157, v157
    v_rcp_f32 v158, v158
    v_rcp_f32 v159, v159
    v_rcp_f32 v160, v160
    v_rcp_f32 v161, v161
    v_rcp_f32 v162, v162
    v_rcp_f32 v163, v163
    v_rcp_f32 v164, v164
    v_rcp_f32 v165, v165
    v_rcp_f32 v166, v166
    v_rcp_f32 v167, v167
    v_pk_mul_f32 v[104:105], v[104:105], v[152:153]
    v_pk_mul_f32 v[106:107], v[106:107], v[154:155]
    v_pk_mul_f32 v[108:109], v[108:109], v[156:157]
    v_pk_mul_f32 v[110:111], v[110:111], v[158:159]
    v_pk_mul_f32 v[112:113], v[112:113], v[160:161]
    v_pk_mul_f32 v[114:115], v[114:115], v[162:163]
    v_pk_mul_f32 v[116:117], v[116:117], v[164:165]
    v_pk_mul_f32 v[118:119], v[118:119], v[166:167]
    v_cvt_pk_bf16_f32 v192, v104, v105
    v_cvt_pk_bf16_f32 v193, v106, v107
    v_cvt_pk_bf16_f32 v194, v108, v109
    v_cvt_pk_bf16_f32 v195, v110, v111
    v_cvt_pk_bf16_f32 v196, v112, v113
    v_cvt_pk_bf16_f32 v197, v114, v115
    v_cvt_pk_bf16_f32 v198, v116, v117
    v_cvt_pk_bf16_f32 v199, v118, v119
    s_nop 1
    v_permlane32_swap_b32 v192, v194
    v_permlane32_swap_b32 v193, v195
    v_permlane32_swap_b32 v196, v198
    v_permlane32_swap_b32 v197, v199
    s_lshl_b32 s48, s30, 11
    s_add_u32 s48, s48, s49
    buffer_store_dwordx4 v[192:195], v39, s[12:15], s48 offen offset:0 sc1
    buffer_store_dwordx4 v[196:199], v39, s[12:15], s48 offen offset:1024 sc1
    s_lshl_b32 s48, s31, 7
    s_add_u32 s48, s48, 147456
    v_lshl_add_u32 v34, v3, 4, s48
    ds_read_b128 v[152:155], v34 offset:4608
    ds_read_b128 v[168:171], v34 offset:5120
    ds_read_b128 v[156:159], v34 offset:4640
    ds_read_b128 v[172:175], v34 offset:5152
    ds_read_b128 v[160:163], v34 offset:4672
    ds_read_b128 v[176:179], v34 offset:5184
    ds_read_b128 v[164:167], v34 offset:4704
    ds_read_b128 v[180:183], v34 offset:5216
    s_waitcnt lgkmcnt(0)
    v_pk_fma_f32 v[168:169], v[152:153], v[44:45], v[168:169]
    v_pk_fma_f32 v[170:171], v[154:155], v[44:45], v[170:171]
    v_pk_fma_f32 v[172:173], v[156:157], v[44:45], v[172:173]
    v_pk_fma_f32 v[174:175], v[158:159], v[44:45], v[174:175]
    v_pk_fma_f32 v[176:177], v[160:161], v[44:45], v[176:177]
    v_pk_fma_f32 v[178:179], v[162:163], v[44:45], v[178:179]
    v_pk_fma_f32 v[180:181], v[164:165], v[44:45], v[180:181]
    v_pk_fma_f32 v[182:183], v[166:167], v[44:45], v[182:183]
    v_pk_fma_f32 v[120:121], v[120:121], v[42:43], v[168:169]
    v_pk_fma_f32 v[122:123], v[122:123], v[42:43], v[170:171]
    v_pk_fma_f32 v[124:125], v[124:125], v[42:43], v[172:173]
    v_pk_fma_f32 v[126:127], v[126:127], v[42:43], v[174:175]
    v_pk_fma_f32 v[128:129], v[128:129], v[42:43], v[176:177]
    v_pk_fma_f32 v[130:131], v[130:131], v[42:43], v[178:179]
    v_pk_fma_f32 v[132:133], v[132:133], v[42:43], v[180:181]
    v_pk_fma_f32 v[134:135], v[134:135], v[42:43], v[182:183]
    v_pk_mul_f32 v[152:153], v[120:121], v[120:121]
    v_pk_mul_f32 v[154:155], v[122:123], v[122:123]
    v_pk_mul_f32 v[156:157], v[124:125], v[124:125]
    v_pk_mul_f32 v[158:159], v[126:127], v[126:127]
    v_pk_mul_f32 v[160:161], v[128:129], v[128:129]
    v_pk_mul_f32 v[162:163], v[130:131], v[130:131]
    v_pk_mul_f32 v[164:165], v[132:133], v[132:133]
    v_pk_mul_f32 v[166:167], v[134:135], v[134:135]
    v_pk_fma_f32 v[152:153], v[152:153], v[200:201], v[46:47]
    v_pk_fma_f32 v[154:155], v[154:155], v[200:201], v[46:47]
    v_pk_fma_f32 v[156:157], v[156:157], v[200:201], v[46:47]
    v_pk_fma_f32 v[158:159], v[158:159], v[200:201], v[46:47]
    v_pk_fma_f32 v[160:161], v[160:161], v[200:201], v[46:47]
    v_pk_fma_f32 v[162:163], v[162:163], v[200:201], v[46:47]
    v_pk_fma_f32 v[164:165], v[164:165], v[200:201], v[46:47]
    v_pk_fma_f32 v[166:167], v[166:167], v[200:201], v[46:47]
    v_pk_mul_f32 v[152:153], v[152:153], v[120:121]
    v_pk_mul_f32 v[154:155], v[154:155], v[122:123]
    v_pk_mul_f32 v[156:157], v[156:157], v[124:125]
    v_pk_mul_f32 v[158:159], v[158:159], v[126:127]
    v_pk_mul_f32 v[160:161], v[160:161], v[128:129]
    v_pk_mul_f32 v[162:163], v[162:163], v[130:131]
    v_pk_mul_f32 v[164:165], v[164:165], v[132:133]
    v_pk_mul_f32 v[166:167], v[166:167], v[134:135]
    v_exp_f32 v152, v152
    v_exp_f32 v153, v153
    v_exp_f32 v154, v154
    v_exp_f32 v155, v155
    v_exp_f32 v156, v156
    v_exp_f32 v157, v157
    v_exp_f32 v158, v158
    v_exp_f32 v159, v159
    v_exp_f32 v160, v160
    v_exp_f32 v161, v161
    v_exp_f32 v162, v162
    v_exp_f32 v163, v163
    v_exp_f32 v164, v164
    v_exp_f32 v165, v165
    v_exp_f32 v166, v166
    v_exp_f32 v167, v167
    v_pk_add_f32 v[152:153], v[152:153], v[202:203]
    v_pk_add_f32 v[154:155], v[154:155], v[202:203]
    v_pk_add_f32 v[156:157], v[156:157], v[202:203]
    v_pk_add_f32 v[158:159], v[158:159], v[202:203]
    v_pk_add_f32 v[160:161], v[160:161], v[202:203]
    v_pk_add_f32 v[162:163], v[162:163], v[202:203]
    v_pk_add_f32 v[164:165], v[164:165], v[202:203]
    v_pk_add_f32 v[166:167], v[166:167], v[202:203]
    v_rcp_f32 v152, v152
    v_rcp_f32 v153, v153
    v_rcp_f32 v154, v154
    v_rcp_f32 v155, v155
    v_rcp_f32 v156, v156
    v_rcp_f32 v157, v157
    v_rcp_f32 v158, v158
    v_rcp_f32 v159, v159
    v_rcp_f32 v160, v160
    v_rcp_f32 v161, v161
    v_rcp_f32 v162, v162
    v_rcp_f32 v163, v163
    v_rcp_f32 v164, v164
    v_rcp_f32 v165, v165
    v_rcp_f32 v166, v166
    v_rcp_f32 v167, v167
    v_pk_mul_f32 v[120:121], v[120:121], v[152:153]
    v_pk_mul_f32 v[122:123], v[122:123], v[154:155]
    v_pk_mul_f32 v[124:125], v[124:125], v[156:157]
    v_pk_mul_f32 v[126:127], v[126:127], v[158:159]
    v_pk_mul_f32 v[128:129], v[128:129], v[160:161]
    v_pk_mul_f32 v[130:131], v[130:131], v[162:163]
    v_pk_mul_f32 v[132:133], v[132:133], v[164:165]
    v_pk_mul_f32 v[134:135], v[134:135], v[166:167]
    v_cvt_pk_bf16_f32 v184, v120, v121
    v_cvt_pk_bf16_f32 v185, v122, v123
    v_cvt_pk_bf16_f32 v186, v124, v125
    v_cvt_pk_bf16_f32 v187, v126, v127
    v_cvt_pk_bf16_f32 v188, v128, v129
    v_cvt_pk_bf16_f32 v189, v130, v131
    v_cvt_pk_bf16_f32 v190, v132, v133
    v_cvt_pk_bf16_f32 v191, v134, v135
    s_nop 1
    v_permlane32_swap_b32 v184, v186
    v_permlane32_swap_b32 v185, v187
    v_permlane32_swap_b32 v188, v190
    v_permlane32_swap_b32 v189, v191
    s_lshl_b32 s48, s31, 11
    s_add_u32 s48, s48, s49
    buffer_store_dwordx4 v[184:187], v39, s[12:15], s48 offen offset:0 sc1
    buffer_store_dwordx4 v[188:191], v39, s[12:15], s48 offen offset:1024 sc1
    s_endpgm
p1_kernel_S:
    buffer_load_dwordx4 v[152:155], v182, s[4:7], s53 offen
    buffer_load_dword v156, v183, s[4:7], s53 offen offset:1024
    v_mov_b32 v218, -1
    v_mov_b32 v219, -1
    v_mov_b32 v220, -1
    v_mov_b32 v221, -1
    s_mul_i32 s48, s2, 10240
    s_add_u32 s48, s48, 16777216
    s_add_u32 s49, s48, 8192
    v_lshlrev_b32 v222, 4, v0
    v_lshlrev_b32 v223, 2, v0
    buffer_store_dwordx4 v[218:221], v222, s[12:15], s48 offen sc1
    buffer_store_dword v218, v223, s[12:15], s49 offen sc1
    s_lshl_b32 s84, s2, 3
    s_add_u32 s84, s84, s20
    s_cmp_ge_u32 s84, 1920
    s_cselect_b32 s85, 1920, 0
    s_cselect_b32 s88, s82, s80
    s_cselect_b32 s89, s83, s81
    s_mov_b32 s90, 1966080
    s_mov_b32 s93, 27262976
    s_cselect_b32 s90, 819200, s90
    s_cselect_b32 s93, 30408704, s93
    s_cselect_b32 s94, 40, 96
    s_and_b32 s89, s89, 0xffff
    s_mov_b32 s91, 0x00020000
    s_sub_u32 s84, s84, s85
    s_mul_i32 s86, s84, 3277
    s_lshr_b32 s86, s86, 16
    s_mul_i32 s87, s86, 20
    s_sub_u32 s87, s84, s87
    s_mul_i32 s95, s87, 205
    s_lshr_b32 s95, s95, 10
    s_mul_i32 s96, s95, 5
    s_sub_u32 s96, s87, s96
    s_mul_i32 s95, s95, s94
    s_add_u32 s95, s95, s86
    s_mul_i32 s95, s95, 5
    s_add_u32 s95, s95, s96
    s_lshl_b32 s95, s95, 10
    s_add_u32 s92, s95, s93
    v_lshrrev_b32 v218, 2, v1
    s_mul_i32 s95, s86, 16
    s_cmp_eq_u32 s85, 0
    s_cbranch_scc1 p1_kernel_S_tr0_rows
    s_cmp_ge_u32 s86, 32
    s_cbranch_scc1 p1_kernel_S_tr0_tb
    s_mul_i32 s95, s86, 20
    v_lshrrev_b32 v219, 3, v218
    v_lshl_add_u32 v218, v219, 1, v218
    s_branch p1_kernel_S_tr0_rows
p1_kernel_S_tr0_tb:
    s_sub_u32 s95, s86, 32
    s_mul_i32 s95, s95, 80
    s_add_u32 s95, s95, 8
    v_lshrrev_b32 v219, 1, v218
    v_and_b32 v218, 1, v218
    v_mad_u32_u24 v218, v219, 10, v218
p1_kernel_S_tr0_rows:
    s_mul_i32 s95, s95, 1280
    s_lshl_b32 s96, s87, 6
    s_add_u32 s95, s95, s96
    v_mul_u32_u24 v218, 1280, v218
    v_and_b32 v219, 3, v1
    v_lshl_add_u32 v218, v219, 4, v218
    s_lshl_b32 s96, s20, 10
    s_add_u32 m0, s96, 155136
    s_nop 0
    buffer_load_dwordx4 v218, s[88:91], s95 offen lds
p1_kernel_S_tr0_end:
    s_waitcnt vmcnt(0)
    s_cmp_eq_u32 s92, -1
    s_cbranch_scc1 p1_kernel_S_tr0_fin
    v_bfe_u32 v218, v1, 2, 2
    v_lshl_add_u32 v218, v3, 3, v218
    v_lshlrev_b32 v218, 6, v218
    v_bfe_u32 v219, v1, 4, 1
    v_lshl_add_u32 v218, v219, 5, v218
    v_and_b32 v219, 3, v1
    v_lshl_add_u32 v218, v219, 3, v218
    s_lshl_b32 s96, s20, 10
    s_add_u32 s96, s96, 155136
    v_add_u32 v218, s96, v218
    ds_read_b64_tr_b16 v[220:221], v218
    ds_read_b64_tr_b16 v[222:223], v218 offset:256
    v_lshlrev_b32 v219, 4, v1
    s_waitcnt lgkmcnt(0)
    buffer_store_dwordx4 v[220:223], v219, s[12:15], s92 offen sc1
p1_kernel_S_tr0_fin:
    s_lshl_b32 s84, s2, 3
    s_add_u32 s84, s84, s20
    s_mov_b32 s92, -1
    s_cmp_ge_u32 s84, 672
    s_cbranch_scc1 p1_kernel_S_tr1_end
    s_add_u32 s84, s84, 2048
    s_cmp_ge_u32 s84, 1920
    s_cselect_b32 s85, 1920, 0
    s_cselect_b32 s88, s82, s80
    s_cselect_b32 s89, s83, s81
    s_mov_b32 s90, 1966080
    s_mov_b32 s93, 27262976
    s_cselect_b32 s90, 819200, s90
    s_cselect_b32 s93, 30408704, s93
    s_cselect_b32 s94, 40, 96
    s_and_b32 s89, s89, 0xffff
    s_mov_b32 s91, 0x00020000
    s_sub_u32 s84, s84, s85
    s_mul_i32 s86, s84, 3277
    s_lshr_b32 s86, s86, 16
    s_mul_i32 s87, s86, 20
    s_sub_u32 s87, s84, s87
    s_mul_i32 s95, s87, 205
    s_lshr_b32 s95, s95, 10
    s_mul_i32 s96, s95, 5
    s_sub_u32 s96, s87, s96
    s_mul_i32 s95, s95, s94
    s_add_u32 s95, s95, s86
    s_mul_i32 s95, s95, 5
    s_add_u32 s95, s95, s96
    s_lshl_b32 s95, s95, 10
    s_add_u32 s92, s95, s93
    v_lshrrev_b32 v218, 2, v1
    s_mul_i32 s95, s86, 16
    s_cmp_eq_u32 s85, 0
    s_cbranch_scc1 p1_kernel_S_tr1_rows
    s_cmp_ge_u32 s86, 32
    s_cbranch_scc1 p1_kernel_S_tr1_tb
    s_mul_i32 s95, s86, 20
    v_lshrrev_b32 v219, 3, v218
    v_lshl_add_u32 v218, v219, 1, v218
    s_branch p1_kernel_S_tr1_rows
p1_kernel_S_tr1_tb:
    s_sub_u32 s95, s86, 32
    s_mul_i32 s95, s95, 80
    s_add_u32 s95, s95, 8
    v_lshrrev_b32 v219, 1, v218
    v_and_b32 v218, 1, v218
    v_mad_u32_u24 v218, v219, 10, v218
p1_kernel_S_tr1_rows:
    s_mul_i32 s95, s95, 1280
    s_lshl_b32 s96, s87, 6
    s_add_u32 s95, s95, s96
    v_mul_u32_u24 v218, 1280, v218
    v_and_b32 v219, 3, v1
    v_lshl_add_u32 v218, v219, 4, v218
    s_lshl_b32 s96, s20, 10
    s_add_u32 m0, s96, 155136
    s_nop 0
    buffer_load_dwordx4 v218, s[88:91], s95 offen lds
p1_kernel_S_tr1_end:
    s_waitcnt vmcnt(0)
    s_cmp_eq_u32 s92, -1
    s_cbranch_scc1 p1_kernel_S_tr1_fin
    v_bfe_u32 v218, v1, 2, 2
    v_lshl_add_u32 v218, v3, 3, v218
    v_lshlrev_b32 v218, 6, v218
    v_bfe_u32 v219, v1, 4, 1
    v_lshl_add_u32 v218, v219, 5, v218
    v_and_b32 v219, 3, v1
    v_lshl_add_u32 v218, v219, 3, v218
    s_lshl_b32 s96, s20, 10
    s_add_u32 s96, s96, 155136
    v_add_u32 v218, s96, v218
    ds_read_b64_tr_b16 v[220:221], v218
    ds_read_b64_tr_b16 v[222:223], v218 offset:256
    v_lshlrev_b32 v219, 4, v1
    s_waitcnt lgkmcnt(0)
    buffer_store_dwordx4 v[220:223], v219, s[12:15], s92 offen sc1
p1_kernel_S_tr1_fin:
    s_waitcnt vmcnt(0)
    v_and_b32 v168, 0xffff0000, v152
    v_lshlrev_b32 v169, 16, v152
    v_and_b32 v170, 0xffff0000, v153
    v_lshlrev_b32 v171, 16, v153
    v_and_b32 v172, 0xffff0000, v154
    v_lshlrev_b32 v173, 16, v154
    v_and_b32 v174, 0xffff0000, v155
    v_lshlrev_b32 v175, 16, v155
    v_and_b32 v176, 0xffff0000, v156
    v_lshlrev_b32 v177, 16, v156
    v_add_f32 v178, v168, v169
    v_mul_f32 v179, v168, v168
    v_fmac_f32 v179, v169, v169
    v_add_f32 v178, v178, v170
    v_fmac_f32 v179, v170, v170
    v_add_f32 v178, v178, v171
    v_fmac_f32 v179, v171, v171
    v_add_f32 v178, v178, v172
    v_fmac_f32 v179, v172, v172
    v_add_f32 v178, v178, v173
    v_fmac_f32 v179, v173, v173
    v_add_f32 v178, v178, v174
    v_fmac_f32 v179, v174, v174
    v_add_f32 v178, v178, v175
    v_fmac_f32 v179, v175, v175
    v_add_f32 v178, v178, v176
    v_fmac_f32 v179, v176, v176
    v_add_f32 v178, v178, v177
    v_fmac_f32 v179, v177, v177
    s_nop 1
    v_add_f32_dpp v178, v178, v178 row_shr:1 row_mask:0xf bank_mask:0xf bound_ctrl:0
    v_add_f32_dpp v179, v179, v179 row_shr:1 row_mask:0xf bank_mask:0xf bound_ctrl:0
    s_nop 1
    v_add_f32_dpp v178, v178, v178 row_shr:2 row_mask:0xf bank_mask:0xf bound_ctrl:0
    v_add_f32_dpp v179, v179, v179 row_shr:2 row_mask:0xf bank_mask:0xf bound_ctrl:0
    s_nop 1
    v_add_f32_dpp v178, v178, v178 row_shr:4 row_mask:0xf bank_mask:0xf bound_ctrl:0
    v_add_f32_dpp v179, v179, v179 row_shr:4 row_mask:0xf bank_mask:0xf bound_ctrl:0
    s_nop 1
    v_add_f32_dpp v178, v178, v178 row_shr:8 row_mask:0xf bank_mask:0xf bound_ctrl:0
    v_add_f32_dpp v179, v179, v179 row_shr:8 row_mask:0xf bank_mask:0xf bound_ctrl:0
    s_nop 1
    v_add_f32_dpp v178, v178, v178 row_bcast:15 row_mask:0xa bank_mask:0xf
    v_add_f32_dpp v179, v179, v179 row_bcast:15 row_mask:0xa bank_mask:0xf
    s_nop 1
    v_add_f32_dpp v178, v178, v178 row_bcast:31 row_mask:0xc bank_mask:0xf
    v_add_f32_dpp v179, v179, v179 row_bcast:31 row_mask:0xc bank_mask:0xf
    s_lshl_b32 s48, s20, 3
    v_mov_b32 v168, s48
    v_add_u32 v168, 151552, v168
    s_mov_b32 s48, 0
    s_mov_b32 s49, 0x80000000
    s_mov_b64 exec, s[48:49]
    ds_write_b64 v168, v[178:179]
    s_mov_b64 exec, -1
    s_waitcnt lgkmcnt(0)
    s_barrier
    s_cmp_lg_u32 s20, 0
    s_cbranch_scc1 p1_kernel_end
    v_lshlrev_b32 v168, 3, v1
    v_add_u32 v169, 151552, v168
    s_mov_b64 exec, 0xff
    ds_read_b64 v[170:171], v169
    s_lshl_b32 s48, s21, 11
    s_lshl_b32 s49, s22, 6
    s_add_u32 s48, s48, s49
    s_add_u32 s48, s48, 24117248
    s_waitcnt lgkmcnt(0)
    buffer_store_dwordx2 v[170:171], v168, s[12:15], s48 offen sc0 sc1
    s_mov_b64 exec, -1
    s_waitcnt vmcnt(0)
    s_mov_b64 exec, 1
    v_mov_b32 v168, 1
    v_mov_b32 v169, 0
    s_lshl_b32 s48, s21, 5
    s_add_u32 s48, s48, s22
    buffer_store_byte v168, v169, s[76:79], s48 offen sc0 sc1
    s_mov_b64 exec, -1
p1_kernel_end:
    s_endpgm
.globl attn_kernel
.p2align 8
.type attn_kernel,@function
attn_kernel:
    s_cmp_ge_u32 s2, 256
    s_cbranch_scc1 attn_kernel_end
    s_load_dwordx2 s[24:25], s[0:1], 80
    v_lshrrev_b32 v4, 6, v0
    v_and_b32 v7, 63, v0
    s_and_b32 s26, s2, 7
    v_readfirstlane_b32 s10, v4
    s_nop 3
    s_cmp_ge_u32 s10, 8
    s_cbranch_scc1 attn_kernel_ffn2
    s_lshr_b32 s27, s2, 3
    s_and_b32 s28, s27, 3
    s_lshl_b32 s26, s26, 2
    s_add_u32 s8, s26, s28
    s_lshr_b32 s9, s27, 2
    s_and_b32 s11, s10, 1
    s_lshr_b32 s12, s10, 1
    s_mov_b32 s20, 0
    s_mov_b32 s21, -1
    s_mov_b32 s32, -1
    s_mov_b32 s33, 0
    s_mov_b32 s34, 0x33ffff
    s_mov_b32 s35, 0x33ffff
    s_mov_b32 s36, 0x440000
    s_mov_b32 s37, 0x440000
    v_and_b32 v4, 31, v7
    v_lshrrev_b32 v5, 5, v7
    s_and_b32 s29, s8, 1
    s_mul_i32 s30, s29, 1536
    s_lshl_b32 s29, s29, 3
    s_add_u32 s29, s29, 1024
    v_lshl_add_u32 v2, v4, 4, s29
    v_lshl_add_u32 v1, v7, 4, s30
    v_lshlrev_b32 v3, 4, v7
    v_lshrrev_b32 v6, 3, v4
    v_and_b32 v160, 3, v4
    v_lshl_add_u32 v160, v6, 2, v160
    v_bfe_u32 v6, v4, 2, 1
    v_mad_u32_u24 v160, v6, 10, v160
    v_lshlrev_b32 v160, 6, v160
    v_lshl_add_u32 v160, v5, 4, v160
    s_lshr_b32 s26, s8, 1
    s_mul_i32 s26, s26, 163840
    s_lshl_b32 s27, s9, 1
    s_add_u32 s27, s27, s11
    s_mul_i32 s27, s27, 10240
    s_add_u32 s27, s27, s26
    s_mul_i32 s29, s12, 40960
    s_add_u32 s29, s29, s26
    s_add_u32 s18, s29, 3145728
    s_mul_i32 s29, s8, 81920
    s_mul_i32 s30, s12, 20480
    s_add_u32 s29, s29, s30
    s_add_u32 s19, s29, 6291456
    s_waitcnt lgkmcnt(0)
    s_mov_b32 s4, s24
    s_and_b32 s5, s25, 0xffff
    s_mov_b32 s6, 0x10000000
    s_mov_b32 s7, 0x00020000
    s_mov_b32 s13, s18
    s_mov_b32 s14, s19
    buffer_load_dwordx4 v[128:131], v1, s[4:7], s13 offen
    s_mov_b64 exec, s[32:33]
    buffer_load_dwordx2 v[132:133], v2, s[4:7], s13 offen
    s_mov_b64 exec, s[34:35]
    buffer_load_dwordx4 v[134:137], v160, s[4:7], s14 offen
    buffer_load_dwordx4 v[138:141], v160, s[4:7], s14 offen offset:32
    s_mov_b64 exec, -1
    s_add_u32 s13, s13, 2560
    s_add_u32 s14, s14, 1280
    s_add_u32 s28, s27, 2560
    s_add_u32 s29, s27, 5120
    s_add_u32 s30, s27, 7680
    buffer_load_dwordx4 v[8:11], v1, s[4:7], s27 offen
    buffer_load_dwordx4 v[14:17], v1, s[4:7], s28 offen
    buffer_load_dwordx4 v[20:23], v1, s[4:7], s29 offen
    buffer_load_dwordx4 v[26:29], v1, s[4:7], s30 offen
    s_mov_b64 exec, s[32:33]
    buffer_load_dwordx2 v[12:13], v2, s[4:7], s27 offen
    buffer_load_dwordx2 v[18:19], v2, s[4:7], s28 offen
    buffer_load_dwordx2 v[24:25], v2, s[4:7], s29 offen
    buffer_load_dwordx2 v[30:31], v2, s[4:7], s30 offen
    s_mov_b64 exec, s[20:21]
    v_mov_b32 v132, 0x3f803f80
    v_mov_b32 v133, 0x3f80
    v_mov_b32 v146, 0x3f803f80
    v_mov_b32 v147, 0x3f80
    v_mov_b32 v12, 0
    v_mov_b32 v13, 0
    v_mov_b32 v18, 0
    v_mov_b32 v19, 0
    v_mov_b32 v24, 0
    v_mov_b32 v25, 0
    v_mov_b32 v30, 0
    v_mov_b32 v31, 0
    s_mov_b32 s38, 0xff880000
    s_mov_b32 s39, 0xff880000
    s_mov_b64 exec, s[38:39]
    v_mov_b32 v134, 0
    v_mov_b32 v135, 0
    v_mov_b32 v136, 0
    v_mov_b32 v137, 0
    v_mov_b32 v138, 0
    v_mov_b32 v139, 0
    v_mov_b32 v140, 0
    v_mov_b32 v141, 0
    v_mov_b32 v148, 0
    v_mov_b32 v149, 0
    v_mov_b32 v150, 0
    v_mov_b32 v151, 0
    v_mov_b32 v152, 0
    v_mov_b32 v153, 0
    v_mov_b32 v154, 0
    v_mov_b32 v155, 0
    s_mov_b64 exec, s[36:37]
    v_mov_b32 v134, 0x3f803f80
    v_mov_b32 v135, 0x3f803f80
    v_mov_b32 v136, 0x3f803f80
    v_mov_b32 v137, 0x3f803f80
    v_mov_b32 v138, 0x3f803f80
    v_mov_b32 v139, 0x3f803f80
    v_mov_b32 v140, 0x3f803f80
    v_mov_b32 v141, 0x3f803f80
    v_mov_b32 v148, 0x3f803f80
    v_mov_b32 v149, 0x3f803f80
    v_mov_b32 v150, 0x3f803f80
    v_mov_b32 v151, 0x3f803f80
    v_mov_b32 v152, 0x3f803f80
    v_mov_b32 v153, 0x3f803f80
    v_mov_b32 v154, 0x3f803f80
    v_mov_b32 v155, 0x3f803f80
    s_mov_b64 exec, -1
    v_mov_b32 v156, 0xff800000
    v_mov_b32 v157, 0xff800000
    v_mov_b32 v158, 0xff800000
    v_mov_b32 v159, 0xff800000
    s_mov_b32 s16, 1
    s_mov_b32 s15, 0
    s_barrier
    s_waitcnt vmcnt(0)
    s_branch attn_kernel_maxbody
attn_kernel_maxpass:
    s_mov_b64 exec, s[20:21]
    v_mov_b32 v12, 0
    v_mov_b32 v13, 0
    v_mov_b32 v18, 0
    v_mov_b32 v19, 0
    v_mov_b32 v24, 0
    v_mov_b32 v25, 0
    v_mov_b32 v30, 0
    v_mov_b32 v31, 0
    s_mov_b64 exec, -1
    v_mov_b32 v156, 0xff800000
    v_mov_b32 v157, 0xff800000
    v_mov_b32 v158, 0xff800000
    v_mov_b32 v159, 0xff800000
    s_add_u32 s13, s18, 38400
    s_mov_b32 s15, 0
attn_kernel_maxloop:
    buffer_load_dwordx4 v[128:131], v1, s[4:7], s13 offen
    s_mov_b64 exec, s[32:33]
    buffer_load_dwordx2 v[132:133], v2, s[4:7], s13 offen
    s_mov_b64 exec, -1
    s_sub_u32 s13, s13, 2560
    s_waitcnt vmcnt(0)
attn_kernel_maxbody:
    v_mfma_f32_32x32x16_bf16 v[32:47], v[128:131], v[8:11], 0
    v_mfma_f32_32x32x8_bf16 v[32:47], v[132:133], v[12:13], v[32:47]
    v_mfma_f32_32x32x16_bf16 v[48:63], v[128:131], v[14:17], 0
    v_mfma_f32_32x32x8_bf16 v[48:63], v[132:133], v[18:19], v[48:63]
    v_mfma_f32_32x32x16_bf16 v[64:79], v[128:131], v[20:23], 0
    v_mfma_f32_32x32x8_bf16 v[64:79], v[132:133], v[24:25], v[64:79]
    v_mfma_f32_32x32x16_bf16 v[80:95], v[128:131], v[26:29], 0
    v_mfma_f32_32x32x8_bf16 v[80:95], v[132:133], v[30:31], v[80:95]
    s_nop 7
    v_max3_f32 v156, v32, v33, v156
    v_max3_f32 v156, v34, v35, v156
    v_max3_f32 v156, v36, v37, v156
    v_max3_f32 v156, v38, v39, v156
    v_max3_f32 v156, v40, v41, v156
    v_max3_f32 v156, v42, v43, v156
    v_max3_f32 v156, v44, v45, v156
    v_max3_f32 v156, v46, v47, v156
    v_max3_f32 v157, v48, v49, v157
    v_max3_f32 v157, v50, v51, v157
    v_max3_f32 v157, v52, v53, v157
    v_max3_f32 v157, v54, v55, v157
    v_max3_f32 v157, v56, v57, v157
    v_max3_f32 v157, v58, v59, v157
    v_max3_f32 v157, v60, v61, v157
    v_max3_f32 v157, v62, v63, v157
    v_max3_f32 v158, v64, v65, v158
    v_max3_f32 v158, v66, v67, v158
    v_max3_f32 v158, v68, v69, v158
    v_max3_f32 v158, v70, v71, v158
    v_max3_f32 v158, v72, v73, v158
    v_max3_f32 v158, v74, v75, v158
    v_max3_f32 v158, v76, v77, v158
    v_max3_f32 v158, v78, v79, v158
    s_nop 7
    v_max3_f32 v159, v80, v81, v159
    v_max3_f32 v159, v82, v83, v159
    v_max3_f32 v159, v84, v85, v159
    v_max3_f32 v159, v86, v87, v159
    v_max3_f32 v159, v88, v89, v159
    v_max3_f32 v159, v90, v91, v159
    v_max3_f32 v159, v92, v93, v159
    v_max3_f32 v159, v94, v95, v159
    s_add_u32 s15, s15, 1
    s_cmp_lt_u32 s15, s16
    s_cbranch_scc1 attn_kernel_maxloop
    s_cmp_eq_u32 s16, 1
    s_cbranch_scc1 attn_kernel_haveV
    s_mov_b32 s13, s18
    s_mov_b32 s14, s19
    buffer_load_dwordx4 v[128:131], v1, s[4:7], s13 offen
    s_mov_b64 exec, s[32:33]
    buffer_load_dwordx2 v[132:133], v2, s[4:7], s13 offen
    s_mov_b64 exec, s[34:35]
    buffer_load_dwordx4 v[134:137], v160, s[4:7], s14 offen
    buffer_load_dwordx4 v[138:141], v160, s[4:7], s14 offen offset:32
    s_mov_b64 exec, -1
    s_add_u32 s13, s13, 2560
    s_add_u32 s14, s14, 1280
attn_kernel_haveV:
    v_mov_b32 v96, v156
    v_mov_b32 v97, v157
    v_mov_b32 v98, v158
    v_mov_b32 v99, v159
    s_nop 1
    v_permlane32_swap_b32 v96, v156
    v_permlane32_swap_b32 v97, v157
    v_permlane32_swap_b32 v98, v158
    v_permlane32_swap_b32 v99, v159
    s_nop 1
    v_max_f32 v156, v156, v96
    v_max_f32 v157, v157, v97
    v_max_f32 v158, v158, v98
    v_max_f32 v159, v159, v99
    v_sub_f32 v100, 0, v156
    v_and_b32 v101, 0xffff0000, v100
    v_sub_f32 v100, v100, v101
    v_and_b32 v102, 0xffff0000, v100
    v_sub_f32 v100, v100, v102
    v_lshrrev_b32 v101, 16, v101
    v_or_b32 v101, v101, v102
    v_lshrrev_b32 v100, 16, v100
    v_sub_f32 v103, 0, v157
    v_and_b32 v104, 0xffff0000, v103
    v_sub_f32 v103, v103, v104
    v_and_b32 v105, 0xffff0000, v103
    v_sub_f32 v103, v103, v105
    v_lshrrev_b32 v104, 16, v104
    v_or_b32 v104, v104, v105
    v_lshrrev_b32 v103, 16, v103
    v_sub_f32 v106, 0, v158
    v_and_b32 v107, 0xffff0000, v106
    v_sub_f32 v106, v106, v107
    v_and_b32 v108, 0xffff0000, v106
    v_sub_f32 v106, v106, v108
    v_lshrrev_b32 v107, 16, v107
    v_or_b32 v107, v107, v108
    v_lshrrev_b32 v106, 16, v106
    v_sub_f32 v109, 0, v159
    v_and_b32 v110, 0xffff0000, v109
    v_sub_f32 v109, v109, v110
    v_and_b32 v111, 0xffff0000, v109
    v_sub_f32 v109, v109, v111
    v_lshrrev_b32 v110, 16, v110
    v_or_b32 v110, v110, v111
    v_lshrrev_b32 v109, 16, v109
    s_mov_b64 exec, s[20:21]
    v_mov_b32 v12, v101
    v_mov_b32 v13, v100
    v_mov_b32 v18, v104
    v_mov_b32 v19, v103
    v_mov_b32 v24, v107
    v_mov_b32 v25, v106
    v_mov_b32 v30, v110
    v_mov_b32 v31, v109
    s_mov_b64 exec, s[34:35]
    v_mov_b32 v152, 0
    v_mov_b32 v153, 0
    v_mov_b32 v154, 0
    v_mov_b32 v155, 0
    s_mov_b64 exec, -1
    s_waitcnt vmcnt(0)
    v_mfma_f32_32x32x16_bf16 v[96:111], v[128:131], v[8:11], 0
    v_mfma_f32_32x32x8_bf16 v[96:111], v[132:133], v[12:13], v[96:111]
    v_mov_b32 v32, 0
    v_mov_b32 v33, 0
    v_mov_b32 v34, 0
    v_mov_b32 v35, 0
    v_mov_b32 v36, 0
    v_mov_b32 v37, 0
    v_mov_b32 v38, 0
    v_mov_b32 v39, 0
    v_mov_b32 v40, 0
    v_mov_b32 v41, 0
    v_mov_b32 v42, 0
    v_mov_b32 v43, 0
    v_mov_b32 v44, 0
    v_mov_b32 v45, 0
    v_mov_b32 v46, 0
    v_mov_b32 v47, 0
    v_mov_b32 v48, 0
    v_mov_b32 v49, 0
    v_mov_b32 v50, 0
    v_mov_b32 v51, 0
    v_mov_b32 v52, 0
    v_mov_b32 v53, 0
    v_mov_b32 v54, 0
    v_mov_b32 v55, 0
    v_mov_b32 v56, 0
    v_mov_b32 v57, 0
    v_mov_b32 v58, 0
    v_mov_b32 v59, 0
    v_mov_b32 v60, 0
    v_mov_b32 v61, 0
    v_mov_b32 v62, 0
    v_mov_b32 v63, 0
    v_mov_b32 v64, 0
    v_mov_b32 v65, 0
    v_mov_b32 v66, 0
    v_mov_b32 v67, 0
    v_mov_b32 v68, 0
    v_mov_b32 v69, 0
    v_mov_b32 v70, 0
    v_mov_b32 v71, 0
    v_mov_b32 v72, 0
    v_mov_b32 v73, 0
    v_mov_b32 v74, 0
    v_mov_b32 v75, 0
    v_mov_b32 v76, 0
    v_mov_b32 v77, 0
    v_mov_b32 v78, 0
    v_mov_b32 v79, 0
    v_mov_b32 v80, 0
    v_mov_b32 v81, 0
    v_mov_b32 v82, 0
    v_mov_b32 v83, 0
    v_mov_b32 v84, 0
    v_mov_b32 v85, 0
    v_mov_b32 v86, 0
    v_mov_b32 v87, 0
    v_mov_b32 v88, 0
    v_mov_b32 v89, 0
    v_mov_b32 v90, 0
    v_mov_b32 v91, 0
    v_mov_b32 v92, 0
    v_mov_b32 v93, 0
    v_mov_b32 v94, 0
    v_mov_b32 v95, 0
    v_mov_b32 v120, 0
    v_mov_b32 v121, 0
    v_mov_b32 v122, 0
    v_mov_b32 v123, 0
    s_mov_b32 s15, 0
    s_setprio 2
attn_kernel_loop:
    s_cmp_lg_u32 s15, 5
    s_cbranch_scc1 attn_kernel_np5
    s_setprio 1
attn_kernel_np5:
    s_cmp_lg_u32 s15, 7
    s_cbranch_scc1 attn_kernel_np7
    s_setprio 0
attn_kernel_np7:
    v_exp_f32 v96, v96
    v_exp_f32 v97, v97
    v_mfma_f32_32x32x16_bf16 v[80:95], v[152:155], v[120:123], v[80:95]
    buffer_load_dwordx4 v[142:145], v1, s[4:7], s13 offen
    s_mov_b64 exec, s[32:33]
    buffer_load_dwordx2 v[146:147], v2, s[4:7], s13 offen
    s_mov_b64 exec, s[34:35]
    buffer_load_dwordx4 v[148:151], v160, s[4:7], s14 offen
    buffer_load_dwordx4 v[152:155], v160, s[4:7], s14 offen offset:32
    s_mov_b64 exec, -1
    s_add_u32 s13, s13, 2560
    s_add_u32 s14, s14, 1280
    v_exp_f32 v98, v98
    v_exp_f32 v99, v99
    v_exp_f32 v100, v100
    v_exp_f32 v101, v101
    v_mfma_f32_32x32x16_bf16 v[112:127], v[128:131], v[14:17], 0
    v_exp_f32 v102, v102
    v_exp_f32 v103, v103
    v_cvt_pk_bf16_f32 v96, v96, v97
    v_cvt_pk_bf16_f32 v97, v98, v99
    v_cvt_pk_bf16_f32 v98, v100, v101
    v_cvt_pk_bf16_f32 v99, v102, v103
    v_mfma_f32_32x32x8_bf16 v[112:127], v[132:133], v[18:19], v[112:127]
    v_exp_f32 v104, v104
    v_exp_f32 v105, v105
    v_exp_f32 v106, v106
    v_exp_f32 v107, v107
    v_mfma_f32_32x32x16_bf16 v[32:47], v[134:137], v[96:99], v[32:47]
    v_exp_f32 v108, v108
    v_exp_f32 v109, v109
    v_exp_f32 v110, v110
    v_exp_f32 v111, v111
    v_cvt_pk_bf16_f32 v104, v104, v105
    v_cvt_pk_bf16_f32 v105, v106, v107
    v_cvt_pk_bf16_f32 v106, v108, v109
    v_cvt_pk_bf16_f32 v107, v110, v111
    v_exp_f32 v112, v112
    v_exp_f32 v113, v113
    v_mfma_f32_32x32x16_bf16 v[32:47], v[138:141], v[104:107], v[32:47]
    v_exp_f32 v114, v114
    v_exp_f32 v115, v115
    v_exp_f32 v116, v116
    v_exp_f32 v117, v117
    v_mfma_f32_32x32x16_bf16 v[96:111], v[128:131], v[20:23], 0
    v_exp_f32 v118, v118
    v_exp_f32 v119, v119
    v_cvt_pk_bf16_f32 v112, v112, v113
    v_cvt_pk_bf16_f32 v113, v114, v115
    v_cvt_pk_bf16_f32 v114, v116, v117
    v_cvt_pk_bf16_f32 v115, v118, v119
    v_mfma_f32_32x32x8_bf16 v[96:111], v[132:133], v[24:25], v[96:111]
    v_exp_f32 v120, v120
    v_exp_f32 v121, v121
    v_exp_f32 v122, v122
    v_exp_f32 v123, v123
    v_mfma_f32_32x32x16_bf16 v[48:63], v[134:137], v[112:115], v[48:63]
    v_exp_f32 v124, v124
    v_exp_f32 v125, v125
    v_exp_f32 v126, v126
    v_exp_f32 v127, v127
    v_cvt_pk_bf16_f32 v120, v120, v121
    v_cvt_pk_bf16_f32 v121, v122, v123
    v_cvt_pk_bf16_f32 v122, v124, v125
    v_cvt_pk_bf16_f32 v123, v126, v127
    v_exp_f32 v96, v96
    v_exp_f32 v97, v97
    v_mfma_f32_32x32x16_bf16 v[48:63], v[138:141], v[120:123], v[48:63]
    v_exp_f32 v98, v98
    v_exp_f32 v99, v99
    v_exp_f32 v100, v100
    v_exp_f32 v101, v101
    v_mfma_f32_32x32x16_bf16 v[112:127], v[128:131], v[26:29], 0
    v_exp_f32 v102, v102
    v_exp_f32 v103, v103
    v_cvt_pk_bf16_f32 v96, v96, v97
    v_cvt_pk_bf16_f32 v97, v98, v99
    v_cvt_pk_bf16_f32 v98, v100, v101
    v_cvt_pk_bf16_f32 v99, v102, v103
    v_mfma_f32_32x32x8_bf16 v[112:127], v[132:133], v[30:31], v[112:127]
    v_exp_f32 v104, v104
    v_exp_f32 v105, v105
    v_exp_f32 v106, v106
    v_exp_f32 v107, v107
    v_mfma_f32_32x32x16_bf16 v[64:79], v[134:137], v[96:99], v[64:79]
    v_exp_f32 v108, v108
    v_exp_f32 v109, v109
    v_exp_f32 v110, v110
    v_exp_f32 v111, v111
    v_cvt_pk_bf16_f32 v104, v104, v105
    v_cvt_pk_bf16_f32 v105, v106, v107
    v_cvt_pk_bf16_f32 v106, v108, v109
    v_cvt_pk_bf16_f32 v107, v110, v111
    v_exp_f32 v112, v112
    v_exp_f32 v113, v113
    v_mfma_f32_32x32x16_bf16 v[64:79], v[138:141], v[104:107], v[64:79]
    v_exp_f32 v114, v114
    v_exp_f32 v115, v115
    v_exp_f32 v116, v116
    v_exp_f32 v117, v117
    s_waitcnt vmcnt(0)
    v_mfma_f32_32x32x16_bf16 v[96:111], v[142:145], v[8:11], 0
    v_exp_f32 v118, v118
    v_exp_f32 v119, v119
    v_cvt_pk_bf16_f32 v112, v112, v113
    v_cvt_pk_bf16_f32 v113, v114, v115
    v_cvt_pk_bf16_f32 v114, v116, v117
    v_cvt_pk_bf16_f32 v115, v118, v119
    v_mfma_f32_32x32x8_bf16 v[96:111], v[146:147], v[12:13], v[96:111]
    v_exp_f32 v120, v120
    v_exp_f32 v121, v121
    v_exp_f32 v122, v122
    v_exp_f32 v123, v123
    v_mfma_f32_32x32x16_bf16 v[80:95], v[134:137], v[112:115], v[80:95]
    v_exp_f32 v124, v124
    v_exp_f32 v125, v125
    v_exp_f32 v126, v126
    v_exp_f32 v127, v127
    v_cvt_pk_bf16_f32 v120, v120, v121
    v_cvt_pk_bf16_f32 v121, v122, v123
    v_cvt_pk_bf16_f32 v122, v124, v125
    v_cvt_pk_bf16_f32 v123, v126, v127
    v_exp_f32 v96, v96
    v_exp_f32 v97, v97
    v_mfma_f32_32x32x16_bf16 v[80:95], v[138:141], v[120:123], v[80:95]
    buffer_load_dwordx4 v[128:131], v1, s[4:7], s13 offen
    s_mov_b64 exec, s[32:33]
    buffer_load_dwordx2 v[132:133], v2, s[4:7], s13 offen
    s_mov_b64 exec, s[34:35]
    buffer_load_dwordx4 v[134:137], v160, s[4:7], s14 offen
    buffer_load_dwordx4 v[138:141], v160, s[4:7], s14 offen offset:32
    s_mov_b64 exec, -1
    s_add_u32 s13, s13, 2560
    s_add_u32 s14, s14, 1280
    v_exp_f32 v98, v98
    v_exp_f32 v99, v99
    v_exp_f32 v100, v100
    v_exp_f32 v101, v101
    v_mfma_f32_32x32x16_bf16 v[112:127], v[142:145], v[14:17], 0
    v_exp_f32 v102, v102
    v_exp_f32 v103, v103
    v_cvt_pk_bf16_f32 v96, v96, v97
    v_cvt_pk_bf16_f32 v97, v98, v99
    v_cvt_pk_bf16_f32 v98, v100, v101
    v_cvt_pk_bf16_f32 v99, v102, v103
    v_mfma_f32_32x32x8_bf16 v[112:127], v[146:147], v[18:19], v[112:127]
    v_exp_f32 v104, v104
    v_exp_f32 v105, v105
    v_exp_f32 v106, v106
    v_exp_f32 v107, v107
    v_mfma_f32_32x32x16_bf16 v[32:47], v[148:151], v[96:99], v[32:47]
    v_exp_f32 v108, v108
    v_exp_f32 v109, v109
    v_exp_f32 v110, v110
    v_exp_f32 v111, v111
    v_cvt_pk_bf16_f32 v104, v104, v105
    v_cvt_pk_bf16_f32 v105, v106, v107
    v_cvt_pk_bf16_f32 v106, v108, v109
    v_cvt_pk_bf16_f32 v107, v110, v111
    v_exp_f32 v112, v112
    v_exp_f32 v113, v113
    v_mfma_f32_32x32x16_bf16 v[32:47], v[152:155], v[104:107], v[32:47]
    v_exp_f32 v114, v114
    v_exp_f32 v115, v115
    v_exp_f32 v116, v116
    v_exp_f32 v117, v117
    v_mfma_f32_32x32x16_bf16 v[96:111], v[142:145], v[20:23], 0
    v_exp_f32 v118, v118
    v_exp_f32 v119, v119
    v_cvt_pk_bf16_f32 v112, v112, v113
    v_cvt_pk_bf16_f32 v113, v114, v115
    v_cvt_pk_bf16_f32 v114, v116, v117
    v_cvt_pk_bf16_f32 v115, v118, v119
    v_mfma_f32_32x32x8_bf16 v[96:111], v[146:147], v[24:25], v[96:111]
    v_exp_f32 v120, v120
    v_exp_f32 v121, v121
    v_exp_f32 v122, v122
    v_exp_f32 v123, v123
    v_mfma_f32_32x32x16_bf16 v[48:63], v[148:151], v[112:115], v[48:63]
    v_exp_f32 v124, v124
    v_exp_f32 v125, v125
    v_exp_f32 v126, v126
    v_exp_f32 v127, v127
    v_cvt_pk_bf16_f32 v120, v120, v121
    v_cvt_pk_bf16_f32 v121, v122, v123
    v_cvt_pk_bf16_f32 v122, v124, v125
    v_cvt_pk_bf16_f32 v123, v126, v127
    v_exp_f32 v96, v96
    v_exp_f32 v97, v97
    v_mfma_f32_32x32x16_bf16 v[48:63], v[152:155], v[120:123], v[48:63]
    v_exp_f32 v98, v98
    v_exp_f32 v99, v99
    v_exp_f32 v100, v100
    v_exp_f32 v101, v101
    v_mfma_f32_32x32x16_bf16 v[112:127], v[142:145], v[26:29], 0
    v_exp_f32 v102, v102
    v_exp_f32 v103, v103
    v_cvt_pk_bf16_f32 v96, v96, v97
    v_cvt_pk_bf16_f32 v97, v98, v99
    v_cvt_pk_bf16_f32 v98, v100, v101
    v_cvt_pk_bf16_f32 v99, v102, v103
    v_mfma_f32_32x32x8_bf16 v[112:127], v[146:147], v[30:31], v[112:127]
    v_exp_f32 v104, v104
    v_exp_f32 v105, v105
    v_exp_f32 v106, v106
    v_exp_f32 v107, v107
    v_mfma_f32_32x32x16_bf16 v[64:79], v[148:151], v[96:99], v[64:79]
    v_exp_f32 v108, v108
    v_exp_f32 v109, v109
    v_exp_f32 v110, v110
    v_exp_f32 v111, v111
    v_cvt_pk_bf16_f32 v104, v104, v105
    v_cvt_pk_bf16_f32 v105, v106, v107
    v_cvt_pk_bf16_f32 v106, v108, v109
    v_cvt_pk_bf16_f32 v107, v110, v111
    v_exp_f32 v112, v112
    v_exp_f32 v113, v113
    v_mfma_f32_32x32x16_bf16 v[64:79], v[152:155], v[104:107], v[64:79]
    v_exp_f32 v114, v114
    v_exp_f32 v115, v115
    v_exp_f32 v116, v116
    v_exp_f32 v117, v117
    s_waitcnt vmcnt(0)
    v_mfma_f32_32x32x16_bf16 v[96:111], v[128:131], v[8:11], 0
    v_exp_f32 v118, v118
    v_exp_f32 v119, v119
    v_cvt_pk_bf16_f32 v112, v112, v113
    v_cvt_pk_bf16_f32 v113, v114, v115
    v_cvt_pk_bf16_f32 v114, v116, v117
    v_cvt_pk_bf16_f32 v115, v118, v119
    v_mfma_f32_32x32x8_bf16 v[96:111], v[132:133], v[12:13], v[96:111]
    v_exp_f32 v120, v120
    v_exp_f32 v121, v121
    v_exp_f32 v122, v122
    v_exp_f32 v123, v123
    v_mfma_f32_32x32x16_bf16 v[80:95], v[148:151], v[112:115], v[80:95]
    v_exp_f32 v124, v124
    v_exp_f32 v125, v125
    v_exp_f32 v126, v126
    v_exp_f32 v127, v127
    v_cvt_pk_bf16_f32 v120, v120, v121
    v_cvt_pk_bf16_f32 v121, v122, v123
    v_cvt_pk_bf16_f32 v122, v124, v125
    v_cvt_pk_bf16_f32 v123, v126, v127
    s_add_u32 s15, s15, 1
    s_cmp_lt_u32 s15, 8
    s_cbranch_scc1 attn_kernel_loop
    s_nop 1
    v_mfma_f32_32x32x16_bf16 v[80:95], v[152:155], v[120:123], v[80:95]
    s_waitcnt vmcnt(0)
    s_mov_b32 s26, 0x5d800000
    s_nop 13
    v_cmp_nlt_f32 s[28:29], v42, s26
    v_cmp_nlt_f32 s[30:31], v58, s26
    s_or_b64 s[28:29], s[28:29], s[30:31]
    v_cmp_nlt_f32 s[30:31], v74, s26
    s_or_b64 s[28:29], s[28:29], s[30:31]
    v_cmp_nlt_f32 s[30:31], v90, s26
    s_or_b64 s[28:29], s[28:29], s[30:31]
    s_cmp_eq_u64 s[28:29], 0
    s_cbranch_scc1 attn_kernel_combine
    s_cmp_eq_u32 s16, 16
    s_cbranch_scc1 attn_kernel_combine
    s_mov_b32 s16, 16
    s_branch attn_kernel_maxpass
attn_kernel_combine:
    v_mov_b32 v43, v156
    v_mov_b32 v59, v157
    v_mov_b32 v75, v158
    v_mov_b32 v91, v159
    s_cmp_eq_u32 s12, 0
    s_cbranch_scc1 attn_kernel_own0
    s_sub_u32 s26, s12, 1
    s_and_b32 s26, s26, 3
    s_mul_i32 s26, s26, 3072
    s_mul_i32 s27, s11, 36864
    s_add_u32 s26, s26, s27
    s_add_u32 s26, s26, 84608
    v_add_u32 v4, s26, v3
    ds_write_b128 v4, v[32:35] offset:0
    ds_write_b128 v4, v[36:39] offset:1024
    ds_write_b128 v4, v[40:43] offset:2048
    s_branch attn_kernel_nx0
attn_kernel_own0:
    v_mov_b32 v112, v32
    v_mov_b32 v113, v33
    v_mov_b32 v114, v34
    v_mov_b32 v115, v35
    v_mov_b32 v116, v36
    v_mov_b32 v117, v37
    v_mov_b32 v118, v38
    v_mov_b32 v119, v39
    v_mov_b32 v120, v40
    v_mov_b32 v121, v41
    v_mov_b32 v122, v42
    v_mov_b32 v123, v43
attn_kernel_nx0:
    s_cmp_eq_u32 s12, 1
    s_cbranch_scc1 attn_kernel_own1
    s_sub_u32 s26, s12, 2
    s_and_b32 s26, s26, 3
    s_mul_i32 s26, s26, 3072
    s_mul_i32 s27, s11, 36864
    s_add_u32 s26, s26, s27
    s_add_u32 s26, s26, 93824
    v_add_u32 v4, s26, v3
    ds_write_b128 v4, v[48:51] offset:0
    ds_write_b128 v4, v[52:55] offset:1024
    ds_write_b128 v4, v[56:59] offset:2048
    s_branch attn_kernel_nx1
attn_kernel_own1:
    v_mov_b32 v112, v48
    v_mov_b32 v113, v49
    v_mov_b32 v114, v50
    v_mov_b32 v115, v51
    v_mov_b32 v116, v52
    v_mov_b32 v117, v53
    v_mov_b32 v118, v54
    v_mov_b32 v119, v55
    v_mov_b32 v120, v56
    v_mov_b32 v121, v57
    v_mov_b32 v122, v58
    v_mov_b32 v123, v59
attn_kernel_nx1:
    s_cmp_eq_u32 s12, 2
    s_cbranch_scc1 attn_kernel_own2
    s_sub_u32 s26, s12, 3
    s_and_b32 s26, s26, 3
    s_mul_i32 s26, s26, 3072
    s_mul_i32 s27, s11, 36864
    s_add_u32 s26, s26, s27
    s_add_u32 s26, s26, 103040
    v_add_u32 v4, s26, v3
    ds_write_b128 v4, v[64:67] offset:0
    ds_write_b128 v4, v[68:71] offset:1024
    ds_write_b128 v4, v[72:75] offset:2048
    s_branch attn_kernel_nx2
attn_kernel_own2:
    v_mov_b32 v112, v64
    v_mov_b32 v113, v65
    v_mov_b32 v114, v66
    v_mov_b32 v115, v67
    v_mov_b32 v116, v68
    v_mov_b32 v117, v69
    v_mov_b32 v118, v70
    v_mov_b32 v119, v71
    v_mov_b32 v120, v72
    v_mov_b32 v121, v73
    v_mov_b32 v122, v74
    v_mov_b32 v123, v75
attn_kernel_nx2:
    s_cmp_eq_u32 s12, 3
    s_cbranch_scc1 attn_kernel_own3
    s_sub_u32 s26, s12, 4
    s_and_b32 s26, s26, 3
    s_mul_i32 s26, s26, 3072
    s_mul_i32 s27, s11, 36864
    s_add_u32 s26, s26, s27
    s_add_u32 s26, s26, 112256
    v_add_u32 v4, s26, v3
    ds_write_b128 v4, v[80:83] offset:0
    ds_write_b128 v4, v[84:87] offset:1024
    ds_write_b128 v4, v[88:91] offset:2048
    s_branch attn_kernel_nx3
attn_kernel_own3:
    v_mov_b32 v112, v80
    v_mov_b32 v113, v81
    v_mov_b32 v114, v82
    v_mov_b32 v115, v83
    v_mov_b32 v116, v84
    v_mov_b32 v117, v85
    v_mov_b32 v118, v86
    v_mov_b32 v119, v87
    v_mov_b32 v120, v88
    v_mov_b32 v121, v89
    v_mov_b32 v122, v90
    v_mov_b32 v123, v91
attn_kernel_nx3:
    s_lshl_b32 s26, s11, 2
    s_add_u32 s26, s26, 84480
    v_mov_b32 v108, s26
    v_mov_b32 v109, 1
    s_mul_i32 s26, s11, 36864
    s_mul_i32 s27, s12, 9216
    s_add_u32 s26, s26, s27
    s_add_u32 s26, s26, 84608
    v_add_u32 v4, s26, v3
    s_waitcnt lgkmcnt(0)
    s_mov_b64 exec, 1
    ds_add_u32 v108, v109 offset:16
    s_mov_b64 exec, -1
attn_kernel_cw_spin:
    ds_read_b32 v5, v108 offset:16
    s_waitcnt lgkmcnt(0)
    v_readfirstlane_b32 s26, v5
    s_cmp_ge_u32 s26, 4
    s_cbranch_scc1 attn_kernel_cw_go
    s_sleep 1
    s_branch attn_kernel_cw_spin
attn_kernel_cw_go:
    ds_read_b128 v[48:51], v4 offset:0
    ds_read_b128 v[52:55], v4 offset:1024
    ds_read_b128 v[56:59], v4 offset:2048
    ds_read_b128 v[64:67], v4 offset:3072
    ds_read_b128 v[68:71], v4 offset:4096
    ds_read_b128 v[72:75], v4 offset:5120
    ds_read_b128 v[80:83], v4 offset:6144
    ds_read_b128 v[84:87], v4 offset:7168
    ds_read_b128 v[88:91], v4 offset:8192
    s_lshl_b32 s26, s9, 3
    s_lshl_b32 s27, s11, 2
    s_add_u32 s26, s26, s27
    s_add_u32 s26, s26, s12
    s_mul_i32 s26, s26, 40960
    s_add_u32 s26, s26, 16777216
    s_lshr_b32 s27, s8, 1
    s_lshl_b32 s27, s27, 9
    s_and_b32 s28, s8, 1
    s_lshl_b32 s28, s28, 3
    s_add_u32 s27, s27, s28
    s_add_u32 s27, s27, s26
    s_add_u32 s27, s27, 32768
    s_lshl_b32 s28, s8, 10
    s_add_u32 s26, s26, s28
    v_mov_b32 v108, 84480
    s_waitcnt lgkmcnt(0)
    s_mov_b64 exec, 1
    ds_add_u32 v108, v109 offset:8
    s_mov_b64 exec, -1
    v_max_f32 v5, v123, v59
    v_max3_f32 v5, v75, v91, v5
    v_sub_f32 v123, v123, v5
    v_sub_f32 v59, v59, v5
    v_sub_f32 v75, v75, v5
    v_sub_f32 v91, v91, v5
    v_exp_f32 v123, v123
    v_exp_f32 v59, v59
    v_exp_f32 v75, v75
    v_exp_f32 v91, v91
    s_nop 0
    v_mul_f32 v112, v112, v123
    v_mul_f32 v113, v113, v123
    v_mul_f32 v114, v114, v123
    v_mul_f32 v115, v115, v123
    v_mul_f32 v116, v116, v123
    v_mul_f32 v117, v117, v123
    v_mul_f32 v118, v118, v123
    v_mul_f32 v119, v119, v123
    v_mul_f32 v120, v120, v123
    v_mul_f32 v121, v121, v123
    v_mul_f32 v122, v122, v123
    v_fma_f32 v112, v48, v59, v112
    v_fma_f32 v113, v49, v59, v113
    v_fma_f32 v114, v50, v59, v114
    v_fma_f32 v115, v51, v59, v115
    v_fma_f32 v116, v52, v59, v116
    v_fma_f32 v117, v53, v59, v117
    v_fma_f32 v118, v54, v59, v118
    v_fma_f32 v119, v55, v59, v119
    v_fma_f32 v120, v56, v59, v120
    v_fma_f32 v121, v57, v59, v121
    v_fma_f32 v122, v58, v59, v122
    v_fma_f32 v112, v64, v75, v112
    v_fma_f32 v113, v65, v75, v113
    v_fma_f32 v114, v66, v75, v114
    v_fma_f32 v115, v67, v75, v115
    v_fma_f32 v116, v68, v75, v116
    v_fma_f32 v117, v69, v75, v117
    v_fma_f32 v118, v70, v75, v118
    v_fma_f32 v119, v71, v75, v119
    v_fma_f32 v120, v72, v75, v120
    v_fma_f32 v121, v73, v75, v121
    v_fma_f32 v122, v74, v75, v122
    v_fma_f32 v112, v80, v91, v112
    v_fma_f32 v113, v81, v91, v113
    v_fma_f32 v114, v82, v91, v114
    v_fma_f32 v115, v83, v91, v115
    v_fma_f32 v116, v84, v91, v116
    v_fma_f32 v117, v85, v91, v117
    v_fma_f32 v118, v86, v91, v118
    v_fma_f32 v119, v87, v91, v119
    v_fma_f32 v120, v88, v91, v120
    v_fma_f32 v121, v89, v91, v121
    v_fma_f32 v122, v90, v91, v122
    v_rcp_f32 v5, v122
    s_nop 0
    v_mul_f32 v112, v112, v5
    v_mul_f32 v113, v113, v5
    v_mul_f32 v114, v114, v5
    v_mul_f32 v115, v115, v5
    v_mul_f32 v116, v116, v5
    v_mul_f32 v117, v117, v5
    v_mul_f32 v118, v118, v5
    v_mul_f32 v119, v119, v5
    v_mul_f32 v120, v120, v5
    v_mul_f32 v121, v121, v5
    v_cvt_pk_bf16_f32 v48, v112, v113
    v_cvt_pk_bf16_f32 v49, v114, v115
    v_cvt_pk_bf16_f32 v50, v116, v117
    v_cvt_pk_bf16_f32 v51, v118, v119
    v_cvt_pk_bf16_f32 v52, v120, v121
    v_mov_b32 v53, v52
    buffer_store_dwordx4 v[48:51], v3, s[4:7], s26 offen sc0 sc1
    s_nop 0
    v_permlane32_swap_b32 v53, v52
    v_mov_b32 v54, v53
    v_mov_b32 v55, v52
    s_mov_b64 exec, s[32:33]
    buffer_store_dwordx2 v[54:55], v3, s[4:7], s27 offen sc0 sc1
    s_mov_b64 exec, -1
attn_kernel_end:
    s_endpgm
attn_kernel_ffn2:
    s_waitcnt lgkmcnt(0)
    s_load_dwordx2 s[42:43], s[0:1], 56
    s_load_dwordx2 s[46:47], s[0:1], 80
    s_load_dwordx2 s[36:37], s[0:1], 0
    s_load_dwordx2 s[44:45], s[0:1], 64
    v_and_b32 v1, 63, v0
    s_and_b32 s48, s2, 7
    s_sub_u32 s28, s10, 8
    s_lshr_b32 s49, s2, 3
    s_and_b32 s30, s48, 3
    s_lshr_b32 s48, s48, 2
    s_lshl_b32 s48, s48, 5
    s_add_u32 s29, s48, s49
    s_mul_i32 s31, s28, 21120
    s_mul_i32 s34, s28, 15360
    s_add_u32 s34, s34, 84608
    v_mov_b32 v6, 84480
    v_lshl_add_u32 v2, v1, 2, v6
    v_mov_b32 v3, 0
    s_mov_b64 exec, 0xff
    ds_write_b32 v2, v3
    s_mov_b64 exec, -1
    v_mov_b32 v7, 1
    s_waitcnt lgkmcnt(0)
    s_barrier
    s_mov_b32 s16, s46
    s_and_b32 s17, s47, 0xffff
    s_mov_b32 s18, 0x10000000
    s_mov_b32 s19, 0x00020000
    v_lshlrev_b32 v8, 4, v1
    v_add_u32 v9, 4096, v8
    s_mul_i32 s32, s29, 98304
    s_mul_i32 s48, s28, 24576
    s_add_u32 s32, s32, s48
    s_add_u32 s32, s32, 10485760
    s_mul_i32 s33, s30, 491520
    s_mul_i32 s48, s28, 122880
    s_add_u32 s33, s33, s48
    s_add_u32 s33, s33, 27262976
    buffer_load_dwordx4 v[104:107], v8, s[16:19], s32 offen
    s_add_u32 s32, s32, 1024
    buffer_load_dwordx4 v[108:111], v8, s[16:19], s33 offen offset:0
    buffer_load_dwordx4 v[112:115], v8, s[16:19], s33 offen offset:1024
    buffer_load_dwordx4 v[116:119], v8, s[16:19], s33 offen offset:2048
    buffer_load_dwordx4 v[120:123], v8, s[16:19], s33 offen offset:3072
    buffer_load_dwordx4 v[124:127], v9, s[16:19], s33 offen
    s_add_u32 s33, s33, 5120
    buffer_load_dwordx4 v[128:131], v8, s[16:19], s32 offen
    s_add_u32 s32, s32, 1024
    buffer_load_dwordx4 v[132:135], v8, s[16:19], s33 offen offset:0
    buffer_load_dwordx4 v[136:139], v8, s[16:19], s33 offen offset:1024
    buffer_load_dwordx4 v[140:143], v8, s[16:19], s33 offen offset:2048
    buffer_load_dwordx4 v[144:147], v8, s[16:19], s33 offen offset:3072
    buffer_load_dwordx4 v[148:151], v9, s[16:19], s33 offen
    s_add_u32 s33, s33, 5120
    s_lshl_b32 s48, s28, 3
    v_lshrrev_b32 v2, 3, v1
    v_add_u32 v2, s48, v2
    v_and_b32 v3, 7, v1
    v_mul_u32_u24 v10, 1280, v2
    v_mad_u32_u24 v10, v3, 40, v10
    v_mul_u32_u24 v11, 656, v2
    v_mad_u32_u24 v11, v3, 64, v11
    v_mad_u32_u24 v11, v3, 16, v11
    v_add_u32 v12, s31, v8
    v_add_u32 v13, s34, v8
    s_mov_b32 s24, s42
    s_and_b32 s25, s43, 0xffff
    s_mov_b32 s26, 0x500
    s_mov_b32 s27, 0x00020000
    s_mov_b32 s56, s36
    s_and_b32 s57, s37, 0xffff
    s_mov_b32 s58, 0x280000
    s_mov_b32 s59, 0x00020000
    s_mov_b32 s60, s44
    s_and_b32 s61, s45, 0xffff
    s_mov_b32 s62, 0x280000
    s_mov_b32 s63, 0x00020000
    s_mul_i32 s50, s30, 320
    s_mul_i32 s51, s29, 40960
    s_add_u32 s51, s51, s50
    v_mul_u32_u24 v5, 40, v3
    s_waitcnt vmcnt(6)
    s_setprio 3
    v_mfma_f32_32x32x16_bf16 v[24:39], v[108:111], v[104:107], 0
    v_mfma_f32_32x32x16_bf16 v[40:55], v[112:115], v[104:107], 0
    v_mfma_f32_32x32x16_bf16 v[56:71], v[116:119], v[104:107], 0
    v_mfma_f32_32x32x16_bf16 v[72:87], v[120:123], v[104:107], 0
    v_mfma_f32_32x32x16_bf16 v[88:103], v[124:127], v[104:107], 0
    s_setprio 0
    buffer_load_dwordx4 v[104:107], v8, s[16:19], s32 offen
    s_add_u32 s32, s32, 1024
    buffer_load_dwordx4 v[108:111], v8, s[16:19], s33 offen offset:0
    buffer_load_dwordx4 v[112:115], v8, s[16:19], s33 offen offset:1024
    buffer_load_dwordx4 v[116:119], v8, s[16:19], s33 offen offset:2048
    buffer_load_dwordx4 v[120:123], v8, s[16:19], s33 offen offset:3072
    buffer_load_dwordx4 v[124:127], v9, s[16:19], s33 offen
    s_add_u32 s33, s33, 5120
    s_waitcnt vmcnt(6)
    s_setprio 3
    v_mfma_f32_32x32x16_bf16 v[24:39], v[132:135], v[128:131], v[24:39]
    v_mfma_f32_32x32x16_bf16 v[40:55], v[136:139], v[128:131], v[40:55]
    v_mfma_f32_32x32x16_bf16 v[56:71], v[140:143], v[128:131], v[56:71]
    v_mfma_f32_32x32x16_bf16 v[72:87], v[144:147], v[128:131], v[72:87]
    v_mfma_f32_32x32x16_bf16 v[88:103], v[148:151], v[128:131], v[88:103]
    s_setprio 0
    buffer_load_dwordx4 v[128:131], v8, s[16:19], s32 offen
    s_add_u32 s32, s32, 1024
    buffer_load_dwordx4 v[132:135], v8, s[16:19], s33 offen offset:0
    buffer_load_dwordx4 v[136:139], v8, s[16:19], s33 offen offset:1024
    buffer_load_dwordx4 v[140:143], v8, s[16:19], s33 offen offset:2048
    buffer_load_dwordx4 v[144:147], v8, s[16:19], s33 offen offset:3072
    buffer_load_dwordx4 v[148:151], v9, s[16:19], s33 offen
    s_add_u32 s33, s33, 5120
    s_mov_b32 s49, 0
attn_kernel_g2loop:
    s_waitcnt vmcnt(6)
    s_setprio 3
    v_mfma_f32_32x32x16_bf16 v[24:39], v[108:111], v[104:107], v[24:39]
    v_mfma_f32_32x32x16_bf16 v[40:55], v[112:115], v[104:107], v[40:55]
    v_mfma_f32_32x32x16_bf16 v[56:71], v[116:119], v[104:107], v[56:71]
    v_mfma_f32_32x32x16_bf16 v[72:87], v[120:123], v[104:107], v[72:87]
    v_mfma_f32_32x32x16_bf16 v[88:103], v[124:127], v[104:107], v[88:103]
    s_setprio 0
    buffer_load_dwordx4 v[104:107], v8, s[16:19], s32 offen
    s_add_u32 s32, s32, 1024
    buffer_load_dwordx4 v[108:111], v8, s[16:19], s33 offen offset:0
    buffer_load_dwordx4 v[112:115], v8, s[16:19], s33 offen offset:1024
    buffer_load_dwordx4 v[116:119], v8, s[16:19], s33 offen offset:2048
    buffer_load_dwordx4 v[120:123], v8, s[16:19], s33 offen offset:3072
    buffer_load_dwordx4 v[124:127], v9, s[16:19], s33 offen
    s_add_u32 s33, s33, 5120
    s_waitcnt vmcnt(6)
    s_setprio 3
    v_mfma_f32_32x32x16_bf16 v[24:39], v[132:135], v[128:131], v[24:39]
    v_mfma_f32_32x32x16_bf16 v[40:55], v[136:139], v[128:131], v[40:55]
    v_mfma_f32_32x32x16_bf16 v[56:71], v[140:143], v[128:131], v[56:71]
    v_mfma_f32_32x32x16_bf16 v[72:87], v[144:147], v[128:131], v[72:87]
    v_mfma_f32_32x32x16_bf16 v[88:103], v[148:151], v[128:131], v[88:103]
    s_setprio 0
    buffer_load_dwordx4 v[128:131], v8, s[16:19], s32 offen
    s_add_u32 s32, s32, 1024
    buffer_load_dwordx4 v[132:135], v8, s[16:19], s33 offen offset:0
    buffer_load_dwordx4 v[136:139], v8, s[16:19], s33 offen offset:1024
    buffer_load_dwordx4 v[140:143], v8, s[16:19], s33 offen offset:2048
    buffer_load_dwordx4 v[144:147], v8, s[16:19], s33 offen offset:3072
    buffer_load_dwordx4 v[148:151], v9, s[16:19], s33 offen
    s_add_u32 s33, s33, 5120
    s_add_u32 s49, s49, 1
    s_cmp_lt_u32 s49, 10
    s_cbranch_scc1 attn_kernel_g2loop
    s_waitcnt vmcnt(6)
    s_setprio 3
    v_mfma_f32_32x32x16_bf16 v[24:39], v[108:111], v[104:107], v[24:39]
    v_mfma_f32_32x32x16_bf16 v[40:55], v[112:115], v[104:107], v[40:55]
    v_mfma_f32_32x32x16_bf16 v[56:71], v[116:119], v[104:107], v[56:71]
    v_mfma_f32_32x32x16_bf16 v[72:87], v[120:123], v[104:107], v[72:87]
    v_mfma_f32_32x32x16_bf16 v[88:103], v[124:127], v[104:107], v[88:103]
    s_setprio 0
    buffer_load_dwordx4 v[14:17], v5, s[24:27], s50 offen
    buffer_load_dwordx4 v[18:21], v5, s[24:27], s50 offen offset:16
    buffer_load_dwordx2 v[22:23], v5, s[24:27], s50 offen offset:32
    s_waitcnt vmcnt(3)
    s_setprio 3
    v_mfma_f32_32x32x16_bf16 v[24:39], v[132:135], v[128:131], v[24:39]
    v_mfma_f32_32x32x16_bf16 v[40:55], v[136:139], v[128:131], v[40:55]
    v_mfma_f32_32x32x16_bf16 v[56:71], v[140:143], v[128:131], v[56:71]
    v_mfma_f32_32x32x16_bf16 v[72:87], v[144:147], v[128:131], v[72:87]
    v_mfma_f32_32x32x16_bf16 v[88:103], v[148:151], v[128:131], v[88:103]
    s_setprio 0
    s_setprio 3
    v_and_b32 v2, 31, v1
    v_lshrrev_b32 v3, 5, v1
    v_mul_u32_u24 v2, 656, v2
    v_lshl_add_u32 v2, v3, 4, v2
    v_add_u32 v2, s31, v2
    s_nop 10
    ds_write_b128 v2, v[24:27] offset:0
    ds_write_b128 v2, v[28:31] offset:32
    ds_write_b128 v2, v[32:35] offset:64
    ds_write_b128 v2, v[36:39] offset:96
    ds_write_b128 v2, v[40:43] offset:128
    ds_write_b128 v2, v[44:47] offset:160
    ds_write_b128 v2, v[48:51] offset:192
    ds_write_b128 v2, v[52:55] offset:224
    ds_write_b128 v2, v[56:59] offset:256
    ds_write_b128 v2, v[60:63] offset:288
    ds_write_b128 v2, v[64:67] offset:320
    ds_write_b128 v2, v[68:71] offset:352
    ds_write_b128 v2, v[72:75] offset:384
    ds_write_b128 v2, v[76:79] offset:416
    ds_write_b128 v2, v[80:83] offset:448
    ds_write_b128 v2, v[84:87] offset:480
    ds_write_b128 v2, v[88:91] offset:512
    ds_write_b128 v2, v[92:95] offset:544
    ds_write_b128 v2, v[96:99] offset:576
    ds_write_b128 v2, v[100:103] offset:608
    s_waitcnt lgkmcnt(0)
    s_mov_b64 exec, 1
    ds_add_u32 v6, v7 offset:0
    s_mov_b64 exec, -1
attn_kernel_gA_spin:
    ds_read_b32 v2, v6 offset:0
    s_waitcnt lgkmcnt(0)
    v_readfirstlane_b32 s48, v2
    s_cmp_ge_u32 s48, 4
    s_cbranch_scc1 attn_kernel_gA_go
    s_sleep 1
    s_branch attn_kernel_gA_spin
attn_kernel_gA_go:
    ds_read_b128 v[24:27], v11 offset:0
    ds_read_b128 v[28:31], v11 offset:16
    ds_read_b128 v[32:35], v11 offset:32
    ds_read_b128 v[36:39], v11 offset:48
    ds_read_b128 v[40:43], v11 offset:64
    ds_read_b128 v[44:47], v11 offset:21120
    ds_read_b128 v[48:51], v11 offset:21136
    ds_read_b128 v[52:55], v11 offset:21152
    ds_read_b128 v[56:59], v11 offset:21168
    ds_read_b128 v[60:63], v11 offset:21184
    ds_read_b128 v[64:67], v11 offset:42240
    ds_read_b128 v[68:71], v11 offset:42256
    ds_read_b128 v[72:75], v11 offset:42272
    ds_read_b128 v[76:79], v11 offset:42288
    ds_read_b128 v[80:83], v11 offset:42304
    ds_read_b128 v[84:87], v11 offset:63360
    ds_read_b128 v[88:91], v11 offset:63376
    ds_read_b128 v[92:95], v11 offset:63392
    ds_read_b128 v[96:99], v11 offset:63408
    ds_read_b128 v[100:103], v11 offset:63424
    s_waitcnt lgkmcnt(0)
    v_pk_add_f32 v[24:25], v[24:25], v[44:45]
    v_pk_add_f32 v[64:65], v[64:65], v[84:85]
    v_pk_add_f32 v[26:27], v[26:27], v[46:47]
    v_pk_add_f32 v[66:67], v[66:67], v[86:87]
    v_pk_add_f32 v[28:29], v[28:29], v[48:49]
    v_pk_add_f32 v[68:69], v[68:69], v[88:89]
    v_pk_add_f32 v[30:31], v[30:31], v[50:51]
    v_pk_add_f32 v[70:71], v[70:71], v[90:91]
    v_pk_add_f32 v[32:33], v[32:33], v[52:53]
    v_pk_add_f32 v[72:73], v[72:73], v[92:93]
    v_pk_add_f32 v[34:35], v[34:35], v[54:55]
    v_pk_add_f32 v[74:75], v[74:75], v[94:95]
    v_pk_add_f32 v[36:37], v[36:37], v[56:57]
    v_pk_add_f32 v[76:77], v[76:77], v[96:97]
    v_pk_add_f32 v[38:39], v[38:39], v[58:59]
    v_pk_add_f32 v[78:79], v[78:79], v[98:99]
    v_pk_add_f32 v[40:41], v[40:41], v[60:61]
    v_pk_add_f32 v[80:81], v[80:81], v[100:101]
    v_pk_add_f32 v[42:43], v[42:43], v[62:63]
    v_pk_add_f32 v[82:83], v[82:83], v[102:103]
    v_pk_add_f32 v[24:25], v[24:25], v[64:65]
    v_pk_add_f32 v[26:27], v[26:27], v[66:67]
    v_pk_add_f32 v[28:29], v[28:29], v[68:69]
    v_pk_add_f32 v[30:31], v[30:31], v[70:71]
    v_pk_add_f32 v[32:33], v[32:33], v[72:73]
    v_pk_add_f32 v[34:35], v[34:35], v[74:75]
    v_pk_add_f32 v[36:37], v[36:37], v[76:77]
    v_pk_add_f32 v[38:39], v[38:39], v[78:79]
    v_pk_add_f32 v[40:41], v[40:41], v[80:81]
    v_pk_add_f32 v[42:43], v[42:43], v[82:83]
    s_mov_b64 exec, 1
    ds_add_u32 v6, v7 offset:4
    s_mov_b64 exec, -1
    s_waitcnt vmcnt(0)
    v_lshlrev_b32 v44, 16, v14
    v_and_b32 v45, 0xffff0000, v14
    v_lshlrev_b32 v46, 16, v15
    v_and_b32 v47, 0xffff0000, v15
    v_lshlrev_b32 v48, 16, v16
    v_and_b32 v49, 0xffff0000, v16
    v_lshlrev_b32 v50, 16, v17
    v_and_b32 v51, 0xffff0000, v17
    v_lshlrev_b32 v52, 16, v18
    v_and_b32 v53, 0xffff0000, v18
    v_lshlrev_b32 v54, 16, v19
    v_and_b32 v55, 0xffff0000, v19
    v_lshlrev_b32 v56, 16, v20
    v_and_b32 v57, 0xffff0000, v20
    v_lshlrev_b32 v58, 16, v21
    v_and_b32 v59, 0xffff0000, v21
    v_lshlrev_b32 v60, 16, v22
    v_and_b32 v61, 0xffff0000, v22
    v_lshlrev_b32 v62, 16, v23
    v_and_b32 v63, 0xffff0000, v23
    v_mov_b32 v84, 0xbfb8aa3b
    v_mov_b32 v85, 0xbfb8aa3b
    v_mov_b32 v86, 0x3f800000
    v_mov_b32 v87, 0x3f800000
    v_pk_add_f32 v[24:25], v[24:25], v[44:45]
    v_pk_add_f32 v[26:27], v[26:27], v[46:47]
    v_pk_add_f32 v[28:29], v[28:29], v[48:49]
    v_pk_add_f32 v[30:31], v[30:31], v[50:51]
    v_pk_add_f32 v[32:33], v[32:33], v[52:53]
    v_pk_add_f32 v[34:35], v[34:35], v[54:55]
    v_pk_add_f32 v[36:37], v[36:37], v[56:57]
    v_pk_add_f32 v[38:39], v[38:39], v[58:59]
    v_pk_add_f32 v[40:41], v[40:41], v[60:61]
    v_pk_add_f32 v[42:43], v[42:43], v[62:63]
    v_pk_mul_f32 v[44:45], v[24:25], v[84:85]
    v_pk_mul_f32 v[46:47], v[26:27], v[84:85]
    v_pk_mul_f32 v[48:49], v[28:29], v[84:85]
    v_pk_mul_f32 v[50:51], v[30:31], v[84:85]
    v_pk_mul_f32 v[52:53], v[32:33], v[84:85]
    v_pk_mul_f32 v[54:55], v[34:35], v[84:85]
    v_pk_mul_f32 v[56:57], v[36:37], v[84:85]
    v_pk_mul_f32 v[58:59], v[38:39], v[84:85]
    v_pk_mul_f32 v[60:61], v[40:41], v[84:85]
    v_pk_mul_f32 v[62:63], v[42:43], v[84:85]
    v_exp_f32 v44, v44
    v_exp_f32 v45, v45
    v_exp_f32 v46, v46
    v_exp_f32 v47, v47
    v_exp_f32 v48, v48
    v_exp_f32 v49, v49
    v_exp_f32 v50, v50
    v_exp_f32 v51, v51
    v_exp_f32 v52, v52
    v_exp_f32 v53, v53
    v_exp_f32 v54, v54
    v_exp_f32 v55, v55
    v_exp_f32 v56, v56
    v_exp_f32 v57, v57
    v_exp_f32 v58, v58
    v_exp_f32 v59, v59
    v_exp_f32 v60, v60
    v_exp_f32 v61, v61
    v_exp_f32 v62, v62
    v_exp_f32 v63, v63
    v_pk_add_f32 v[44:45], v[44:45], v[86:87]
    v_pk_add_f32 v[46:47], v[46:47], v[86:87]
    v_pk_add_f32 v[48:49], v[48:49], v[86:87]
    v_pk_add_f32 v[50:51], v[50:51], v[86:87]
    v_pk_add_f32 v[52:53], v[52:53], v[86:87]
    v_pk_add_f32 v[54:55], v[54:55], v[86:87]
    v_pk_add_f32 v[56:57], v[56:57], v[86:87]
    v_pk_add_f32 v[58:59], v[58:59], v[86:87]
    v_pk_add_f32 v[60:61], v[60:61], v[86:87]
    v_pk_add_f32 v[62:63], v[62:63], v[86:87]
    v_rcp_f32 v44, v44
    v_rcp_f32 v45, v45
    v_rcp_f32 v46, v46
    v_rcp_f32 v47, v47
    v_rcp_f32 v48, v48
    v_rcp_f32 v49, v49
    v_rcp_f32 v50, v50
    v_rcp_f32 v51, v51
    v_rcp_f32 v52, v52
    v_rcp_f32 v53, v53
    v_rcp_f32 v54, v54
    v_rcp_f32 v55, v55
    v_rcp_f32 v56, v56
    v_rcp_f32 v57, v57
    v_rcp_f32 v58, v58
    v_rcp_f32 v59, v59
    v_rcp_f32 v60, v60
    v_rcp_f32 v61, v61
    v_rcp_f32 v62, v62
    v_rcp_f32 v63, v63
    v_pk_mul_f32 v[24:25], v[24:25], v[44:45]
    v_pk_mul_f32 v[26:27], v[26:27], v[46:47]
    v_pk_mul_f32 v[28:29], v[28:29], v[48:49]
    v_pk_mul_f32 v[30:31], v[30:31], v[50:51]
    v_pk_mul_f32 v[32:33], v[32:33], v[52:53]
    v_pk_mul_f32 v[34:35], v[34:35], v[54:55]
    v_pk_mul_f32 v[36:37], v[36:37], v[56:57]
    v_pk_mul_f32 v[38:39], v[38:39], v[58:59]
    v_pk_mul_f32 v[40:41], v[40:41], v[60:61]
    v_pk_mul_f32 v[42:43], v[42:43], v[62:63]
    v_cvt_pk_bf16_f32 v14, v24, v25
    v_cvt_pk_bf16_f32 v15, v26, v27
    v_cvt_pk_bf16_f32 v16, v28, v29
    v_cvt_pk_bf16_f32 v17, v30, v31
    v_cvt_pk_bf16_f32 v18, v32, v33
    v_cvt_pk_bf16_f32 v19, v34, v35
    v_cvt_pk_bf16_f32 v20, v36, v37
    v_cvt_pk_bf16_f32 v21, v38, v39
    v_cvt_pk_bf16_f32 v22, v40, v41
    v_cvt_pk_bf16_f32 v23, v42, v43
    s_mul_i32 s48, s30, 204800
    s_add_u32 s48, s48, 30408704
    s_mul_i32 s33, s28, 40960
    s_add_u32 s33, s33, s48
    s_mul_i32 s52, s28, 10240
    s_add_u32 s52, s52, s48
    s_add_u32 s52, s52, 163840
    s_setprio 0
    buffer_load_dwordx4 v[104:107], v8, s[16:19], s52 offen offset:0
    buffer_load_dwordx4 v[108:111], v8, s[16:19], s52 offen offset:1024
    buffer_load_dwordx4 v[112:115], v8, s[16:19], s52 offen offset:2048
    buffer_load_dwordx4 v[116:119], v8, s[16:19], s52 offen offset:3072
    buffer_load_dwordx4 v[120:123], v9, s[16:19], s52 offen
    s_add_u32 s52, s52, 5120
attn_kernel_gB_spin:
    ds_read_b32 v2, v6 offset:4
    s_waitcnt lgkmcnt(0)
    v_readfirstlane_b32 s48, v2
    s_cmp_ge_u32 s48, 4
    s_cbranch_scc1 attn_kernel_gB_go
    s_sleep 1
    s_branch attn_kernel_gB_spin
attn_kernel_gB_go:
    s_add_u32 m0, s31, 0
    s_nop 0
    buffer_load_dwordx4 v8, s[16:19], s52 offen offset:0 lds
    buffer_load_dwordx4 v8, s[16:19], s52 offen offset:1024 lds
    buffer_load_dwordx4 v8, s[16:19], s52 offen offset:2048 lds
    buffer_load_dwordx4 v8, s[16:19], s52 offen offset:3072 lds
    s_add_u32 m0, s31, 4096
    s_nop 0
    buffer_load_dwordx4 v9, s[16:19], s52 offen lds
    s_add_u32 s52, s52, 5120
    s_add_u32 m0, s31, 5120
    s_nop 0
    buffer_load_dwordx4 v8, s[16:19], s33 offen offset:0 lds
    buffer_load_dwordx4 v8, s[16:19], s33 offen offset:1024 lds
    buffer_load_dwordx4 v8, s[16:19], s33 offen offset:2048 lds
    buffer_load_dwordx4 v8, s[16:19], s33 offen offset:3072 lds
    s_add_u32 m0, s31, 9216
    s_nop 0
    buffer_load_dwordx4 v9, s[16:19], s33 offen lds
    s_add_u32 s33, s33, 5120
    s_add_u32 m0, s31, 10240
    s_nop 0
    buffer_load_dwordx4 v8, s[16:19], s33 offen offset:0 lds
    buffer_load_dwordx4 v8, s[16:19], s33 offen offset:1024 lds
    buffer_load_dwordx4 v8, s[16:19], s33 offen offset:2048 lds
    buffer_load_dwordx4 v8, s[16:19], s33 offen offset:3072 lds
    s_add_u32 m0, s31, 14336
    s_nop 0
    buffer_load_dwordx4 v9, s[16:19], s33 offen lds
    s_add_u32 s33, s33, 5120
    s_add_u32 m0, s31, 15360
    s_nop 0
    buffer_load_dwordx4 v8, s[16:19], s33 offen offset:0 lds
    buffer_load_dwordx4 v8, s[16:19], s33 offen offset:1024 lds
    buffer_load_dwordx4 v8, s[16:19], s33 offen offset:2048 lds
    buffer_load_dwordx4 v8, s[16:19], s33 offen offset:3072 lds
    s_add_u32 m0, s31, 19456
    s_nop 0
    buffer_load_dwordx4 v9, s[16:19], s33 offen lds
    s_add_u32 s33, s33, 5120
    s_mul_i32 s32, s29, 40960
    s_add_u32 s32, s32, 16777216
    s_lshl_b32 s48, s28, 13
    s_add_u32 s35, s32, s48
    s_add_u32 s64, s35, 4096
    s_lshl_b32 s48, s28, 11
    s_add_u32 s65, s32, s48
    s_add_u32 s65, s65, 32768
    v_lshrrev_b32 v3, 1, v1
    v_and_b32 v4, 1, v1
    v_lshlrev_b32 v3, 9, v3
    v_lshl_add_u32 v3, v4, 3, v3
attn_kernel_gC_spin:
    ds_read_b32 v2, v6 offset:8
    s_waitcnt lgkmcnt(0)
    v_readfirstlane_b32 s48, v2
    s_cmp_ge_u32 s48, 8
    s_cbranch_scc1 attn_kernel_gC_go
    s_sleep 8
    s_branch attn_kernel_gC_spin
attn_kernel_gC_go:
    s_add_u32 m0, s34, 0
    s_nop 0
    buffer_load_dwordx4 v8, s[16:19], s33 offen offset:0 lds
    buffer_load_dwordx4 v8, s[16:19], s33 offen offset:1024 lds
    buffer_load_dwordx4 v8, s[16:19], s33 offen offset:2048 lds
    buffer_load_dwordx4 v8, s[16:19], s33 offen offset:3072 lds
    s_add_u32 m0, s34, 4096
    s_nop 0
    buffer_load_dwordx4 v9, s[16:19], s33 offen lds
    s_add_u32 s33, s33, 5120
    s_add_u32 m0, s34, 5120
    s_nop 0
    buffer_load_dwordx4 v8, s[16:19], s33 offen offset:0 lds
    buffer_load_dwordx4 v8, s[16:19], s33 offen offset:1024 lds
    buffer_load_dwordx4 v8, s[16:19], s33 offen offset:2048 lds
    buffer_load_dwordx4 v8, s[16:19], s33 offen offset:3072 lds
    s_add_u32 m0, s34, 9216
    s_nop 0
    buffer_load_dwordx4 v9, s[16:19], s33 offen lds
    s_add_u32 s33, s33, 5120
    s_add_u32 m0, s34, 10240
    s_nop 0
    buffer_load_dwordx4 v8, s[16:19], s33 offen offset:0 lds
    buffer_load_dwordx4 v8, s[16:19], s33 offen offset:1024 lds
    buffer_load_dwordx4 v8, s[16:19], s33 offen offset:2048 lds
    buffer_load_dwordx4 v8, s[16:19], s33 offen offset:3072 lds
    s_add_u32 m0, s34, 14336
    s_nop 0
    buffer_load_dwordx4 v9, s[16:19], s33 offen lds
    s_add_u32 s33, s33, 5120
    s_mov_b32 s49, 0
    s_mov_b64 exec, 0xff
attn_kernel_glight:
    buffer_load_dword v2, v3, s[16:19], s65 offen sc0 sc1
    s_waitcnt vmcnt(0)
    v_cmp_eq_u32 vcc, -1, v2
    s_add_u32 s49, s49, 1
    s_cmp_gt_u32 s49, 0x20000
    s_cbranch_scc1 attn_kernel_glok
    s_cmp_lg_u64 vcc, 0
    s_cbranch_scc1 attn_kernel_glight
attn_kernel_glok:
    s_mov_b64 exec, -1
attn_kernel_gpoll:
    buffer_load_dwordx4 v[124:127], v8, s[16:19], s35 offen offset:0 sc0 sc1
    buffer_load_dwordx4 v[128:131], v8, s[16:19], s35 offen offset:1024 sc0 sc1
    buffer_load_dwordx4 v[132:135], v8, s[16:19], s35 offen offset:2048 sc0 sc1
    buffer_load_dwordx4 v[136:139], v8, s[16:19], s35 offen offset:3072 sc0 sc1
    buffer_load_dwordx4 v[140:143], v8, s[16:19], s64 offen offset:0 sc0 sc1
    buffer_load_dwordx4 v[144:147], v8, s[16:19], s64 offen offset:1024 sc0 sc1
    buffer_load_dwordx4 v[148:151], v8, s[16:19], s64 offen offset:2048 sc0 sc1
    buffer_load_dwordx4 v[152:155], v8, s[16:19], s64 offen offset:3072 sc0 sc1
    buffer_load_dwordx4 v[156:159], v8, s[16:19], s65 offen offset:0 sc0 sc1
    buffer_load_dwordx4 v[160:163], v8, s[16:19], s65 offen offset:1024 sc0 sc1
    s_waitcnt vmcnt(9)
    v_max3_u32 v2, v124, v125, v126
    v_max_u32 v2, v127, v2
    s_waitcnt vmcnt(8)
    v_max3_u32 v2, v128, v129, v2
    v_max3_u32 v2, v130, v131, v2
    s_waitcnt vmcnt(7)
    v_max3_u32 v2, v132, v133, v2
    v_max3_u32 v2, v134, v135, v2
    s_waitcnt vmcnt(6)
    v_max3_u32 v2, v136, v137, v2
    v_max3_u32 v2, v138, v139, v2
    s_waitcnt vmcnt(5)
    v_max3_u32 v2, v140, v141, v2
    v_max3_u32 v2, v142, v143, v2
    s_waitcnt vmcnt(4)
    v_max3_u32 v2, v144, v145, v2
    v_max3_u32 v2, v146, v147, v2
    s_waitcnt vmcnt(3)
    v_max3_u32 v2, v148, v149, v2
    v_max3_u32 v2, v150, v151, v2
    s_waitcnt vmcnt(2)
    v_max3_u32 v2, v152, v153, v2
    v_max3_u32 v2, v154, v155, v2
    s_waitcnt vmcnt(1)
    v_max3_u32 v2, v156, v157, v2
    v_max3_u32 v2, v158, v159, v2
    s_waitcnt vmcnt(0)
    v_max3_u32 v2, v160, v161, v2
    v_max3_u32 v2, v162, v163, v2
    v_cmp_eq_u32 vcc, -1, v2
    s_add_u32 s49, s49, 1
    s_cmp_gt_u32 s49, 0x20000
    s_cbranch_scc1 attn_kernel_gok
    s_cmp_lg_u64 vcc, 0
    s_cbranch_scc1 attn_kernel_gpoll
attn_kernel_gok:
    v_mfma_f32_32x32x16_bf16 v[24:39], v[104:107], v[156:159], 0
    ds_read_b128 v[104:107], v12 offset:0
    v_mfma_f32_32x32x16_bf16 v[40:55], v[108:111], v[156:159], 0
    ds_read_b128 v[108:111], v12 offset:1024
    v_mfma_f32_32x32x16_bf16 v[56:71], v[112:115], v[156:159], 0
    ds_read_b128 v[112:115], v12 offset:2048
    v_mfma_f32_32x32x16_bf16 v[72:87], v[116:119], v[156:159], 0
    ds_read_b128 v[116:119], v12 offset:3072
    v_mfma_f32_32x32x16_bf16 v[88:103], v[120:123], v[156:159], 0
    ds_read_b128 v[120:123], v12 offset:4096
    s_waitcnt lgkmcnt(4)
    v_mfma_f32_32x32x16_bf16 v[24:39], v[104:107], v[160:163], v[24:39]
    ds_read_b128 v[104:107], v12 offset:5120
    s_waitcnt lgkmcnt(4)
    v_mfma_f32_32x32x16_bf16 v[40:55], v[108:111], v[160:163], v[40:55]
    ds_read_b128 v[108:111], v12 offset:6144
    s_waitcnt lgkmcnt(4)
    v_mfma_f32_32x32x16_bf16 v[56:71], v[112:115], v[160:163], v[56:71]
    ds_read_b128 v[112:115], v12 offset:7168
    s_waitcnt lgkmcnt(4)
    v_mfma_f32_32x32x16_bf16 v[72:87], v[116:119], v[160:163], v[72:87]
    ds_read_b128 v[116:119], v12 offset:8192
    s_waitcnt lgkmcnt(4)
    v_mfma_f32_32x32x16_bf16 v[88:103], v[120:123], v[160:163], v[88:103]
    ds_read_b128 v[120:123], v12 offset:9216
    s_add_u32 m0, s31, 0
    s_nop 0
    buffer_load_dwordx4 v8, s[16:19], s33 offen offset:0 lds
    buffer_load_dwordx4 v8, s[16:19], s33 offen offset:1024 lds
    buffer_load_dwordx4 v8, s[16:19], s33 offen offset:2048 lds
    buffer_load_dwordx4 v8, s[16:19], s33 offen offset:3072 lds
    s_add_u32 m0, s31, 4096
    s_nop 0
    buffer_load_dwordx4 v9, s[16:19], s33 offen lds
    s_add_u32 s33, s33, 5120
    s_waitcnt lgkmcnt(4)
    v_mfma_f32_32x32x16_bf16 v[24:39], v[104:107], v[124:127], v[24:39]
    ds_read_b128 v[104:107], v12 offset:10240
    s_waitcnt lgkmcnt(4)
    v_mfma_f32_32x32x16_bf16 v[40:55], v[108:111], v[124:127], v[40:55]
    ds_read_b128 v[108:111], v12 offset:11264
    s_waitcnt lgkmcnt(4)
    v_mfma_f32_32x32x16_bf16 v[56:71], v[112:115], v[124:127], v[56:71]
    ds_read_b128 v[112:115], v12 offset:12288
    s_waitcnt lgkmcnt(4)
    v_mfma_f32_32x32x16_bf16 v[72:87], v[116:119], v[124:127], v[72:87]
    ds_read_b128 v[116:119], v12 offset:13312
    s_waitcnt lgkmcnt(4)
    v_mfma_f32_32x32x16_bf16 v[88:103], v[120:123], v[124:127], v[88:103]
    ds_read_b128 v[120:123], v12 offset:14336
    s_add_u32 m0, s31, 5120
    s_nop 0
    buffer_load_dwordx4 v8, s[16:19], s33 offen offset:0 lds
    buffer_load_dwordx4 v8, s[16:19], s33 offen offset:1024 lds
    buffer_load_dwordx4 v8, s[16:19], s33 offen offset:2048 lds
    buffer_load_dwordx4 v8, s[16:19], s33 offen offset:3072 lds
    s_add_u32 m0, s31, 9216
    s_nop 0
    buffer_load_dwordx4 v9, s[16:19], s33 offen lds
    s_add_u32 s33, s33, 5120
    buffer_load_dwordx4 v[156:159], v10, s[56:59], s51 offen
    buffer_load_dwordx4 v[160:163], v10, s[56:59], s51 offen offset:16
    buffer_load_dwordx2 v[124:125], v10, s[56:59], s51 offen offset:32
    s_waitcnt lgkmcnt(4)
    v_mfma_f32_32x32x16_bf16 v[24:39], v[104:107], v[128:131], v[24:39]
    ds_read_b128 v[104:107], v12 offset:15360
    s_waitcnt lgkmcnt(4)
    v_mfma_f32_32x32x16_bf16 v[40:55], v[108:111], v[128:131], v[40:55]
    ds_read_b128 v[108:111], v12 offset:16384
    s_waitcnt lgkmcnt(4)
    v_mfma_f32_32x32x16_bf16 v[56:71], v[112:115], v[128:131], v[56:71]
    ds_read_b128 v[112:115], v12 offset:17408
    s_waitcnt lgkmcnt(4)
    v_mfma_f32_32x32x16_bf16 v[72:87], v[116:119], v[128:131], v[72:87]
    ds_read_b128 v[116:119], v12 offset:18432
    s_waitcnt lgkmcnt(4)
    v_mfma_f32_32x32x16_bf16 v[88:103], v[120:123], v[128:131], v[88:103]
    ds_read_b128 v[120:123], v12 offset:19456
    s_waitcnt lgkmcnt(4)
    v_mfma_f32_32x32x16_bf16 v[24:39], v[104:107], v[132:135], v[24:39]
    ds_read_b128 v[104:107], v13 offset:0
    s_waitcnt lgkmcnt(4)
    v_mfma_f32_32x32x16_bf16 v[40:55], v[108:111], v[132:135], v[40:55]
    ds_read_b128 v[108:111], v13 offset:1024
    s_waitcnt lgkmcnt(4)
    v_mfma_f32_32x32x16_bf16 v[56:71], v[112:115], v[132:135], v[56:71]
    ds_read_b128 v[112:115], v13 offset:2048
    s_waitcnt lgkmcnt(4)
    v_mfma_f32_32x32x16_bf16 v[72:87], v[116:119], v[132:135], v[72:87]
    ds_read_b128 v[116:119], v13 offset:3072
    s_waitcnt lgkmcnt(4)
    v_mfma_f32_32x32x16_bf16 v[88:103], v[120:123], v[132:135], v[88:103]
    ds_read_b128 v[120:123], v13 offset:4096
    s_waitcnt lgkmcnt(4)
    v_mfma_f32_32x32x16_bf16 v[24:39], v[104:107], v[136:139], v[24:39]
    ds_read_b128 v[104:107], v13 offset:5120
    s_waitcnt lgkmcnt(4)
    v_mfma_f32_32x32x16_bf16 v[40:55], v[108:111], v[136:139], v[40:55]
    ds_read_b128 v[108:111], v13 offset:6144
    s_waitcnt lgkmcnt(4)
    v_mfma_f32_32x32x16_bf16 v[56:71], v[112:115], v[136:139], v[56:71]
    ds_read_b128 v[112:115], v13 offset:7168
    s_waitcnt lgkmcnt(4)
    v_mfma_f32_32x32x16_bf16 v[72:87], v[116:119], v[136:139], v[72:87]
    ds_read_b128 v[116:119], v13 offset:8192
    s_waitcnt lgkmcnt(4)
    v_mfma_f32_32x32x16_bf16 v[88:103], v[120:123], v[136:139], v[88:103]
    ds_read_b128 v[120:123], v13 offset:9216
    s_waitcnt lgkmcnt(4)
    v_mfma_f32_32x32x16_bf16 v[24:39], v[104:107], v[140:143], v[24:39]
    ds_read_b128 v[104:107], v13 offset:10240
    s_waitcnt lgkmcnt(4)
    v_mfma_f32_32x32x16_bf16 v[40:55], v[108:111], v[140:143], v[40:55]
    ds_read_b128 v[108:111], v13 offset:11264
    s_waitcnt lgkmcnt(4)
    v_mfma_f32_32x32x16_bf16 v[56:71], v[112:115], v[140:143], v[56:71]
    ds_read_b128 v[112:115], v13 offset:12288
    s_waitcnt lgkmcnt(4)
    v_mfma_f32_32x32x16_bf16 v[72:87], v[116:119], v[140:143], v[72:87]
    ds_read_b128 v[116:119], v13 offset:13312
    s_waitcnt lgkmcnt(4)
    v_mfma_f32_32x32x16_bf16 v[88:103], v[120:123], v[140:143], v[88:103]
    ds_read_b128 v[120:123], v13 offset:14336
    s_waitcnt vmcnt(8)
    s_waitcnt lgkmcnt(4)
    v_mfma_f32_32x32x16_bf16 v[24:39], v[104:107], v[144:147], v[24:39]
    ds_read_b128 v[104:107], v12 offset:0
    s_waitcnt lgkmcnt(4)
    v_mfma_f32_32x32x16_bf16 v[40:55], v[108:111], v[144:147], v[40:55]
    ds_read_b128 v[108:111], v12 offset:1024
    s_waitcnt lgkmcnt(4)
    v_mfma_f32_32x32x16_bf16 v[56:71], v[112:115], v[144:147], v[56:71]
    ds_read_b128 v[112:115], v12 offset:2048
    s_waitcnt lgkmcnt(4)
    v_mfma_f32_32x32x16_bf16 v[72:87], v[116:119], v[144:147], v[72:87]
    ds_read_b128 v[116:119], v12 offset:3072
    s_waitcnt lgkmcnt(4)
    v_mfma_f32_32x32x16_bf16 v[88:103], v[120:123], v[144:147], v[88:103]
    ds_read_b128 v[120:123], v12 offset:4096
    s_waitcnt vmcnt(3)
    s_waitcnt lgkmcnt(4)
    v_mfma_f32_32x32x16_bf16 v[24:39], v[104:107], v[148:151], v[24:39]
    ds_read_b128 v[104:107], v12 offset:5120
    s_waitcnt lgkmcnt(4)
    v_mfma_f32_32x32x16_bf16 v[40:55], v[108:111], v[148:151], v[40:55]
    ds_read_b128 v[108:111], v12 offset:6144
    s_waitcnt lgkmcnt(4)
    v_mfma_f32_32x32x16_bf16 v[56:71], v[112:115], v[148:151], v[56:71]
    ds_read_b128 v[112:115], v12 offset:7168
    s_waitcnt lgkmcnt(4)
    v_mfma_f32_32x32x16_bf16 v[72:87], v[116:119], v[148:151], v[72:87]
    ds_read_b128 v[116:119], v12 offset:8192
    s_waitcnt lgkmcnt(4)
    v_mfma_f32_32x32x16_bf16 v[88:103], v[120:123], v[148:151], v[88:103]
    ds_read_b128 v[120:123], v12 offset:9216
    s_waitcnt lgkmcnt(4)
    v_mfma_f32_32x32x16_bf16 v[24:39], v[104:107], v[152:155], v[24:39]
    s_waitcnt lgkmcnt(3)
    v_mfma_f32_32x32x16_bf16 v[40:55], v[108:111], v[152:155], v[40:55]
    s_waitcnt lgkmcnt(2)
    v_mfma_f32_32x32x16_bf16 v[56:71], v[112:115], v[152:155], v[56:71]
    s_waitcnt lgkmcnt(1)
    v_mfma_f32_32x32x16_bf16 v[72:87], v[116:119], v[152:155], v[72:87]
    s_waitcnt lgkmcnt(0)
    v_mfma_f32_32x32x16_bf16 v[88:103], v[120:123], v[152:155], v[88:103]
    v_and_b32 v2, 31, v1
    v_lshrrev_b32 v3, 5, v1
    v_mul_u32_u24 v2, 656, v2
    v_lshl_add_u32 v2, v3, 4, v2
    v_add_u32 v2, s31, v2
    s_nop 10
    ds_write_b128 v2, v[24:27] offset:0
    ds_write_b128 v2, v[28:31] offset:32
    ds_write_b128 v2, v[32:35] offset:64
    ds_write_b128 v2, v[36:39] offset:96
    ds_write_b128 v2, v[40:43] offset:128
    ds_write_b128 v2, v[44:47] offset:160
    ds_write_b128 v2, v[48:51] offset:192
    ds_write_b128 v2, v[52:55] offset:224
    ds_write_b128 v2, v[56:59] offset:256
    ds_write_b128 v2, v[60:63] offset:288
    ds_write_b128 v2, v[64:67] offset:320
    ds_write_b128 v2, v[68:71] offset:352
    ds_write_b128 v2, v[72:75] offset:384
    ds_write_b128 v2, v[76:79] offset:416
    ds_write_b128 v2, v[80:83] offset:448
    ds_write_b128 v2, v[84:87] offset:480
    ds_write_b128 v2, v[88:91] offset:512
    ds_write_b128 v2, v[92:95] offset:544
    ds_write_b128 v2, v[96:99] offset:576
    ds_write_b128 v2, v[100:103] offset:608
    s_waitcnt lgkmcnt(0)
    s_mov_b64 exec, 1
    ds_add_u32 v6, v7 offset:12
    s_mov_b64 exec, -1
attn_kernel_gD_spin:
    ds_read_b32 v2, v6 offset:12
    s_waitcnt lgkmcnt(0)
    v_readfirstlane_b32 s48, v2
    s_cmp_ge_u32 s48, 4
    s_cbranch_scc1 attn_kernel_gD_go
    s_sleep 1
    s_branch attn_kernel_gD_spin
attn_kernel_gD_go:
    ds_read_b128 v[24:27], v11 offset:0
    ds_read_b128 v[28:31], v11 offset:16
    ds_read_b128 v[32:35], v11 offset:32
    ds_read_b128 v[36:39], v11 offset:48
    ds_read_b128 v[40:43], v11 offset:64
    ds_read_b128 v[44:47], v11 offset:21120
    ds_read_b128 v[48:51], v11 offset:21136
    ds_read_b128 v[52:55], v11 offset:21152
    ds_read_b128 v[56:59], v11 offset:21168
    ds_read_b128 v[60:63], v11 offset:21184
    ds_read_b128 v[64:67], v11 offset:42240
    ds_read_b128 v[68:71], v11 offset:42256
    ds_read_b128 v[72:75], v11 offset:42272
    ds_read_b128 v[76:79], v11 offset:42288
    ds_read_b128 v[80:83], v11 offset:42304
    ds_read_b128 v[84:87], v11 offset:63360
    ds_read_b128 v[88:91], v11 offset:63376
    ds_read_b128 v[92:95], v11 offset:63392
    ds_read_b128 v[96:99], v11 offset:63408
    ds_read_b128 v[100:103], v11 offset:63424
    s_waitcnt lgkmcnt(0)
    v_pk_add_f32 v[24:25], v[24:25], v[44:45]
    v_pk_add_f32 v[64:65], v[64:65], v[84:85]
    v_pk_add_f32 v[26:27], v[26:27], v[46:47]
    v_pk_add_f32 v[66:67], v[66:67], v[86:87]
    v_pk_add_f32 v[28:29], v[28:29], v[48:49]
    v_pk_add_f32 v[68:69], v[68:69], v[88:89]
    v_pk_add_f32 v[30:31], v[30:31], v[50:51]
    v_pk_add_f32 v[70:71], v[70:71], v[90:91]
    v_pk_add_f32 v[32:33], v[32:33], v[52:53]
    v_pk_add_f32 v[72:73], v[72:73], v[92:93]
    v_pk_add_f32 v[34:35], v[34:35], v[54:55]
    v_pk_add_f32 v[74:75], v[74:75], v[94:95]
    v_pk_add_f32 v[36:37], v[36:37], v[56:57]
    v_pk_add_f32 v[76:77], v[76:77], v[96:97]
    v_pk_add_f32 v[38:39], v[38:39], v[58:59]
    v_pk_add_f32 v[78:79], v[78:79], v[98:99]
    v_pk_add_f32 v[40:41], v[40:41], v[60:61]
    v_pk_add_f32 v[80:81], v[80:81], v[100:101]
    v_pk_add_f32 v[42:43], v[42:43], v[62:63]
    v_pk_add_f32 v[82:83], v[82:83], v[102:103]
    v_pk_add_f32 v[24:25], v[24:25], v[64:65]
    v_pk_add_f32 v[26:27], v[26:27], v[66:67]
    v_pk_add_f32 v[28:29], v[28:29], v[68:69]
    v_pk_add_f32 v[30:31], v[30:31], v[70:71]
    v_pk_add_f32 v[32:33], v[32:33], v[72:73]
    v_pk_add_f32 v[34:35], v[34:35], v[74:75]
    v_pk_add_f32 v[36:37], v[36:37], v[76:77]
    v_pk_add_f32 v[38:39], v[38:39], v[78:79]
    v_pk_add_f32 v[40:41], v[40:41], v[80:81]
    v_pk_add_f32 v[42:43], v[42:43], v[82:83]
    s_waitcnt vmcnt(0)
    v_lshlrev_b32 v44, 16, v156
    v_and_b32 v45, 0xffff0000, v156
    v_lshlrev_b32 v64, 16, v14
    v_and_b32 v65, 0xffff0000, v14
    v_lshlrev_b32 v46, 16, v157
    v_and_b32 v47, 0xffff0000, v157
    v_lshlrev_b32 v66, 16, v15
    v_and_b32 v67, 0xffff0000, v15
    v_lshlrev_b32 v48, 16, v158
    v_and_b32 v49, 0xffff0000, v158
    v_lshlrev_b32 v68, 16, v16
    v_and_b32 v69, 0xffff0000, v16
    v_lshlrev_b32 v50, 16, v159
    v_and_b32 v51, 0xffff0000, v159
    v_lshlrev_b32 v70, 16, v17
    v_and_b32 v71, 0xffff0000, v17
    v_lshlrev_b32 v52, 16, v160
    v_and_b32 v53, 0xffff0000, v160
    v_lshlrev_b32 v72, 16, v18
    v_and_b32 v73, 0xffff0000, v18
    v_lshlrev_b32 v54, 16, v161
    v_and_b32 v55, 0xffff0000, v161
    v_lshlrev_b32 v74, 16, v19
    v_and_b32 v75, 0xffff0000, v19
    v_lshlrev_b32 v56, 16, v162
    v_and_b32 v57, 0xffff0000, v162
    v_lshlrev_b32 v76, 16, v20
    v_and_b32 v77, 0xffff0000, v20
    v_lshlrev_b32 v58, 16, v163
    v_and_b32 v59, 0xffff0000, v163
    v_lshlrev_b32 v78, 16, v21
    v_and_b32 v79, 0xffff0000, v21
    v_lshlrev_b32 v60, 16, v124
    v_and_b32 v61, 0xffff0000, v124
    v_lshlrev_b32 v80, 16, v22
    v_and_b32 v81, 0xffff0000, v22
    v_lshlrev_b32 v62, 16, v125
    v_and_b32 v63, 0xffff0000, v125
    v_lshlrev_b32 v82, 16, v23
    v_and_b32 v83, 0xffff0000, v23
    v_pk_fma_f32 v[24:25], v[24:25], v[64:65], v[44:45]
    v_pk_fma_f32 v[26:27], v[26:27], v[66:67], v[46:47]
    v_pk_fma_f32 v[28:29], v[28:29], v[68:69], v[48:49]
    v_pk_fma_f32 v[30:31], v[30:31], v[70:71], v[50:51]
    v_pk_fma_f32 v[32:33], v[32:33], v[72:73], v[52:53]
    v_pk_fma_f32 v[34:35], v[34:35], v[74:75], v[54:55]
    v_pk_fma_f32 v[36:37], v[36:37], v[76:77], v[56:57]
    v_pk_fma_f32 v[38:39], v[38:39], v[78:79], v[58:59]
    v_pk_fma_f32 v[40:41], v[40:41], v[80:81], v[60:61]
    v_pk_fma_f32 v[42:43], v[42:43], v[82:83], v[62:63]
    v_cvt_pk_bf16_f32 v132, v24, v25
    v_cvt_pk_bf16_f32 v133, v26, v27
    v_cvt_pk_bf16_f32 v134, v28, v29
    v_cvt_pk_bf16_f32 v135, v30, v31
    v_cvt_pk_bf16_f32 v136, v32, v33
    v_cvt_pk_bf16_f32 v137, v34, v35
    v_cvt_pk_bf16_f32 v138, v36, v37
    v_cvt_pk_bf16_f32 v139, v38, v39
    v_cvt_pk_bf16_f32 v140, v40, v41
    v_cvt_pk_bf16_f32 v141, v42, v43
    buffer_store_dwordx4 v[132:135], v10, s[60:63], s51 offen
    buffer_store_dwordx4 v[136:139], v10, s[60:63], s51 offen offset:16
    buffer_store_dwordx2 v[140:141], v10, s[60:63], s51 offen offset:32
    s_endpgm
.section .rodata,"a"
.p2align 6
.amdhsa_kernel p1_kernel
  .amdhsa_next_free_vgpr 228
  .amdhsa_next_free_sgpr 102
  .amdhsa_accum_offset 228
  .amdhsa_group_segment_fixed_size 0
  .amdhsa_kernarg_size 88
  .amdhsa_user_sgpr_count 2
  .amdhsa_user_sgpr_kernarg_segment_ptr 1
  .amdhsa_system_sgpr_workgroup_id_x 1
.end_amdhsa_kernel
.p2align 6
.amdhsa_kernel attn_kernel
  .amdhsa_next_free_vgpr 168
  .amdhsa_next_free_sgpr 102
  .amdhsa_accum_offset 168
  .amdhsa_group_segment_fixed_size 0
  .amdhsa_kernarg_size 88
  .amdhsa_user_sgpr_count 2
  .amdhsa_user_sgpr_kernarg_segment_ptr 1
  .amdhsa_system_sgpr_workgroup_id_x 1
.end_amdhsa_kernel
```
